```python
import torch

def _softmax(x, axis=-1):
    return torch.softmax(x, dim=axis)
def _gelu(x):
    return torch.nn.functional.gelu(x, approximate="tanh")
def _silu(x):
    return torch.nn.functional.silu(x)
def _sigmoid(x):
    return torch.sigmoid(x)
def _layernorm(x, axis=-1, eps=1e-5):
    m = x.mean(dim=axis, keepdim=True)
    v = x.var(dim=axis, keepdim=True, unbiased=False)
    return (x - m) / torch.sqrt(v + eps)
def _scatter_add(tgt, idx, src, axis=0):
    return tgt.clone().index_add_(axis, idx, src)
def _segment_sum(src, seg, n):
    out = torch.zeros((n,) + src.shape[1:], dtype=src.dtype)
    return out.index_add_(0, seg, src)
def _pad(x, pw):
    flat = tuple(v for pair in reversed(pw) for v in pair)
    return torch.nn.functional.pad(x, flat)

kernel_name = 'standalone__modern_conv_block_replknet__vision'

def setup_inputs():

    _w = (lambda a: (lambda t: t.to(torch.bfloat16) if t.is_floating_point() else t)(torch.as_tensor(a)))
    H = W = 256
    C = 384
    K = 1
    return {
        "x": _w((lambda *s: torch.randn(*s, dtype=torch.bfloat16) * 0.05)(1, H, W, C)),
        "dw_large": _w((lambda *s: torch.randn(*s, dtype=torch.bfloat16) * 0.4)(K, K, C) * (1.0 / K)),
        "dw_small": _w((lambda *s: torch.randn(*s, dtype=torch.bfloat16) * 0.4)(5, 5, C) * 0.2),
        "w1": _w((lambda *s: torch.randn(*s, dtype=torch.bfloat16) * 0.4)(C, 4 * C) * (C ** -0.5)),
        "w2": _w((lambda *s: torch.randn(*s, dtype=torch.bfloat16) * 0.1)(4 * C, C) * ((4 * C) ** -0.5)),
    }

def reference(x, dw_large, dw_small, w1, w2):
    B, H, W, C = x.shape
    Kl = dw_large.shape[0]
    pl = (Kl - 1) // 2
    xpl = _pad(x, ((0,0),(pl,pl),(pl,pl),(0,0)))
    out = torch.zeros_like(x)
    for i in range(Kl):
        for j in range(Kl):
            out = out + xpl[:, i:i+H, j:j+W, :] * dw_large[i, j][None, None, None, :]
    Ks = dw_small.shape[0]
    ps = (Ks - 1) // 2
    xps = _pad(x, ((0,0),(ps,ps),(ps,ps),(0,0)))
    for i in range(Ks):
        for j in range(Ks):
            out = out + xps[:, i:i+H, j:j+W, :] * dw_small[i, j][None, None, None, :]
    h = _layernorm(out, axis=-1)
    h = _gelu(torch.einsum('bhwc,ce->bhwe', h, w1))
    h = torch.einsum('bhwe,ec->bhwc', h, w2)
    return x + h
```

```asm
; @launch grid=(256,1,1) block=(256,1,1) lds=163840
.amdgcn_target "amdgcn-amd-amdhsa--gfx950"
.text
.globl standalone__modern_conv_block_replknet__vision_kernel
.p2align 8
.type standalone__modern_conv_block_replknet__vision_kernel,@function
standalone__modern_conv_block_replknet__vision_kernel:
    s_cmp_ge_u32 s2, 256
    s_cbranch_scc1 L_end
    s_load_dwordx2 s[4:5], s[0:1], 0
    s_load_dwordx2 s[12:13], s[0:1], 40
    s_load_dwordx2 s[8:9], s[0:1], 56
    s_load_dwordx2 s[16:17], s[0:1], 16
    s_load_dwordx2 s[52:53], s[0:1], 8
    s_load_dwordx2 s[56:57], s[0:1], 48
    s_load_dwordx4 s[60:63], s[0:1], 24
    s_cmp_ge_u32 s2, 32
    s_cbranch_scc1 L_nocpf
    s_getpc_b64 s[90:91]
L_pc:
    s_lshr_b32 s92, s2, 3
    s_lshl_b32 s92, s92, 14
    v_lshlrev_b32 v240, 4, v0
    v_and_b32 v241, 0x3f0, v240
    v_lshrrev_b32 v240, 10, v240
    v_lshl_add_u32 v240, v240, 12, v241
    v_add_u32 v240, s92, v240
    v_add_u32 v241, 0, v240
    v_min_u32 v241, L_codeend-L_pc-16, v241
    global_load_dwordx4 v[244:247], v241, s[90:91]
    v_add_u32 v241, 1024, v240
    v_min_u32 v241, L_codeend-L_pc-16, v241
    global_load_dwordx4 v[244:247], v241, s[90:91]
    v_add_u32 v241, 2048, v240
    v_min_u32 v241, L_codeend-L_pc-16, v241
    global_load_dwordx4 v[244:247], v241, s[90:91]
    v_add_u32 v241, 3072, v240
    v_min_u32 v241, L_codeend-L_pc-16, v241
    global_load_dwordx4 v[244:247], v241, s[90:91]
L_nocpf:
    v_and_b32 v252, 63, v0
    v_lshrrev_b32 v1, 6, v0
    s_mov_b32 s37, 205
    v_readfirstlane_b32 s20, v1
    s_mov_b32 s38, 0x80000000
    s_and_b32 s35, s2, 7
    s_lshr_b32 s36, s2, 3
    s_lshr_b32 s39, s35, 2
    s_lshl_b32 s39, s39, 7
    s_lshr_b32 s41, s36, 2
    s_lshl_b32 s41, s41, 3
    s_add_u32 s39, s39, s41
    s_and_b32 s40, s35, 3
    s_lshl_b32 s40, s40, 6
    s_and_b32 s36, s36, 3
    s_lshl_b32 s36, s36, 4
    s_add_u32 s40, s40, s36
    s_lshl_b32 s41, s39, 8
    s_add_u32 s41, s41, s40
    s_mul_i32 s41, s41, 768
    s_mul_i32 s32, s20, 15360
    s_mul_i32 s34, s20, 64
    s_add_u32 s44, s34, 256
    s_add_u32 s45, s34, 512
    s_mul_i32 s24, s20, 3072
    s_mul_i32 s47, s20, 24576
    s_lshl_b32 s3, s20, 7
    s_add_u32 s3, s3, 0x100
    s_lshr_b32 s46, s20, 1
    s_mul_i32 s46, s46, 24576
    s_and_b32 s35, s20, 1
    s_mul_i32 s35, s35, 6144
    s_add_u32 s46, s46, s35
    v_lshlrev_b32 v200, 4, v252
    s_waitcnt lgkmcnt(0)
    s_sub_u32 s4, s4, 394752
    s_subb_u32 s5, s5, 0
    s_mov_b32 s6, 50726400
    s_mov_b32 s7, 0x20000
    s_mov_b32 s10, 2621440
    s_mov_b32 s11, 0x20000
    s_mov_b32 s14, 50331648
    s_mov_b32 s15, 0x20000
    s_mov_b32 s18, 19200
    s_mov_b32 s19, 0x20000
    s_mov_b32 s54, 768
    s_mov_b32 s55, 0x20000
    s_mov_b32 s58, 256
    s_mov_b32 s59, 0x20000
    v_and_b32 v160, 15, v252
    v_lshrrev_b32 v161, 4, v252
    s_mov_b32 s66, 1179648
    s_mov_b32 s67, 0x20000
    s_cmp_ge_u32 s2, 96
    s_cbranch_scc1 L_prep_w2
    s_mov_b32 s64, s60
    s_mov_b32 s65, s61
    s_mul_hi_u32 s71, s2, 0x15555556
    s_mul_i32 s71, s71, 12
    s_sub_u32 s72, s2, s71
    v_mul_u32_u24 v162, 6144, v161
    v_lshl_add_u32 v162, v160, 1, v162
    s_mul_i32 s70, s72, 98304
    v_add_u32 v162, s70, v162
    s_mov_b32 s80, 0
    s_mov_b32 s81, 3072
    s_mov_b32 s82, 24576
    s_mov_b32 s83, 27648
    s_mov_b32 s84, 49152
    s_mov_b32 s85, 52224
    s_mov_b32 s86, 73728
    s_mov_b32 s87, 76800
    s_branch L_prep_go
L_prep_w2:
    s_mov_b32 s64, s62
    s_mov_b32 s65, s63
    s_sub_u32 s70, s2, 96
    v_mul_u32_u24 v162, 3072, v161
    v_lshrrev_b32 v163, 2, v160
    v_lshl_add_u32 v162, v163, 4, v162
    v_and_b32 v163, 3, v160
    v_lshl_add_u32 v162, v163, 1, v162
    s_mov_b32 s80, 0
    s_mov_b32 s81, 768
    s_mov_b32 s82, 1536
    s_mov_b32 s83, 2304
    s_mov_b32 s84, 12288
    s_mov_b32 s85, 13056
    s_mov_b32 s86, 13824
    s_mov_b32 s87, 14592
    s_add_u32 s73, s70, 9
    s_mul_i32 s73, s73, 24576
    s_add_u32 s73, s73, 12288
L_prep_go:
    s_cmp_ge_u32 s2, 192
    s_cselect_b32 s74, s38, 0
    v_add_u32 v162, s74, v162
    s_mul_i32 s75, s20, 3
    s_add_u32 s75, s75, 0
    s_add_u32 s76, s75, s71
    s_mul_i32 s95, s76, 24576
    s_lshl_b32 s77, s72, 10
    s_add_u32 s95, s95, s77
    s_lshl_b32 s76, s76, 5
    s_lshr_b32 s77, s75, 2
    s_and_b32 s78, s75, 3
    s_and_b32 s79, s70, 7
    s_mul_i32 s79, s79, 3
    s_add_u32 s79, s79, s77
    s_lshr_b32 s77, s70, 3
    s_lshl_b32 s77, s77, 7
    s_lshl_b32 s78, s78, 5
    s_add_u32 s77, s77, s78
    s_mul_i32 s77, s77, 768
    s_lshr_b32 s78, s79, 1
    s_lshl_b32 s78, s78, 6
    s_add_u32 s77, s77, s78
    s_and_b32 s78, s79, 1
    s_lshl_b32 s78, s78, 3
    s_add_u32 s77, s77, s78
    s_lshl_b32 s78, s75, 10
    s_add_u32 s78, s78, s73
    s_cmp_ge_u32 s2, 96
    s_cselect_b32 s76, s77, s76
    s_cselect_b32 s95, s78, s95
    s_add_u32 s77, s76, s80
    buffer_load_ushort v128, v162, s[64:67], s77 offen
    s_add_u32 s77, s76, s81
    buffer_load_ushort v129, v162, s[64:67], s77 offen
    s_add_u32 s77, s76, s82
    buffer_load_ushort v130, v162, s[64:67], s77 offen
    s_add_u32 s77, s76, s83
    buffer_load_ushort v131, v162, s[64:67], s77 offen
    s_add_u32 s77, s76, s84
    buffer_load_ushort v132, v162, s[64:67], s77 offen
    s_add_u32 s77, s76, s85
    buffer_load_ushort v133, v162, s[64:67], s77 offen
    s_add_u32 s77, s76, s86
    buffer_load_ushort v134, v162, s[64:67], s77 offen
    s_add_u32 s77, s76, s87
    buffer_load_ushort v135, v162, s[64:67], s77 offen
    s_mul_i32 s75, s20, 3
    s_add_u32 s75, s75, 1
    s_add_u32 s76, s75, s71
    s_mul_i32 s96, s76, 24576
    s_lshl_b32 s77, s72, 10
    s_add_u32 s96, s96, s77
    s_lshl_b32 s76, s76, 5
    s_lshr_b32 s77, s75, 2
    s_and_b32 s78, s75, 3
    s_and_b32 s79, s70, 7
    s_mul_i32 s79, s79, 3
    s_add_u32 s79, s79, s77
    s_lshr_b32 s77, s70, 3
    s_lshl_b32 s77, s77, 7
    s_lshl_b32 s78, s78, 5
    s_add_u32 s77, s77, s78
    s_mul_i32 s77, s77, 768
    s_lshr_b32 s78, s79, 1
    s_lshl_b32 s78, s78, 6
    s_add_u32 s77, s77, s78
    s_and_b32 s78, s79, 1
    s_lshl_b32 s78, s78, 3
    s_add_u32 s77, s77, s78
    s_lshl_b32 s78, s75, 10
    s_add_u32 s78, s78, s73
    s_cmp_ge_u32 s2, 96
    s_cselect_b32 s76, s77, s76
    s_cselect_b32 s96, s78, s96
    s_add_u32 s77, s76, s80
    buffer_load_ushort v136, v162, s[64:67], s77 offen
    s_add_u32 s77, s76, s81
    buffer_load_ushort v137, v162, s[64:67], s77 offen
    s_add_u32 s77, s76, s82
    buffer_load_ushort v138, v162, s[64:67], s77 offen
    s_add_u32 s77, s76, s83
    buffer_load_ushort v139, v162, s[64:67], s77 offen
    s_add_u32 s77, s76, s84
    buffer_load_ushort v140, v162, s[64:67], s77 offen
    s_add_u32 s77, s76, s85
    buffer_load_ushort v141, v162, s[64:67], s77 offen
    s_add_u32 s77, s76, s86
    buffer_load_ushort v142, v162, s[64:67], s77 offen
    s_add_u32 s77, s76, s87
    buffer_load_ushort v143, v162, s[64:67], s77 offen
    s_mul_i32 s75, s20, 3
    s_add_u32 s75, s75, 2
    s_add_u32 s76, s75, s71
    s_mul_i32 s97, s76, 24576
    s_lshl_b32 s77, s72, 10
    s_add_u32 s97, s97, s77
    s_lshl_b32 s76, s76, 5
    s_lshr_b32 s77, s75, 2
    s_and_b32 s78, s75, 3
    s_and_b32 s79, s70, 7
    s_mul_i32 s79, s79, 3
    s_add_u32 s79, s79, s77
    s_lshr_b32 s77, s70, 3
    s_lshl_b32 s77, s77, 7
    s_lshl_b32 s78, s78, 5
    s_add_u32 s77, s77, s78
    s_mul_i32 s77, s77, 768
    s_lshr_b32 s78, s79, 1
    s_lshl_b32 s78, s78, 6
    s_add_u32 s77, s77, s78
    s_and_b32 s78, s79, 1
    s_lshl_b32 s78, s78, 3
    s_add_u32 s77, s77, s78
    s_lshl_b32 s78, s75, 10
    s_add_u32 s78, s78, s73
    s_cmp_ge_u32 s2, 96
    s_cselect_b32 s76, s77, s76
    s_cselect_b32 s97, s78, s97
    s_add_u32 s77, s76, s80
    buffer_load_ushort v144, v162, s[64:67], s77 offen
    s_add_u32 s77, s76, s81
    buffer_load_ushort v145, v162, s[64:67], s77 offen
    s_add_u32 s77, s76, s82
    buffer_load_ushort v146, v162, s[64:67], s77 offen
    s_add_u32 s77, s76, s83
    buffer_load_ushort v147, v162, s[64:67], s77 offen
    s_add_u32 s77, s76, s84
    buffer_load_ushort v148, v162, s[64:67], s77 offen
    s_add_u32 s77, s76, s85
    buffer_load_ushort v149, v162, s[64:67], s77 offen
    s_add_u32 s77, s76, s86
    buffer_load_ushort v150, v162, s[64:67], s77 offen
    s_add_u32 s77, s76, s87
    buffer_load_ushort v151, v162, s[64:67], s77 offen
    v_mov_b32 v197, s38
    v_lshrrev_b32 v192, 2, v252
    v_add_u32 v192, 0, v192
    v_mul_u32_u24 v193, s37, v192
    v_lshrrev_b32 v193, 12, v193
    v_mul_u32_u24 v194, 20, v193
    v_sub_u32 v192, v192, v194
    v_bfe_u32 v194, v192, 2, 2
    v_and_b32 v195, 3, v252
    v_xor_b32 v194, v194, v195
    v_lshlrev_b32 v194, 4, v194
    v_lshl_add_u32 v195, v193, 8, v192
    v_mul_u32_u24 v195, 0x300, v195
    v_add3_u32 v195, v195, v194, s41
    v_add_u32 v192, s40, v192
    v_subrev_u32 v192, 2, v192
    v_add_u32 v193, s39, v193
    v_subrev_u32 v193, 2, v193
    v_add_u32 v194, 0, v193
    v_or_b32 v194, v194, v192
    v_cmp_gt_u32 vcc, 0x100, v194
    v_add_u32 v196, 0, v195
    s_nop 0
    v_cndmask_b32 v212, v197, v196, vcc
    v_add_u32 v194, 4, v193
    v_or_b32 v194, v194, v192
    v_cmp_gt_u32 vcc, 0x100, v194
    v_add_u32 v196, 786432, v195
    s_nop 0
    v_cndmask_b32 v217, v197, v196, vcc
    v_add_u32 v194, 8, v193
    v_or_b32 v194, v194, v192
    v_cmp_gt_u32 vcc, 0x100, v194
    v_add_u32 v196, 1572864, v195
    s_nop 0
    v_cndmask_b32 v222, v197, v196, vcc
    v_lshrrev_b32 v192, 2, v252
    v_add_u32 v192, 16, v192
    v_mul_u32_u24 v193, s37, v192
    v_lshrrev_b32 v193, 12, v193
    v_mul_u32_u24 v194, 20, v193
    v_sub_u32 v192, v192, v194
    v_bfe_u32 v194, v192, 2, 2
    v_and_b32 v195, 3, v252
    v_xor_b32 v194, v194, v195
    v_lshlrev_b32 v194, 4, v194
    v_lshl_add_u32 v195, v193, 8, v192
    v_mul_u32_u24 v195, 0x300, v195
    v_add3_u32 v195, v195, v194, s41
    v_add_u32 v192, s40, v192
    v_subrev_u32 v192, 2, v192
    v_add_u32 v193, s39, v193
    v_subrev_u32 v193, 2, v193
    v_add_u32 v194, 0, v193
    v_or_b32 v194, v194, v192
    v_cmp_gt_u32 vcc, 0x100, v194
    v_add_u32 v196, 0, v195
    s_nop 0
    v_cndmask_b32 v213, v197, v196, vcc
    v_add_u32 v194, 4, v193
    v_or_b32 v194, v194, v192
    v_cmp_gt_u32 vcc, 0x100, v194
    v_add_u32 v196, 786432, v195
    s_nop 0
    v_cndmask_b32 v218, v197, v196, vcc
    v_add_u32 v194, 8, v193
    v_or_b32 v194, v194, v192
    v_cmp_gt_u32 vcc, 0x100, v194
    v_add_u32 v196, 1572864, v195
    s_nop 0
    v_cndmask_b32 v223, v197, v196, vcc
    v_lshrrev_b32 v192, 2, v252
    v_add_u32 v192, 32, v192
    v_mul_u32_u24 v193, s37, v192
    v_lshrrev_b32 v193, 12, v193
    v_mul_u32_u24 v194, 20, v193
    v_sub_u32 v192, v192, v194
    v_bfe_u32 v194, v192, 2, 2
    v_and_b32 v195, 3, v252
    v_xor_b32 v194, v194, v195
    v_lshlrev_b32 v194, 4, v194
    v_lshl_add_u32 v195, v193, 8, v192
    v_mul_u32_u24 v195, 0x300, v195
    v_add3_u32 v195, v195, v194, s41
    v_add_u32 v192, s40, v192
    v_subrev_u32 v192, 2, v192
    v_add_u32 v193, s39, v193
    v_subrev_u32 v193, 2, v193
    v_add_u32 v194, 0, v193
    v_or_b32 v194, v194, v192
    v_cmp_gt_u32 vcc, 0x100, v194
    v_add_u32 v196, 0, v195
    s_nop 0
    v_cndmask_b32 v214, v197, v196, vcc
    v_add_u32 v194, 4, v193
    v_or_b32 v194, v194, v192
    v_cmp_gt_u32 vcc, 0x100, v194
    v_add_u32 v196, 786432, v195
    s_nop 0
    v_cndmask_b32 v219, v197, v196, vcc
    v_add_u32 v194, 8, v193
    v_or_b32 v194, v194, v192
    v_cmp_gt_u32 vcc, 0x100, v194
    v_add_u32 v196, 1572864, v195
    s_nop 0
    v_cndmask_b32 v224, v197, v196, vcc
    v_lshrrev_b32 v192, 2, v252
    v_add_u32 v192, 48, v192
    v_mul_u32_u24 v193, s37, v192
    v_lshrrev_b32 v193, 12, v193
    v_mul_u32_u24 v194, 20, v193
    v_sub_u32 v192, v192, v194
    v_bfe_u32 v194, v192, 2, 2
    v_and_b32 v195, 3, v252
    v_xor_b32 v194, v194, v195
    v_lshlrev_b32 v194, 4, v194
    v_lshl_add_u32 v195, v193, 8, v192
    v_mul_u32_u24 v195, 0x300, v195
    v_add3_u32 v195, v195, v194, s41
    v_add_u32 v192, s40, v192
    v_subrev_u32 v192, 2, v192
    v_add_u32 v193, s39, v193
    v_subrev_u32 v193, 2, v193
    v_add_u32 v194, 0, v193
    v_or_b32 v194, v194, v192
    v_cmp_gt_u32 vcc, 0x100, v194
    v_add_u32 v196, 0, v195
    s_nop 0
    v_cndmask_b32 v215, v197, v196, vcc
    v_add_u32 v194, 4, v193
    v_or_b32 v194, v194, v192
    v_cmp_gt_u32 vcc, 0x100, v194
    v_add_u32 v196, 786432, v195
    s_nop 0
    v_cndmask_b32 v220, v197, v196, vcc
    v_add_u32 v194, 8, v193
    v_or_b32 v194, v194, v192
    v_cmp_gt_u32 vcc, 0x100, v194
    v_add_u32 v196, 1572864, v195
    s_nop 0
    v_cndmask_b32 v225, v197, v196, vcc
    v_lshrrev_b32 v192, 2, v252
    v_add_u32 v192, 64, v192
    v_mul_u32_u24 v193, s37, v192
    v_lshrrev_b32 v193, 12, v193
    v_mul_u32_u24 v194, 20, v193
    v_sub_u32 v192, v192, v194
    v_bfe_u32 v194, v192, 2, 2
    v_and_b32 v195, 3, v252
    v_xor_b32 v194, v194, v195
    v_lshlrev_b32 v194, 4, v194
    v_lshl_add_u32 v195, v193, 8, v192
    v_mul_u32_u24 v195, 0x300, v195
    v_add3_u32 v195, v195, v194, s41
    v_add_u32 v192, s40, v192
    v_subrev_u32 v192, 2, v192
    v_add_u32 v193, s39, v193
    v_subrev_u32 v193, 2, v193
    v_add_u32 v194, 0, v193
    v_or_b32 v194, v194, v192
    v_cmp_gt_u32 vcc, 0x100, v194
    v_add_u32 v196, 0, v195
    s_nop 0
    v_cndmask_b32 v216, v197, v196, vcc
    v_add_u32 v194, 4, v193
    v_or_b32 v194, v194, v192
    v_cmp_gt_u32 vcc, 0x100, v194
    v_add_u32 v196, 786432, v195
    s_nop 0
    v_cndmask_b32 v221, v197, v196, vcc
    v_add_u32 v194, 8, v193
    v_or_b32 v194, v194, v192
    v_cmp_gt_u32 vcc, 0x100, v194
    v_add_u32 v196, 1572864, v195
    s_nop 0
    v_cndmask_b32 v226, v197, v196, vcc
    s_add_u32 s32, s32, 98304
    s_add_u32 m0, s32, 0
    s_nop 0
    buffer_load_dwordx4 v212, s[4:7], s34 offen lds
    s_add_u32 m0, s32, 1024
    s_nop 0
    buffer_load_dwordx4 v213, s[4:7], s34 offen lds
    s_add_u32 m0, s32, 2048
    s_nop 0
    buffer_load_dwordx4 v214, s[4:7], s34 offen lds
    s_add_u32 m0, s32, 3072
    s_nop 0
    buffer_load_dwordx4 v215, s[4:7], s34 offen lds
    s_add_u32 m0, s32, 4096
    s_nop 0
    buffer_load_dwordx4 v216, s[4:7], s34 offen lds
    s_add_u32 m0, s32, 5120
    s_nop 0
    buffer_load_dwordx4 v217, s[4:7], s34 offen lds
    s_add_u32 m0, s32, 6144
    s_nop 0
    buffer_load_dwordx4 v218, s[4:7], s34 offen lds
    s_add_u32 m0, s32, 7168
    s_nop 0
    buffer_load_dwordx4 v219, s[4:7], s34 offen lds
    s_add_u32 m0, s32, 8192
    s_nop 0
    buffer_load_dwordx4 v220, s[4:7], s34 offen lds
    s_add_u32 m0, s32, 9216
    s_nop 0
    buffer_load_dwordx4 v221, s[4:7], s34 offen lds
    s_add_u32 m0, s32, 10240
    s_nop 0
    buffer_load_dwordx4 v222, s[4:7], s34 offen lds
    s_add_u32 m0, s32, 11264
    s_nop 0
    buffer_load_dwordx4 v223, s[4:7], s34 offen lds
    s_add_u32 m0, s32, 12288
    s_nop 0
    buffer_load_dwordx4 v224, s[4:7], s34 offen lds
    s_add_u32 m0, s32, 13312
    s_nop 0
    buffer_load_dwordx4 v225, s[4:7], s34 offen lds
    s_add_u32 m0, s32, 14336
    s_nop 0
    buffer_load_dwordx4 v226, s[4:7], s34 offen lds
    v_add_u32 v176, 0, v252
    v_mul_u32_u24 v177, 171, v176
    v_lshrrev_b32 v177, 11, v177
    v_mul_u32_u24 v178, 12, v177
    v_sub_u32 v178, v176, v178
    v_mul_u32_u24 v177, 0x300, v177
    v_lshrrev_b32 v176, 2, v178
    v_lshlrev_b32 v176, 8, v176
    v_and_b32 v178, 3, v178
    v_lshl_add_u32 v176, v178, 4, v176
    v_add3_u32 v0, v176, v177, s34
    v_add_u32 v176, 64, v252
    v_mul_u32_u24 v177, 171, v176
    v_lshrrev_b32 v177, 11, v177
    v_mul_u32_u24 v178, 12, v177
    v_sub_u32 v178, v176, v178
    v_mul_u32_u24 v177, 0x300, v177
    v_lshrrev_b32 v176, 2, v178
    v_lshlrev_b32 v176, 8, v176
    v_and_b32 v178, 3, v178
    v_lshl_add_u32 v176, v178, 4, v176
    v_add3_u32 v1, v176, v177, s34
    v_add_u32 v176, 128, v252
    v_mul_u32_u24 v177, 171, v176
    v_lshrrev_b32 v177, 11, v177
    v_mul_u32_u24 v178, 12, v177
    v_sub_u32 v178, v176, v178
    v_mul_u32_u24 v177, 0x300, v177
    v_lshrrev_b32 v176, 2, v178
    v_lshlrev_b32 v176, 8, v176
    v_and_b32 v178, 3, v178
    v_lshl_add_u32 v176, v178, 4, v176
    v_add3_u32 v2, v176, v177, s34
    v_add_u32 v176, 192, v252
    v_mul_u32_u24 v177, 171, v176
    v_lshrrev_b32 v177, 11, v177
    v_mul_u32_u24 v178, 12, v177
    v_sub_u32 v178, v176, v178
    v_mul_u32_u24 v177, 0x300, v177
    v_lshrrev_b32 v176, 2, v178
    v_lshlrev_b32 v176, 8, v176
    v_and_b32 v178, 3, v178
    v_lshl_add_u32 v176, v178, 4, v176
    v_add3_u32 v3, v176, v177, s34
    v_add_u32 v176, 256, v252
    v_mul_u32_u24 v177, 171, v176
    v_lshrrev_b32 v177, 11, v177
    v_mul_u32_u24 v178, 12, v177
    v_sub_u32 v178, v176, v178
    v_mul_u32_u24 v177, 0x300, v177
    v_lshrrev_b32 v176, 2, v178
    v_lshlrev_b32 v176, 8, v176
    v_and_b32 v178, 3, v178
    v_lshl_add_u32 v176, v178, 4, v176
    v_add3_u32 v126, v176, v177, s34
    v_mov_b32 v178, v252
    v_lshrrev_b32 v177, 2, v178
    v_lshlrev_b32 v177, 8, v177
    v_and_b32 v178, 3, v178
    v_lshl_add_u32 v177, v178, 4, v177
    v_add_u32 v127, s34, v177
    v_cmp_gt_u32 vcc, 12, v252
    v_mov_b32 v176, s38
    s_nop 0
    v_cndmask_b32 v127, v176, v127, vcc
    s_add_u32 m0, s46, 0
    s_nop 0
    buffer_load_dwordx4 v0, s[16:19], 0 offen lds
    s_add_u32 m0, s46, 1024
    s_nop 0
    buffer_load_dwordx4 v1, s[16:19], 0 offen lds
    s_add_u32 m0, s46, 2048
    s_nop 0
    buffer_load_dwordx4 v2, s[16:19], 0 offen lds
    s_add_u32 m0, s46, 3072
    s_nop 0
    buffer_load_dwordx4 v3, s[16:19], 0 offen lds
    s_add_u32 m0, s46, 4096
    s_nop 0
    buffer_load_dwordx4 v126, s[16:19], 0 offen lds
    s_add_u32 m0, s46, 5120
    s_nop 0
    buffer_load_dwordx4 v127, s[52:55], 0 offen lds
    s_mov_b32 s27, 0x409d30fc
    s_mov_b32 s28, 0xbeeff558
    s_mov_b32 s100, 0x44ea44ea
    s_mov_b32 s101, 0xb780b780
    s_mov_b32 s30, 0x3b2aaaab
    s_mov_b32 s31, 0x3727c5ac
    v_add_u32 v201, 49152, v200
    v_add_u32 v202, 98304, v200
    v_add_u32 v203, s24, v200
    s_mul_i32 s35, s20, 393216
    v_lshrrev_b32 v194, 2, v252
    v_mul_u32_u24 v194, 0x300, v194
    v_lshrrev_b32 v195, 5, v252
    v_lshlrev_b32 v195, 1, v195
    v_and_b32 v196, 3, v252
    v_xor_b32 v195, v195, v196
    v_lshl_add_u32 v194, v195, 4, v194
    v_add_u32 v204, s35, v194
    v_add_u32 v205, 196608, v204
    v_add_u32 v194, v160, v161
    v_bfe_u32 v195, v194, 2, 2
    v_lshlrev_b32 v195, 4, v195
    v_lshl_add_u32 v206, v194, 6, v195
    v_add_u32 v206, s32, v206
    v_add_u32 v194, 4, v160
    v_bfe_u32 v195, v194, 2, 2
    v_lshlrev_b32 v195, 4, v195
    v_lshl_add_u32 v207, v194, 6, v195
    v_mul_u32_u24 v196, 1280, v161
    v_add3_u32 v207, v207, v196, s32
    v_add_u32 v208, 5120, v207
    v_add_u32 v194, 2, v160
    v_bfe_u32 v195, v194, 2, 2
    v_lshlrev_b32 v195, 4, v195
    v_lshl_add_u32 v197, v194, 6, v195
    v_add3_u32 v197, v197, v196, s32
    v_cmp_gt_u32 vcc, 2, v161
    s_nop 1
    v_cndmask_b32 v208, v197, v208, vcc
    v_subrev_u32 v253, 61440, v206
    v_subrev_u32 v254, 61440, v207
    v_subrev_u32 v255, 61440, v208
    v_bfe_u32 v194, v252, 1, 2
    v_mul_u32_u24 v227, 0x5555, v194
    v_lshrrev_b32 v164, 1, v160
    v_and_b32 v165, 1, v160
    v_lshrrev_b32 v166, 1, v161
    v_and_b32 v167, 1, v161
    v_cmp_gt_u32 s[42:43], 4, v164
    v_lshl_add_u32 v168, v164, 1, s46
    s_add_u32 s49, s46, 5312
    v_mov_b32 v169, s49
    v_lshl_add_u32 v170, v167, 1, 0
    v_add_u32 v171, 0, v166
    v_sub_u32 v171, v171, v165
    v_mul_u32_u24 v172, 5, v171
    v_add_u32 v172, v172, v170
    v_mul_u32_u24 v172, 192, v172
    v_cmp_gt_u32 vcc, 5, v171
    v_add_u32 v172, v172, v168
    s_nop 0
    v_cndmask_b32 v228, v169, v172, vcc
    v_lshl_add_u32 v170, v167, 1, 1
    v_add_u32 v171, 0, v166
    v_sub_u32 v171, v171, v165
    v_mul_u32_u24 v172, 5, v171
    v_add_u32 v172, v172, v170
    v_mul_u32_u24 v172, 192, v172
    v_cmp_gt_u32 vcc, 5, v171
    v_add_u32 v172, v172, v168
    s_nop 0
    v_cndmask_b32 v229, v169, v172, vcc
    v_lshl_add_u32 v170, v167, 1, 0
    v_add_u32 v171, 2, v166
    v_sub_u32 v171, v171, v165
    v_mul_u32_u24 v172, 5, v171
    v_add_u32 v172, v172, v170
    v_mul_u32_u24 v172, 192, v172
    v_cmp_gt_u32 vcc, 5, v171
    v_add_u32 v172, v172, v168
    s_nop 0
    v_cndmask_b32 v230, v169, v172, vcc
    v_lshl_add_u32 v170, v167, 1, 1
    v_add_u32 v171, 2, v166
    v_sub_u32 v171, v171, v165
    v_mul_u32_u24 v172, 5, v171
    v_add_u32 v172, v172, v170
    v_mul_u32_u24 v172, 192, v172
    v_cmp_gt_u32 vcc, 5, v171
    v_add_u32 v172, v172, v168
    s_nop 0
    v_cndmask_b32 v231, v169, v172, vcc
    v_lshl_add_u32 v170, v167, 1, 0
    v_add_u32 v171, 4, v166
    v_sub_u32 v171, v171, v165
    v_mul_u32_u24 v172, 5, v171
    v_add_u32 v172, v172, v170
    v_mul_u32_u24 v172, 192, v172
    v_cmp_gt_u32 vcc, 5, v171
    v_add_u32 v172, v172, v168
    s_nop 0
    v_cndmask_b32 v232, v169, v172, vcc
    v_lshl_add_u32 v170, v167, 1, 1
    v_add_u32 v171, 4, v166
    v_sub_u32 v171, v171, v165
    v_mul_u32_u24 v172, 5, v171
    v_add_u32 v172, v172, v170
    v_mul_u32_u24 v172, 192, v172
    v_cmp_gt_u32 vcc, 5, v171
    v_add_u32 v172, v172, v168
    s_nop 0
    v_cndmask_b32 v233, v169, v172, vcc
    v_lshl_add_u32 v170, v167, 1, 0
    v_lshl_add_u32 v173, v166, 2, v170
    v_sub_u32 v171, v173, v165
    v_mul_u32_u24 v172, 5, v171
    v_add_u32 v172, 4, v172
    v_mul_u32_u24 v172, 192, v172
    v_cmp_gt_u32 vcc, 5, v171
    v_cmp_le_u32 s[50:51], 6, v173
    v_subrev_u32 v174, 6, v173
    v_cmp_eq_u32 s[70:71], v174, v165
    v_mov_b32 v174, 5120
    s_nop 1
    v_cndmask_b32 v172, v172, v174, s[50:51]
    s_andn2_b64 vcc, vcc, s[50:51]
    s_and_b64 s[70:71], s[70:71], s[50:51]
    s_or_b64 vcc, vcc, s[70:71]
    v_add_u32 v172, v172, v168
    s_nop 0
    v_cndmask_b32 v234, v169, v172, vcc
    v_lshl_add_u32 v170, v167, 1, 1
    v_lshl_add_u32 v173, v166, 2, v170
    v_sub_u32 v171, v173, v165
    v_mul_u32_u24 v172, 5, v171
    v_add_u32 v172, 4, v172
    v_mul_u32_u24 v172, 192, v172
    v_cmp_gt_u32 vcc, 5, v171
    v_cmp_le_u32 s[50:51], 6, v173
    v_subrev_u32 v174, 6, v173
    v_cmp_eq_u32 s[70:71], v174, v165
    v_mov_b32 v174, 5120
    s_nop 1
    v_cndmask_b32 v172, v172, v174, s[50:51]
    s_andn2_b64 vcc, vcc, s[50:51]
    s_and_b64 s[70:71], s[70:71], s[50:51]
    s_or_b64 vcc, vcc, s[70:71]
    v_add_u32 v172, v172, v168
    s_nop 0
    v_cndmask_b32 v235, v169, v172, vcc
    v_lshrrev_b32 v194, 2, v160
    v_cmp_eq_u32 s[50:51], v194, v161
    v_and_b32 v194, 1, v160
    v_lshlrev_b32 v194, 4, v194
    v_mov_b32 v195, 0x3f80
    v_lshlrev_b32 v195, v194, v195
    v_cndmask_b32 v195, 0, v195, s[50:51]
    v_bfe_u32 v194, v160, 1, 1
    v_cmp_eq_u32 vcc, 0, v194
    s_nop 1
    v_cndmask_b32 v196, 0, v195, vcc
    v_sub_u32 v197, v195, v196
    v_mov_b32 v194, 0
    v_accvgpr_write_b32 a240, v196
    v_accvgpr_write_b32 a241, v197
    v_accvgpr_write_b32 a242, v194
    v_accvgpr_write_b32 a243, v194
    v_accvgpr_write_b32 a244, v194
    v_accvgpr_write_b32 a245, v194
    v_accvgpr_write_b32 a246, v196
    v_accvgpr_write_b32 a247, v197
    v_accvgpr_write_b32 a248, v194
    v_accvgpr_write_b32 a249, v194
    v_accvgpr_write_b32 a250, v194
    v_accvgpr_write_b32 a251, v194
    s_waitcnt vmcnt(21)
    v_add_u32 v163, s74, v200
    v_lshl_or_b32 v128, v129, 16, v128
    v_lshl_or_b32 v129, v131, 16, v130
    v_lshl_or_b32 v130, v133, 16, v132
    v_lshl_or_b32 v131, v135, 16, v134
    buffer_store_dwordx4 v[128:131], v163, s[8:11], s95 offen sc1
    v_lshl_or_b32 v136, v137, 16, v136
    v_lshl_or_b32 v137, v139, 16, v138
    v_lshl_or_b32 v138, v141, 16, v140
    v_lshl_or_b32 v139, v143, 16, v142
    buffer_store_dwordx4 v[136:139], v163, s[8:11], s96 offen sc1
    v_lshl_or_b32 v144, v145, 16, v144
    v_lshl_or_b32 v145, v147, 16, v146
    v_lshl_or_b32 v146, v149, 16, v148
    v_lshl_or_b32 v147, v151, 16, v150
    buffer_store_dwordx4 v[144:147], v163, s[8:11], s97 offen sc1
    buffer_load_dwordx4 v[64:67], v212, s[4:7], s44 offen
    buffer_load_dwordx4 v[68:71], v213, s[4:7], s44 offen
    buffer_load_dwordx4 v[72:75], v214, s[4:7], s44 offen
    buffer_load_dwordx4 v[76:79], v215, s[4:7], s44 offen
    buffer_load_dwordx4 v[80:83], v216, s[4:7], s44 offen
    buffer_load_dwordx4 v[84:87], v217, s[4:7], s44 offen
    buffer_load_dwordx4 v[88:91], v218, s[4:7], s44 offen
    buffer_load_dwordx4 v[92:95], v219, s[4:7], s44 offen
    buffer_load_dwordx4 v[96:99], v220, s[4:7], s44 offen
    buffer_load_dwordx4 v[100:103], v221, s[4:7], s44 offen
    buffer_load_dwordx4 v[104:107], v222, s[4:7], s44 offen
    buffer_load_dwordx4 v[108:111], v223, s[4:7], s44 offen
    buffer_load_dwordx4 v[112:115], v224, s[4:7], s44 offen
    buffer_load_dwordx4 v[116:119], v225, s[4:7], s44 offen
    buffer_load_dwordx4 v[120:123], v226, s[4:7], s44 offen
    s_cmp_ge_u32 s2, 96
    s_cselect_b32 s75, 128, 0
    s_add_u32 s75, s75, s74
    s_cmp_eq_u32 s20, 0
    s_cselect_b32 s48, s75, s38
    v_cmp_eq_u32 vcc, 0, v252
    v_mov_b32 v2, s38
    v_mov_b32 v3, s48
    v_cndmask_b32 v2, v2, v3, vcc
    v_mov_b32 v3, 1
    s_mov_b32 s21, 0
    s_waitcnt vmcnt(15)
    s_waitcnt lgkmcnt(0)
L_tile:
    s_mov_b32 s22, s41
    s_add_u32 s23, s22, 394752
    s_add_u32 s39, s39, 64
    s_add_u32 s41, s41, 12582912
    s_cmp_eq_u32 s21, 0
    s_cselect_b32 s40, s40, 0x10000
    s_waitcnt lgkmcnt(0)
    s_barrier
    s_mul_i32 s35, s20, 15360
    s_add_u32 s35, s35, 36864
    s_waitcnt vmcnt(13)
    v_add_u32 v0, s35, v200
    v_add_u32 v1, s32, v200
    v_xor_b32 v209, 0, v206
    v_xor_b32 v210, 0, v207
    v_xor_b32 v211, 0, v208
    ds_read_u16 v192, v228 offset:0
    ds_read_u16 v193, v229 offset:0
    ds_read_u16 v194, v230 offset:0
    ds_read_u16 v195, v231 offset:0
    ds_read_u16 v196, v232 offset:0
    ds_read_u16 v197, v233 offset:0
    ds_read_u16 v198, v234 offset:0
    ds_read_u16 v199, v235 offset:0
    ds_read_b128 a[0:3], v209 offset:0
    ds_read_b128 a[4:7], v209 offset:1280
    ds_read_b128 a[8:11], v209 offset:2560
    ds_read_b128 a[12:15], v209 offset:3840
    ds_read_b128 a[16:19], v209 offset:5120
    ds_read_b128 a[20:23], v209 offset:6400
    ds_read_b128 a[48:51], v210 offset:0
    ds_read_b128 a[52:55], v211 offset:0
    ds_read_b128 a[24:27], v209 offset:7680
    ds_read_b128 a[28:31], v209 offset:8960
    ds_read_b128 a[56:59], v210 offset:2560
    ds_read_b128 a[60:63], v211 offset:2560
    ds_read_b128 a[32:35], v209 offset:10240
    ds_read_b128 a[36:39], v209 offset:11520
    ds_read_b128 a[64:67], v210 offset:5120
    ds_read_b128 a[68:71], v211 offset:5120
    ds_read_b128 a[40:43], v209 offset:12800
    ds_read_b128 a[44:47], v209 offset:14080
    ds_read_b128 a[72:75], v210 offset:7680
    ds_read_b128 a[76:79], v211 offset:7680
    v_mfma_f32_16x16x32_bf16 v[128:131], a[248:251], a[248:251], 0
    v_mfma_f32_16x16x32_bf16 v[132:135], a[248:251], a[248:251], 0
    v_mfma_f32_16x16x32_bf16 v[136:139], a[248:251], a[248:251], 0
    v_mfma_f32_16x16x32_bf16 v[140:143], a[248:251], a[248:251], 0
    s_waitcnt lgkmcnt(15)
    v_cndmask_b32_e64 v236, 0, v192, s[42:43]
    v_cndmask_b32_e64 v237, v192, 0, s[42:43]
    v_cndmask_b32_e64 v238, 0, v193, s[42:43]
    v_cndmask_b32_e64 v239, v193, 0, s[42:43]
    v_cndmask_b32_e64 v240, 0, v194, s[42:43]
    v_cndmask_b32_e64 v241, v194, 0, s[42:43]
    v_cndmask_b32_e64 v242, 0, v195, s[42:43]
    v_cndmask_b32_e64 v243, v195, 0, s[42:43]
    v_cndmask_b32_e64 v244, 0, v196, s[42:43]
    v_cndmask_b32_e64 v245, v196, 0, s[42:43]
    v_cndmask_b32_e64 v246, 0, v197, s[42:43]
    v_cndmask_b32_e64 v247, v197, 0, s[42:43]
    v_cndmask_b32_e64 v248, 0, v198, s[42:43]
    v_cndmask_b32_e64 v249, v198, 0, s[42:43]
    v_cndmask_b32_e64 v250, 0, v199, s[42:43]
    v_cndmask_b32_e64 v251, v199, 0, s[42:43]
    v_xor_b32 v209, 16, v206
    v_xor_b32 v210, 16, v207
    v_xor_b32 v211, 16, v208
    v_mfma_f32_16x16x32_bf16 v[144:147], a[248:251], a[248:251], 0
    ds_read_u16 v192, v228 offset:16
    ds_read_u16 v193, v229 offset:16
    v_mfma_f32_16x16x32_bf16 v[148:151], a[248:251], a[248:251], 0
    ds_read_u16 v194, v230 offset:16
    ds_read_u16 v195, v231 offset:16
    v_mfma_f32_16x16x32_bf16 v[152:155], a[248:251], a[248:251], 0
    ds_read_u16 v196, v232 offset:16
    ds_read_u16 v197, v233 offset:16
    v_mfma_f32_16x16x32_bf16 v[156:159], a[248:251], a[248:251], 0
    ds_read_u16 v198, v234 offset:16
    ds_read_u16 v199, v235 offset:16
    v_smfmac_f32_16x16x64_bf16 v[128:131], v[236:239], a[0:7], v227
    ds_read_b128 a[80:83], v209 offset:0
    ds_read_b128 a[84:87], v209 offset:1280
    v_smfmac_f32_16x16x64_bf16 v[128:131], v[240:243], a[8:15], v227
    ds_read_b128 a[88:91], v209 offset:2560
    ds_read_b128 a[92:95], v209 offset:3840
    s_waitcnt lgkmcnt(15)
    v_smfmac_f32_16x16x64_bf16 v[128:131], v[244:247], a[16:23], v227
    ds_read_b128 a[96:99], v209 offset:5120
    ds_read_b128 a[100:103], v209 offset:6400
    v_smfmac_f32_16x16x64_bf16 v[128:131], v[248:251], a[48:55], v227
    ds_read_b128 a[128:131], v210 offset:0
    ds_read_b128 a[132:135], v211 offset:0
    v_smfmac_f32_16x16x64_bf16 v[132:135], v[236:239], a[8:15], v227
    ds_read_b128 a[104:107], v209 offset:7680
    ds_read_b128 a[108:111], v209 offset:8960
    v_smfmac_f32_16x16x64_bf16 v[132:135], v[240:243], a[16:23], v227
    ds_read_b128 a[136:139], v210 offset:2560
    ds_read_b128 a[140:143], v211 offset:2560
    v_smfmac_f32_16x16x64_bf16 v[132:135], v[244:247], a[24:31], v227
    ds_read_b128 a[112:115], v209 offset:10240
    v_smfmac_f32_16x16x64_bf16 v[132:135], v[248:251], a[56:63], v227
    ds_read_b128 a[116:119], v209 offset:11520
    v_smfmac_f32_16x16x64_bf16 v[136:139], v[236:239], a[16:23], v227
    ds_read_b128 a[144:147], v210 offset:5120
    v_smfmac_f32_16x16x64_bf16 v[136:139], v[240:243], a[24:31], v227
    ds_read_b128 a[148:151], v211 offset:5120
    v_smfmac_f32_16x16x64_bf16 v[136:139], v[244:247], a[32:39], v227
    ds_read_b128 a[120:123], v209 offset:12800
    v_smfmac_f32_16x16x64_bf16 v[136:139], v[248:251], a[64:71], v227
    ds_read_b128 a[124:127], v209 offset:14080
    v_smfmac_f32_16x16x64_bf16 v[140:143], v[236:239], a[24:31], v227
    ds_read_b128 a[152:155], v210 offset:7680
    v_cndmask_b32_e64 v236, 0, v192, s[42:43]
    v_cndmask_b32_e64 v237, v192, 0, s[42:43]
    v_cndmask_b32_e64 v238, 0, v193, s[42:43]
    v_cndmask_b32_e64 v239, v193, 0, s[42:43]
    v_smfmac_f32_16x16x64_bf16 v[140:143], v[240:243], a[32:39], v227
    ds_read_b128 a[156:159], v211 offset:7680
    v_cndmask_b32_e64 v240, 0, v194, s[42:43]
    v_cndmask_b32_e64 v241, v194, 0, s[42:43]
    v_cndmask_b32_e64 v242, 0, v195, s[42:43]
    v_cndmask_b32_e64 v243, v195, 0, s[42:43]
    s_waitcnt lgkmcnt(15)
    v_smfmac_f32_16x16x64_bf16 v[140:143], v[244:247], a[40:47], v227
    s_cmp_eq_u32 s21, 0
    s_cbranch_scc0 L_x20
    buffer_load_dwordx4 v[4:7], v212, s[4:7], s45 offen
    buffer_load_dwordx4 v[8:11], v213, s[4:7], s45 offen
    buffer_load_dwordx4 v[12:15], v214, s[4:7], s45 offen
    buffer_load_dwordx4 v[16:19], v215, s[4:7], s45 offen
    buffer_load_dwordx4 v[20:23], v216, s[4:7], s45 offen
L_x20:
    v_cndmask_b32_e64 v244, 0, v196, s[42:43]
    v_cndmask_b32_e64 v245, v196, 0, s[42:43]
    v_cndmask_b32_e64 v246, 0, v197, s[42:43]
    v_cndmask_b32_e64 v247, v197, 0, s[42:43]
    v_smfmac_f32_16x16x64_bf16 v[140:143], v[248:251], a[72:79], v227
    v_cndmask_b32_e64 v248, 0, v198, s[42:43]
    v_cndmask_b32_e64 v249, v198, 0, s[42:43]
    v_cndmask_b32_e64 v250, 0, v199, s[42:43]
    v_cndmask_b32_e64 v251, v199, 0, s[42:43]
    v_xor_b32 v209, 32, v206
    v_xor_b32 v210, 32, v207
    v_xor_b32 v211, 32, v208
    v_mfma_f32_16x16x32_bf16 v[160:163], a[248:251], a[248:251], 0
    ds_read_u16 v192, v228 offset:32
    ds_read_u16 v193, v229 offset:32
    v_mfma_f32_16x16x32_bf16 v[164:167], a[248:251], a[248:251], 0
    ds_read_u16 v194, v230 offset:32
    ds_read_u16 v195, v231 offset:32
    v_mfma_f32_16x16x32_bf16 v[168:171], a[248:251], a[248:251], 0
    ds_read_u16 v196, v232 offset:32
    ds_read_u16 v197, v233 offset:32
    v_mfma_f32_16x16x32_bf16 v[172:175], a[248:251], a[248:251], 0
    ds_read_u16 v198, v234 offset:32
    ds_read_u16 v199, v235 offset:32
    v_smfmac_f32_16x16x64_bf16 v[144:147], v[236:239], a[80:87], v227
    ds_read_b128 a[0:3], v209 offset:0
    ds_read_b128 a[4:7], v209 offset:1280
    v_smfmac_f32_16x16x64_bf16 v[144:147], v[240:243], a[88:95], v227
    ds_read_b128 a[8:11], v209 offset:2560
    ds_read_b128 a[12:15], v209 offset:3840
    s_waitcnt lgkmcnt(15)
    v_smfmac_f32_16x16x64_bf16 v[144:147], v[244:247], a[96:103], v227
    ds_read_b128 a[16:19], v209 offset:5120
    ds_read_b128 a[20:23], v209 offset:6400
    v_smfmac_f32_16x16x64_bf16 v[144:147], v[248:251], a[128:135], v227
    ds_read_b128 a[48:51], v210 offset:0
    ds_read_b128 a[52:55], v211 offset:0
    v_smfmac_f32_16x16x64_bf16 v[148:151], v[236:239], a[88:95], v227
    ds_read_b128 a[24:27], v209 offset:7680
    ds_read_b128 a[28:31], v209 offset:8960
    v_smfmac_f32_16x16x64_bf16 v[148:151], v[240:243], a[96:103], v227
    ds_read_b128 a[56:59], v210 offset:2560
    ds_read_b128 a[60:63], v211 offset:2560
    v_smfmac_f32_16x16x64_bf16 v[148:151], v[244:247], a[104:111], v227
    ds_read_b128 a[32:35], v209 offset:10240
    ds_read_b128 a[36:39], v209 offset:11520
    v_smfmac_f32_16x16x64_bf16 v[148:151], v[248:251], a[136:143], v227
    ds_read_b128 a[64:67], v210 offset:5120
    ds_read_b128 a[68:71], v211 offset:5120
    v_smfmac_f32_16x16x64_bf16 v[152:155], v[236:239], a[96:103], v227
    ds_read_b128 a[40:43], v209 offset:12800
    ds_read_b128 a[44:47], v209 offset:14080
    v_smfmac_f32_16x16x64_bf16 v[152:155], v[240:243], a[104:111], v227
    ds_read_b128 a[72:75], v210 offset:7680
    ds_read_b128 a[76:79], v211 offset:7680
    v_smfmac_f32_16x16x64_bf16 v[152:155], v[244:247], a[112:119], v227
    s_cmp_eq_u32 s21, 0
    s_cbranch_scc0 L_w1
    s_waitcnt vmcnt(5)
L_w1:
    v_smfmac_f32_16x16x64_bf16 v[152:155], v[248:251], a[144:151], v227
    ds_write_b128 v0, v[64:67] offset:0
    ds_write_b128 v0, v[68:71] offset:1024
    v_smfmac_f32_16x16x64_bf16 v[156:159], v[236:239], a[104:111], v227
    ds_write_b128 v0, v[72:75] offset:2048
    ds_write_b128 v0, v[76:79] offset:3072
    v_cndmask_b32_e64 v236, 0, v192, s[42:43]
    v_cndmask_b32_e64 v237, v192, 0, s[42:43]
    v_cndmask_b32_e64 v238, 0, v193, s[42:43]
    v_cndmask_b32_e64 v239, v193, 0, s[42:43]
    v_smfmac_f32_16x16x64_bf16 v[156:159], v[240:243], a[112:119], v227
    ds_write_b128 v0, v[80:83] offset:4096
    ds_write_b128 v0, v[84:87] offset:5120
    v_cndmask_b32_e64 v240, 0, v194, s[42:43]
    v_cndmask_b32_e64 v241, v194, 0, s[42:43]
    v_cndmask_b32_e64 v242, 0, v195, s[42:43]
    v_cndmask_b32_e64 v243, v195, 0, s[42:43]
    s_waitcnt lgkmcnt(15)
    v_smfmac_f32_16x16x64_bf16 v[156:159], v[244:247], a[120:127], v227
    ds_write_b128 v0, v[88:91] offset:6144
    ds_write_b128 v0, v[92:95] offset:7168
    v_cndmask_b32_e64 v244, 0, v196, s[42:43]
    v_cndmask_b32_e64 v245, v196, 0, s[42:43]
    v_cndmask_b32_e64 v246, 0, v197, s[42:43]
    v_cndmask_b32_e64 v247, v197, 0, s[42:43]
    v_smfmac_f32_16x16x64_bf16 v[156:159], v[248:251], a[152:159], v227
    s_cmp_eq_u32 s21, 0
    s_cbranch_scc0 L_x21
    buffer_load_dwordx4 v[24:27], v217, s[4:7], s45 offen
    buffer_load_dwordx4 v[28:31], v218, s[4:7], s45 offen
    buffer_load_dwordx4 v[32:35], v219, s[4:7], s45 offen
    buffer_load_dwordx4 v[36:39], v220, s[4:7], s45 offen
    buffer_load_dwordx4 v[40:43], v221, s[4:7], s45 offen
L_x21:
    v_cndmask_b32_e64 v248, 0, v198, s[42:43]
    v_cndmask_b32_e64 v249, v198, 0, s[42:43]
    v_cndmask_b32_e64 v250, 0, v199, s[42:43]
    v_cndmask_b32_e64 v251, v199, 0, s[42:43]
    v_xor_b32 v209, 48, v206
    v_xor_b32 v210, 48, v207
    v_xor_b32 v211, 48, v208
    v_mfma_f32_16x16x32_bf16 v[176:179], a[248:251], a[248:251], 0
    ds_read_u16 v192, v228 offset:48
    ds_read_u16 v193, v229 offset:48
    v_mfma_f32_16x16x32_bf16 v[180:183], a[248:251], a[248:251], 0
    ds_read_u16 v194, v230 offset:48
    ds_read_u16 v195, v231 offset:48
    v_mfma_f32_16x16x32_bf16 v[184:187], a[248:251], a[248:251], 0
    ds_read_u16 v196, v232 offset:48
    ds_read_u16 v197, v233 offset:48
    v_mfma_f32_16x16x32_bf16 v[188:191], a[248:251], a[248:251], 0
    ds_read_u16 v198, v234 offset:48
    ds_read_u16 v199, v235 offset:48
    v_smfmac_f32_16x16x64_bf16 v[160:163], v[236:239], a[0:7], v227
    ds_read_b128 a[80:83], v209 offset:0
    ds_read_b128 a[84:87], v209 offset:1280
    v_smfmac_f32_16x16x64_bf16 v[160:163], v[240:243], a[8:15], v227
    ds_read_b128 a[88:91], v209 offset:2560
    ds_read_b128 a[92:95], v209 offset:3840
    v_smfmac_f32_16x16x64_bf16 v[160:163], v[244:247], a[16:23], v227
    ds_read_b128 a[96:99], v209 offset:5120
    ds_read_b128 a[100:103], v209 offset:6400
    v_smfmac_f32_16x16x64_bf16 v[160:163], v[248:251], a[48:55], v227
    ds_read_b128 a[128:131], v210 offset:0
    ds_read_b128 a[132:135], v211 offset:0
    v_smfmac_f32_16x16x64_bf16 v[164:167], v[236:239], a[8:15], v227
    ds_read_b128 a[104:107], v209 offset:7680
    ds_read_b128 a[108:111], v209 offset:8960
    v_smfmac_f32_16x16x64_bf16 v[164:167], v[240:243], a[16:23], v227
    ds_read_b128 a[136:139], v210 offset:2560
    ds_read_b128 a[140:143], v211 offset:2560
    v_smfmac_f32_16x16x64_bf16 v[164:167], v[244:247], a[24:31], v227
    ds_read_b128 a[112:115], v209 offset:10240
    ds_read_b128 a[116:119], v209 offset:11520
    s_waitcnt lgkmcnt(15)
    v_smfmac_f32_16x16x64_bf16 v[164:167], v[248:251], a[56:63], v227
    ds_read_b128 a[144:147], v210 offset:5120
    ds_read_b128 a[148:151], v211 offset:5120
    v_smfmac_f32_16x16x64_bf16 v[168:171], v[236:239], a[16:23], v227
    ds_read_b128 a[120:123], v209 offset:12800
    ds_read_b128 a[124:127], v209 offset:14080
    v_smfmac_f32_16x16x64_bf16 v[168:171], v[240:243], a[24:31], v227
    ds_read_b128 a[152:155], v210 offset:7680
    ds_read_b128 a[156:159], v211 offset:7680
    v_smfmac_f32_16x16x64_bf16 v[168:171], v[244:247], a[32:39], v227
    ds_write_b128 v0, v[96:99] offset:8192
    ds_write_b128 v0, v[100:103] offset:9216
    v_smfmac_f32_16x16x64_bf16 v[168:171], v[248:251], a[64:71], v227
    ds_write_b128 v0, v[104:107] offset:10240
    ds_write_b128 v0, v[108:111] offset:11264
    v_smfmac_f32_16x16x64_bf16 v[172:175], v[236:239], a[24:31], v227
    ds_write_b128 v0, v[112:115] offset:12288
    ds_write_b128 v0, v[116:119] offset:13312
    v_cndmask_b32_e64 v236, 0, v192, s[42:43]
    v_cndmask_b32_e64 v237, v192, 0, s[42:43]
    v_cndmask_b32_e64 v238, 0, v193, s[42:43]
    v_cndmask_b32_e64 v239, v193, 0, s[42:43]
    v_smfmac_f32_16x16x64_bf16 v[172:175], v[240:243], a[32:39], v227
    ds_write_b128 v0, v[120:123] offset:14336
    v_cndmask_b32_e64 v240, 0, v194, s[42:43]
    v_cndmask_b32_e64 v241, v194, 0, s[42:43]
    v_cndmask_b32_e64 v242, 0, v195, s[42:43]
    v_cndmask_b32_e64 v243, v195, 0, s[42:43]
    v_smfmac_f32_16x16x64_bf16 v[172:175], v[244:247], a[40:47], v227
    s_cmp_eq_u32 s21, 0
    s_cbranch_scc0 L_x22
    buffer_load_dwordx4 v[44:47], v222, s[4:7], s45 offen
    buffer_load_dwordx4 v[48:51], v223, s[4:7], s45 offen
    buffer_load_dwordx4 v[52:55], v224, s[4:7], s45 offen
    buffer_load_dwordx4 v[56:59], v225, s[4:7], s45 offen
    buffer_load_dwordx4 v[60:63], v226, s[4:7], s45 offen
L_x22:
    v_cndmask_b32_e64 v244, 0, v196, s[42:43]
    v_cndmask_b32_e64 v245, v196, 0, s[42:43]
    v_cndmask_b32_e64 v246, 0, v197, s[42:43]
    v_cndmask_b32_e64 v247, v197, 0, s[42:43]
    v_smfmac_f32_16x16x64_bf16 v[172:175], v[248:251], a[72:79], v227
    s_waitcnt lgkmcnt(15)
    v_cndmask_b32_e64 v248, 0, v198, s[42:43]
    v_cndmask_b32_e64 v249, v198, 0, s[42:43]
    v_cndmask_b32_e64 v250, 0, v199, s[42:43]
    v_cndmask_b32_e64 v251, v199, 0, s[42:43]
    v_xor_b32 v209, 0, v253
    v_xor_b32 v210, 0, v254
    v_xor_b32 v211, 0, v255
    v_mfma_f32_16x16x32_bf16 v[64:67], a[248:251], a[248:251], 0
    s_waitcnt lgkmcnt(0)
    ds_read_u16 v192, v228 offset:64
    v_mfma_f32_16x16x32_bf16 v[68:71], a[248:251], a[248:251], 0
    ds_read_u16 v193, v229 offset:64
    ds_read_u16 v194, v230 offset:64
    v_mfma_f32_16x16x32_bf16 v[72:75], a[248:251], a[248:251], 0
    ds_read_u16 v195, v231 offset:64
    ds_read_u16 v196, v232 offset:64
    v_mfma_f32_16x16x32_bf16 v[76:79], a[248:251], a[248:251], 0
    ds_read_u16 v197, v233 offset:64
    ds_read_u16 v198, v234 offset:64
    v_smfmac_f32_16x16x64_bf16 v[176:179], v[236:239], a[80:87], v227
    ds_read_u16 v199, v235 offset:64
    ds_read_b128 a[0:3], v209 offset:0
    v_smfmac_f32_16x16x64_bf16 v[176:179], v[240:243], a[88:95], v227
    ds_read_b128 a[4:7], v209 offset:1280
    ds_read_b128 a[8:11], v209 offset:2560
    v_smfmac_f32_16x16x64_bf16 v[176:179], v[244:247], a[96:103], v227
    ds_read_b128 a[12:15], v209 offset:3840
    ds_read_b128 a[16:19], v209 offset:5120
    v_smfmac_f32_16x16x64_bf16 v[176:179], v[248:251], a[128:135], v227
    ds_read_b128 a[20:23], v209 offset:6400
    ds_read_b128 a[48:51], v210 offset:0
    v_smfmac_f32_16x16x64_bf16 v[180:183], v[236:239], a[88:95], v227
    ds_read_b128 a[52:55], v211 offset:0
    ds_read_b128 a[24:27], v209 offset:7680
    v_smfmac_f32_16x16x64_bf16 v[180:183], v[240:243], a[96:103], v227
    ds_read_b128 a[28:31], v209 offset:8960
    ds_read_b128 a[56:59], v210 offset:2560
    v_smfmac_f32_16x16x64_bf16 v[180:183], v[244:247], a[104:111], v227
    ds_read_b128 a[60:63], v211 offset:2560
    ds_read_b128 a[32:35], v209 offset:10240
    v_smfmac_f32_16x16x64_bf16 v[180:183], v[248:251], a[136:143], v227
    ds_read_b128 a[36:39], v209 offset:11520
    v_smfmac_f32_16x16x64_bf16 v[184:187], v[236:239], a[96:103], v227
    ds_read_b128 a[64:67], v210 offset:5120
    v_smfmac_f32_16x16x64_bf16 v[184:187], v[240:243], a[104:111], v227
    ds_read_b128 a[68:71], v211 offset:5120
    v_smfmac_f32_16x16x64_bf16 v[184:187], v[244:247], a[112:119], v227
    ds_read_b128 a[40:43], v209 offset:12800
    v_smfmac_f32_16x16x64_bf16 v[184:187], v[248:251], a[144:151], v227
    ds_read_b128 a[44:47], v209 offset:14080
    v_smfmac_f32_16x16x64_bf16 v[188:191], v[236:239], a[104:111], v227
    ds_read_b128 a[72:75], v210 offset:7680
    v_cndmask_b32_e64 v236, 0, v192, s[42:43]
    v_cndmask_b32_e64 v237, v192, 0, s[42:43]
    v_cndmask_b32_e64 v238, 0, v193, s[42:43]
    v_cndmask_b32_e64 v239, v193, 0, s[42:43]
    v_smfmac_f32_16x16x64_bf16 v[188:191], v[240:243], a[112:119], v227
    ds_read_b128 a[76:79], v211 offset:7680
    v_cndmask_b32_e64 v240, 0, v194, s[42:43]
    v_cndmask_b32_e64 v241, v194, 0, s[42:43]
    v_cndmask_b32_e64 v242, 0, v195, s[42:43]
    v_cndmask_b32_e64 v243, v195, 0, s[42:43]
    v_smfmac_f32_16x16x64_bf16 v[188:191], v[244:247], a[120:127], v227
    s_cmp_eq_u32 s21, 0
    s_cbranch_scc0 L_nosig
    buffer_atomic_add v3, v2, s[56:59], 0 offen sc1
L_nosig:
    v_cndmask_b32_e64 v244, 0, v196, s[42:43]
    v_cndmask_b32_e64 v245, v196, 0, s[42:43]
    v_cndmask_b32_e64 v246, 0, v197, s[42:43]
    v_cndmask_b32_e64 v247, v197, 0, s[42:43]
    v_smfmac_f32_16x16x64_bf16 v[188:191], v[248:251], a[152:159], v227
    s_waitcnt lgkmcnt(15)
    v_cndmask_b32_e64 v248, 0, v198, s[42:43]
    v_cndmask_b32_e64 v249, v198, 0, s[42:43]
    v_cndmask_b32_e64 v250, 0, v199, s[42:43]
    v_cndmask_b32_e64 v251, v199, 0, s[42:43]
    v_xor_b32 v209, 16, v253
    v_xor_b32 v210, 16, v254
    v_xor_b32 v211, 16, v255
    v_mfma_f32_16x16x32_bf16 v[80:83], a[248:251], a[248:251], 0
    ds_read_u16 v192, v228 offset:80
    ds_read_u16 v193, v229 offset:80
    v_mfma_f32_16x16x32_bf16 v[84:87], a[248:251], a[248:251], 0
    ds_read_u16 v194, v230 offset:80
    ds_read_u16 v195, v231 offset:80
    v_mfma_f32_16x16x32_bf16 v[88:91], a[248:251], a[248:251], 0
    ds_read_u16 v196, v232 offset:80
    ds_read_u16 v197, v233 offset:80
    v_mfma_f32_16x16x32_bf16 v[92:95], a[248:251], a[248:251], 0
    ds_read_u16 v198, v234 offset:80
    ds_read_u16 v199, v235 offset:80
    v_smfmac_f32_16x16x64_bf16 v[64:67], v[236:239], a[0:7], v227
    ds_read_b128 a[80:83], v209 offset:0
    ds_read_b128 a[84:87], v209 offset:1280
    v_smfmac_f32_16x16x64_bf16 v[64:67], v[240:243], a[8:15], v227
    ds_read_b128 a[88:91], v209 offset:2560
    ds_read_b128 a[92:95], v209 offset:3840
    s_waitcnt lgkmcnt(15)
    v_smfmac_f32_16x16x64_bf16 v[64:67], v[244:247], a[16:23], v227
    ds_read_b128 a[96:99], v209 offset:5120
    ds_read_b128 a[100:103], v209 offset:6400
    v_smfmac_f32_16x16x64_bf16 v[64:67], v[248:251], a[48:55], v227
    ds_read_b128 a[128:131], v210 offset:0
    ds_read_b128 a[132:135], v211 offset:0
    v_smfmac_f32_16x16x64_bf16 v[68:71], v[236:239], a[8:15], v227
    ds_read_b128 a[104:107], v209 offset:7680
    ds_read_b128 a[108:111], v209 offset:8960
    v_smfmac_f32_16x16x64_bf16 v[68:71], v[240:243], a[16:23], v227
    ds_read_b128 a[136:139], v210 offset:2560
    ds_read_b128 a[140:143], v211 offset:2560
    v_smfmac_f32_16x16x64_bf16 v[68:71], v[244:247], a[24:31], v227
    ds_read_b128 a[112:115], v209 offset:10240
    ds_read_b128 a[116:119], v209 offset:11520
    v_smfmac_f32_16x16x64_bf16 v[68:71], v[248:251], a[56:63], v227
    ds_read_b128 a[144:147], v210 offset:5120
    ds_read_b128 a[148:151], v211 offset:5120
    v_smfmac_f32_16x16x64_bf16 v[72:75], v[236:239], a[16:23], v227
    ds_read_b128 a[120:123], v209 offset:12800
    ds_read_b128 a[124:127], v209 offset:14080
    v_smfmac_f32_16x16x64_bf16 v[72:75], v[240:243], a[24:31], v227
    ds_read_b128 a[152:155], v210 offset:7680
    ds_read_b128 a[156:159], v211 offset:7680
    v_smfmac_f32_16x16x64_bf16 v[72:75], v[244:247], a[32:39], v227
    s_cmp_eq_u32 s21, 0
    s_cbranch_scc0 L_w2
    s_waitcnt vmcnt(1)
L_w2:
    v_smfmac_f32_16x16x64_bf16 v[72:75], v[248:251], a[64:71], v227
    ds_write_b128 v1, v[4:7] offset:0
    ds_write_b128 v1, v[8:11] offset:1024
    v_smfmac_f32_16x16x64_bf16 v[76:79], v[236:239], a[24:31], v227
    ds_write_b128 v1, v[12:15] offset:2048
    ds_write_b128 v1, v[16:19] offset:3072
    v_cndmask_b32_e64 v236, 0, v192, s[42:43]
    v_cndmask_b32_e64 v237, v192, 0, s[42:43]
    v_cndmask_b32_e64 v238, 0, v193, s[42:43]
    v_cndmask_b32_e64 v239, v193, 0, s[42:43]
    v_smfmac_f32_16x16x64_bf16 v[76:79], v[240:243], a[32:39], v227
    ds_write_b128 v1, v[20:23] offset:4096
    ds_write_b128 v1, v[24:27] offset:5120
    v_cndmask_b32_e64 v240, 0, v194, s[42:43]
    v_cndmask_b32_e64 v241, v194, 0, s[42:43]
    v_cndmask_b32_e64 v242, 0, v195, s[42:43]
    v_cndmask_b32_e64 v243, v195, 0, s[42:43]
    s_waitcnt lgkmcnt(15)
    v_smfmac_f32_16x16x64_bf16 v[76:79], v[244:247], a[40:47], v227
    ds_write_b128 v1, v[28:31] offset:6144
    ds_write_b128 v1, v[32:35] offset:7168
    v_cndmask_b32_e64 v244, 0, v196, s[42:43]
    v_cndmask_b32_e64 v245, v196, 0, s[42:43]
    v_cndmask_b32_e64 v246, 0, v197, s[42:43]
    v_cndmask_b32_e64 v247, v197, 0, s[42:43]
    v_smfmac_f32_16x16x64_bf16 v[76:79], v[248:251], a[72:79], v227
    v_cndmask_b32_e64 v248, 0, v198, s[42:43]
    v_cndmask_b32_e64 v249, v198, 0, s[42:43]
    v_cndmask_b32_e64 v250, 0, v199, s[42:43]
    v_cndmask_b32_e64 v251, v199, 0, s[42:43]
    v_xor_b32 v209, 32, v253
    v_xor_b32 v210, 32, v254
    v_xor_b32 v211, 32, v255
    v_mfma_f32_16x16x32_bf16 v[96:99], a[248:251], a[248:251], 0
    ds_read_u16 v192, v228 offset:96
    ds_read_u16 v193, v229 offset:96
    v_mfma_f32_16x16x32_bf16 v[100:103], a[248:251], a[248:251], 0
    ds_read_u16 v194, v230 offset:96
    ds_read_u16 v195, v231 offset:96
    v_mfma_f32_16x16x32_bf16 v[104:107], a[248:251], a[248:251], 0
    ds_read_u16 v196, v232 offset:96
    ds_read_u16 v197, v233 offset:96
    v_mfma_f32_16x16x32_bf16 v[108:111], a[248:251], a[248:251], 0
    ds_read_u16 v198, v234 offset:96
    ds_read_u16 v199, v235 offset:96
    v_smfmac_f32_16x16x64_bf16 v[80:83], v[236:239], a[80:87], v227
    ds_read_b128 a[0:3], v209 offset:0
    ds_read_b128 a[4:7], v209 offset:1280
    v_smfmac_f32_16x16x64_bf16 v[80:83], v[240:243], a[88:95], v227
    ds_read_b128 a[8:11], v209 offset:2560
    ds_read_b128 a[12:15], v209 offset:3840
    v_smfmac_f32_16x16x64_bf16 v[80:83], v[244:247], a[96:103], v227
    ds_read_b128 a[16:19], v209 offset:5120
    ds_read_b128 a[20:23], v209 offset:6400
    v_smfmac_f32_16x16x64_bf16 v[80:83], v[248:251], a[128:135], v227
    ds_read_b128 a[48:51], v210 offset:0
    ds_read_b128 a[52:55], v211 offset:0
    v_smfmac_f32_16x16x64_bf16 v[84:87], v[236:239], a[88:95], v227
    ds_read_b128 a[24:27], v209 offset:7680
    ds_read_b128 a[28:31], v209 offset:8960
    v_smfmac_f32_16x16x64_bf16 v[84:87], v[240:243], a[96:103], v227
    ds_read_b128 a[56:59], v210 offset:2560
    ds_read_b128 a[60:63], v211 offset:2560
    v_smfmac_f32_16x16x64_bf16 v[84:87], v[244:247], a[104:111], v227
    ds_read_b128 a[32:35], v209 offset:10240
    ds_read_b128 a[36:39], v209 offset:11520
    s_waitcnt lgkmcnt(15)
    v_smfmac_f32_16x16x64_bf16 v[84:87], v[248:251], a[136:143], v227
    ds_read_b128 a[64:67], v210 offset:5120
    ds_read_b128 a[68:71], v211 offset:5120
    v_smfmac_f32_16x16x64_bf16 v[88:91], v[236:239], a[96:103], v227
    ds_read_b128 a[40:43], v209 offset:12800
    ds_read_b128 a[44:47], v209 offset:14080
    v_smfmac_f32_16x16x64_bf16 v[88:91], v[240:243], a[104:111], v227
    ds_read_b128 a[72:75], v210 offset:7680
    ds_read_b128 a[76:79], v211 offset:7680
    v_smfmac_f32_16x16x64_bf16 v[88:91], v[244:247], a[112:119], v227
    ds_write_b128 v1, v[36:39] offset:8192
    ds_write_b128 v1, v[40:43] offset:9216
    v_smfmac_f32_16x16x64_bf16 v[88:91], v[248:251], a[144:151], v227
    ds_write_b128 v1, v[44:47] offset:10240
    ds_write_b128 v1, v[48:51] offset:11264
    v_smfmac_f32_16x16x64_bf16 v[92:95], v[236:239], a[104:111], v227
    ds_write_b128 v1, v[52:55] offset:12288
    v_cndmask_b32_e64 v236, 0, v192, s[42:43]
    v_cndmask_b32_e64 v237, v192, 0, s[42:43]
    v_cndmask_b32_e64 v238, 0, v193, s[42:43]
    v_cndmask_b32_e64 v239, v193, 0, s[42:43]
    v_smfmac_f32_16x16x64_bf16 v[92:95], v[240:243], a[112:119], v227
    ds_write_b128 v1, v[56:59] offset:13312
    v_cndmask_b32_e64 v240, 0, v194, s[42:43]
    v_cndmask_b32_e64 v241, v194, 0, s[42:43]
    v_cndmask_b32_e64 v242, 0, v195, s[42:43]
    v_cndmask_b32_e64 v243, v195, 0, s[42:43]
    v_smfmac_f32_16x16x64_bf16 v[92:95], v[244:247], a[120:127], v227
    ds_write_b128 v1, v[60:63] offset:14336
    v_cndmask_b32_e64 v244, 0, v196, s[42:43]
    v_cndmask_b32_e64 v245, v196, 0, s[42:43]
    v_cndmask_b32_e64 v246, 0, v197, s[42:43]
    v_cndmask_b32_e64 v247, v197, 0, s[42:43]
    v_smfmac_f32_16x16x64_bf16 v[92:95], v[248:251], a[152:159], v227
    s_waitcnt lgkmcnt(15)
    v_cndmask_b32_e64 v248, 0, v198, s[42:43]
    v_cndmask_b32_e64 v249, v198, 0, s[42:43]
    v_cndmask_b32_e64 v250, 0, v199, s[42:43]
    v_cndmask_b32_e64 v251, v199, 0, s[42:43]
    v_xor_b32 v209, 48, v253
    v_xor_b32 v210, 48, v254
    v_xor_b32 v211, 48, v255
    v_mfma_f32_16x16x32_bf16 v[112:115], a[248:251], a[248:251], 0
    ds_read_u16 v192, v228 offset:112
    ds_read_u16 v193, v229 offset:112
    v_mov_b32 v53, s38
    v_lshrrev_b32 v48, 2, v252
    v_add_u32 v48, 0, v48
    v_mfma_f32_16x16x32_bf16 v[116:119], a[248:251], a[248:251], 0
    ds_read_u16 v194, v230 offset:112
    ds_read_u16 v195, v231 offset:112
    v_mul_u32_u24 v49, s37, v48
    v_lshrrev_b32 v49, 12, v49
    v_mul_u32_u24 v50, 20, v49
    v_mfma_f32_16x16x32_bf16 v[120:123], a[248:251], a[248:251], 0
    ds_read_u16 v196, v232 offset:112
    ds_read_u16 v197, v233 offset:112
    v_sub_u32 v48, v48, v50
    v_bfe_u32 v50, v48, 2, 2
    v_and_b32 v51, 3, v252
    v_mfma_f32_16x16x32_bf16 v[124:127], a[248:251], a[248:251], 0
    ds_read_u16 v198, v234 offset:112
    ds_read_u16 v199, v235 offset:112
    v_xor_b32 v50, v50, v51
    v_lshlrev_b32 v50, 4, v50
    v_lshl_add_u32 v51, v49, 8, v48
    v_smfmac_f32_16x16x64_bf16 v[96:99], v[236:239], a[0:7], v227
    ds_read_b128 a[80:83], v209 offset:0
    ds_read_b128 a[84:87], v209 offset:1280
    v_mul_u32_u24 v51, 0x300, v51
    v_add3_u32 v51, v51, v50, s41
    v_add_u32 v48, s40, v48
    v_smfmac_f32_16x16x64_bf16 v[96:99], v[240:243], a[8:15], v227
    ds_read_b128 a[88:91], v209 offset:2560
    ds_read_b128 a[92:95], v209 offset:3840
    v_subrev_u32 v48, 2, v48
    v_add_u32 v49, s39, v49
    v_subrev_u32 v49, 2, v49
    v_smfmac_f32_16x16x64_bf16 v[96:99], v[244:247], a[16:23], v227
    ds_read_b128 a[96:99], v209 offset:5120
    ds_read_b128 a[100:103], v209 offset:6400
    v_add_u32 v50, 0, v49
    v_or_b32 v50, v50, v48
    v_cmp_gt_u32 vcc, 0x100, v50
    v_smfmac_f32_16x16x64_bf16 v[96:99], v[248:251], a[48:55], v227
    ds_read_b128 a[128:131], v210 offset:0
    ds_read_b128 a[132:135], v211 offset:0
    v_add_u32 v52, 0, v51
    s_nop 0
    v_cndmask_b32 v212, v53, v52, vcc
    v_smfmac_f32_16x16x64_bf16 v[100:103], v[236:239], a[8:15], v227
    ds_read_b128 a[104:107], v209 offset:7680
    ds_read_b128 a[108:111], v209 offset:8960
    v_add_u32 v50, 4, v49
    v_or_b32 v50, v50, v48
    v_cmp_gt_u32 vcc, 0x100, v50
    v_smfmac_f32_16x16x64_bf16 v[100:103], v[240:243], a[16:23], v227
    ds_read_b128 a[136:139], v210 offset:2560
    v_add_u32 v52, 786432, v51
    s_nop 0
    v_cndmask_b32 v217, v53, v52, vcc
    v_smfmac_f32_16x16x64_bf16 v[100:103], v[244:247], a[24:31], v227
    ds_read_b128 a[140:143], v211 offset:2560
    v_add_u32 v50, 8, v49
    v_or_b32 v50, v50, v48
    v_cmp_gt_u32 vcc, 0x100, v50
    v_smfmac_f32_16x16x64_bf16 v[100:103], v[248:251], a[56:63], v227
    ds_read_b128 a[112:115], v209 offset:10240
    v_add_u32 v52, 1572864, v51
    s_nop 0
    v_cndmask_b32 v222, v53, v52, vcc
    v_smfmac_f32_16x16x64_bf16 v[104:107], v[236:239], a[16:23], v227
    ds_read_b128 a[116:119], v209 offset:11520
    v_lshrrev_b32 v48, 2, v252
    v_add_u32 v48, 16, v48
    v_mul_u32_u24 v49, s37, v48
    v_smfmac_f32_16x16x64_bf16 v[104:107], v[240:243], a[24:31], v227
    ds_read_b128 a[144:147], v210 offset:5120
    v_lshrrev_b32 v49, 12, v49
    v_mul_u32_u24 v50, 20, v49
    v_sub_u32 v48, v48, v50
    s_waitcnt lgkmcnt(15)
    v_smfmac_f32_16x16x64_bf16 v[104:107], v[244:247], a[32:39], v227
    ds_read_b128 a[148:151], v211 offset:5120
    v_bfe_u32 v50, v48, 2, 2
    v_and_b32 v51, 3, v252
    v_smfmac_f32_16x16x64_bf16 v[104:107], v[248:251], a[64:71], v227
    ds_read_b128 a[120:123], v209 offset:12800
    v_smfmac_f32_16x16x64_bf16 v[108:111], v[236:239], a[24:31], v227
    ds_read_b128 a[124:127], v209 offset:14080
    v_cndmask_b32_e64 v236, 0, v192, s[42:43]
    v_cndmask_b32_e64 v237, v192, 0, s[42:43]
    v_cndmask_b32_e64 v238, 0, v193, s[42:43]
    v_cndmask_b32_e64 v239, v193, 0, s[42:43]
    v_smfmac_f32_16x16x64_bf16 v[108:111], v[240:243], a[32:39], v227
    ds_read_b128 a[152:155], v210 offset:7680
    v_cndmask_b32_e64 v240, 0, v194, s[42:43]
    v_cndmask_b32_e64 v241, v194, 0, s[42:43]
    v_cndmask_b32_e64 v242, 0, v195, s[42:43]
    v_cndmask_b32_e64 v243, v195, 0, s[42:43]
    v_smfmac_f32_16x16x64_bf16 v[108:111], v[244:247], a[40:47], v227
    ds_read_b128 a[156:159], v211 offset:7680
    v_cndmask_b32_e64 v244, 0, v196, s[42:43]
    v_cndmask_b32_e64 v245, v196, 0, s[42:43]
    v_cndmask_b32_e64 v246, 0, v197, s[42:43]
    v_cndmask_b32_e64 v247, v197, 0, s[42:43]
    v_smfmac_f32_16x16x64_bf16 v[108:111], v[248:251], a[72:79], v227
    v_cndmask_b32_e64 v248, 0, v198, s[42:43]
    v_cndmask_b32_e64 v249, v198, 0, s[42:43]
    v_cndmask_b32_e64 v250, 0, v199, s[42:43]
    v_cndmask_b32_e64 v251, v199, 0, s[42:43]
    v_xor_b32 v209, 0, v206
    v_xor_b32 v210, 0, v207
    v_xor_b32 v211, 0, v208
    v_mfma_f32_16x16x32_bf16 v[0:3], a[248:251], a[248:251], 0
    ds_read_u16 v192, v228 offset:128
    v_xor_b32 v50, v50, v51
    v_lshlrev_b32 v50, 4, v50
    v_lshl_add_u32 v51, v49, 8, v48
    v_mfma_f32_16x16x32_bf16 v[4:7], a[248:251], a[248:251], 0
    ds_read_u16 v193, v229 offset:128
    ds_read_u16 v194, v230 offset:128
    v_mul_u32_u24 v51, 0x300, v51
    v_add3_u32 v51, v51, v50, s41
    v_add_u32 v48, s40, v48
    v_mfma_f32_16x16x32_bf16 v[8:11], a[248:251], a[248:251], 0
    ds_read_u16 v195, v231 offset:128
    ds_read_u16 v196, v232 offset:128
    v_subrev_u32 v48, 2, v48
    v_add_u32 v49, s39, v49
    v_subrev_u32 v49, 2, v49
    v_mfma_f32_16x16x32_bf16 v[12:15], a[248:251], a[248:251], 0
    ds_read_u16 v197, v233 offset:128
    ds_read_u16 v198, v234 offset:128
    v_add_u32 v50, 0, v49
    v_or_b32 v50, v50, v48
    v_cmp_gt_u32 vcc, 0x100, v50
    s_waitcnt lgkmcnt(15)
    v_smfmac_f32_16x16x64_bf16 v[112:115], v[236:239], a[80:87], v227
    ds_read_u16 v199, v235 offset:128
    ds_read_b128 a[0:3], v209 offset:0
    v_add_u32 v52, 0, v51
    s_nop 0
    v_cndmask_b32 v213, v53, v52, vcc
    v_smfmac_f32_16x16x64_bf16 v[112:115], v[240:243], a[88:95], v227
    ds_read_b128 a[4:7], v209 offset:1280
    ds_read_b128 a[8:11], v209 offset:2560
    v_add_u32 v50, 4, v49
    v_or_b32 v50, v50, v48
    v_cmp_gt_u32 vcc, 0x100, v50
    v_smfmac_f32_16x16x64_bf16 v[112:115], v[244:247], a[96:103], v227
    ds_read_b128 a[12:15], v209 offset:3840
    ds_read_b128 a[16:19], v209 offset:5120
    v_add_u32 v52, 786432, v51
    s_nop 0
    v_cndmask_b32 v218, v53, v52, vcc
    v_smfmac_f32_16x16x64_bf16 v[112:115], v[248:251], a[128:135], v227
    ds_read_b128 a[20:23], v209 offset:6400
    ds_read_b128 a[48:51], v210 offset:0
    v_add_u32 v50, 8, v49
    v_or_b32 v50, v50, v48
    v_cmp_gt_u32 vcc, 0x100, v50
    v_smfmac_f32_16x16x64_bf16 v[116:119], v[236:239], a[88:95], v227
    ds_read_b128 a[52:55], v211 offset:0
    ds_read_b128 a[24:27], v209 offset:7680
    v_add_u32 v52, 1572864, v51
    s_nop 0
    v_cndmask_b32 v223, v53, v52, vcc
    v_smfmac_f32_16x16x64_bf16 v[116:119], v[240:243], a[96:103], v227
    ds_read_b128 a[28:31], v209 offset:8960
    ds_read_b128 a[56:59], v210 offset:2560
    v_lshrrev_b32 v48, 2, v252
    v_add_u32 v48, 32, v48
    v_mul_u32_u24 v49, s37, v48
    v_smfmac_f32_16x16x64_bf16 v[116:119], v[244:247], a[104:111], v227
    ds_read_b128 a[60:63], v211 offset:2560
    v_lshrrev_b32 v49, 12, v49
    v_mul_u32_u24 v50, 20, v49
    v_sub_u32 v48, v48, v50
    v_smfmac_f32_16x16x64_bf16 v[116:119], v[248:251], a[136:143], v227
    ds_read_b128 a[32:35], v209 offset:10240
    v_bfe_u32 v50, v48, 2, 2
    v_and_b32 v51, 3, v252
    v_xor_b32 v50, v50, v51
    v_smfmac_f32_16x16x64_bf16 v[120:123], v[236:239], a[96:103], v227
    ds_read_b128 a[36:39], v209 offset:11520
    v_lshlrev_b32 v50, 4, v50
    v_lshl_add_u32 v51, v49, 8, v48
    v_mul_u32_u24 v51, 0x300, v51
    v_smfmac_f32_16x16x64_bf16 v[120:123], v[240:243], a[104:111], v227
    ds_read_b128 a[64:67], v210 offset:5120
    v_add3_u32 v51, v51, v50, s41
    v_add_u32 v48, s40, v48
    v_subrev_u32 v48, 2, v48
    s_waitcnt lgkmcnt(15)
    v_smfmac_f32_16x16x64_bf16 v[120:123], v[244:247], a[112:119], v227
    ds_read_b128 a[68:71], v211 offset:5120
    v_add_u32 v49, s39, v49
    v_subrev_u32 v49, 2, v49
    v_smfmac_f32_16x16x64_bf16 v[120:123], v[248:251], a[144:151], v227
    ds_read_b128 a[40:43], v209 offset:12800
    v_smfmac_f32_16x16x64_bf16 v[124:127], v[236:239], a[104:111], v227
    ds_read_b128 a[44:47], v209 offset:14080
    v_cndmask_b32_e64 v236, 0, v192, s[42:43]
    v_cndmask_b32_e64 v237, v192, 0, s[42:43]
    v_cndmask_b32_e64 v238, 0, v193, s[42:43]
    v_cndmask_b32_e64 v239, v193, 0, s[42:43]
    v_smfmac_f32_16x16x64_bf16 v[124:127], v[240:243], a[112:119], v227
    ds_read_b128 a[72:75], v210 offset:7680
    v_cndmask_b32_e64 v240, 0, v194, s[42:43]
    v_cndmask_b32_e64 v241, v194, 0, s[42:43]
    v_cndmask_b32_e64 v242, 0, v195, s[42:43]
    v_cndmask_b32_e64 v243, v195, 0, s[42:43]
    v_smfmac_f32_16x16x64_bf16 v[124:127], v[244:247], a[120:127], v227
    ds_read_b128 a[76:79], v211 offset:7680
    v_cndmask_b32_e64 v244, 0, v196, s[42:43]
    v_cndmask_b32_e64 v245, v196, 0, s[42:43]
    v_cndmask_b32_e64 v246, 0, v197, s[42:43]
    v_cndmask_b32_e64 v247, v197, 0, s[42:43]
    v_smfmac_f32_16x16x64_bf16 v[124:127], v[248:251], a[152:159], v227
    v_cndmask_b32_e64 v248, 0, v198, s[42:43]
    v_cndmask_b32_e64 v249, v198, 0, s[42:43]
    v_cndmask_b32_e64 v250, 0, v199, s[42:43]
    v_cndmask_b32_e64 v251, v199, 0, s[42:43]
    v_xor_b32 v209, 16, v206
    v_xor_b32 v210, 16, v207
    v_xor_b32 v211, 16, v208
    v_mfma_f32_16x16x32_bf16 v[16:19], a[248:251], a[248:251], 0
    ds_read_u16 v192, v228 offset:144
    ds_read_u16 v193, v229 offset:144
    v_add_u32 v50, 0, v49
    v_or_b32 v50, v50, v48
    v_cmp_gt_u32 vcc, 0x100, v50
    v_mfma_f32_16x16x32_bf16 v[20:23], a[248:251], a[248:251], 0
    ds_read_u16 v194, v230 offset:144
    ds_read_u16 v195, v231 offset:144
    v_add_u32 v52, 0, v51
    s_nop 0
    v_cndmask_b32 v214, v53, v52, vcc
    v_mfma_f32_16x16x32_bf16 v[24:27], a[248:251], a[248:251], 0
    ds_read_u16 v196, v232 offset:144
    ds_read_u16 v197, v233 offset:144
    v_add_u32 v50, 4, v49
    v_or_b32 v50, v50, v48
    v_cmp_gt_u32 vcc, 0x100, v50
    v_mfma_f32_16x16x32_bf16 v[28:31], a[248:251], a[248:251], 0
    ds_read_u16 v198, v234 offset:144
    ds_read_u16 v199, v235 offset:144
    v_add_u32 v52, 786432, v51
    s_nop 0
    v_cndmask_b32 v219, v53, v52, vcc
    s_waitcnt lgkmcnt(15)
    v_smfmac_f32_16x16x64_bf16 v[0:3], v[236:239], a[0:7], v227
    ds_read_b128 a[80:83], v209 offset:0
    ds_read_b128 a[84:87], v209 offset:1280
    v_add_u32 v50, 8, v49
    v_or_b32 v50, v50, v48
    v_cmp_gt_u32 vcc, 0x100, v50
    v_smfmac_f32_16x16x64_bf16 v[0:3], v[240:243], a[8:15], v227
    ds_read_b128 a[88:91], v209 offset:2560
    ds_read_b128 a[92:95], v209 offset:3840
    v_add_u32 v52, 1572864, v51
    s_nop 0
    v_cndmask_b32 v224, v53, v52, vcc
    v_smfmac_f32_16x16x64_bf16 v[0:3], v[244:247], a[16:23], v227
    ds_read_b128 a[96:99], v209 offset:5120
    ds_read_b128 a[100:103], v209 offset:6400
    v_lshrrev_b32 v48, 2, v252
    v_add_u32 v48, 48, v48
    v_mul_u32_u24 v49, s37, v48
    v_smfmac_f32_16x16x64_bf16 v[0:3], v[248:251], a[48:55], v227
    ds_read_b128 a[128:131], v210 offset:0
    ds_read_b128 a[132:135], v211 offset:0
    v_lshrrev_b32 v49, 12, v49
    v_mul_u32_u24 v50, 20, v49
    v_sub_u32 v48, v48, v50
    v_smfmac_f32_16x16x64_bf16 v[4:7], v[236:239], a[8:15], v227
    ds_read_b128 a[104:107], v209 offset:7680
    ds_read_b128 a[108:111], v209 offset:8960
    v_bfe_u32 v50, v48, 2, 2
    v_and_b32 v51, 3, v252
    v_xor_b32 v50, v50, v51
    v_smfmac_f32_16x16x64_bf16 v[4:7], v[240:243], a[16:23], v227
    ds_read_b128 a[136:139], v210 offset:2560
    v_lshlrev_b32 v50, 4, v50
    v_lshl_add_u32 v51, v49, 8, v48
    v_mul_u32_u24 v51, 0x300, v51
    v_smfmac_f32_16x16x64_bf16 v[4:7], v[244:247], a[24:31], v227
    ds_read_b128 a[140:143], v211 offset:2560
    v_add3_u32 v51, v51, v50, s41
    v_add_u32 v48, s40, v48
    v_subrev_u32 v48, 2, v48
    v_smfmac_f32_16x16x64_bf16 v[4:7], v[248:251], a[56:63], v227
    ds_read_b128 a[112:115], v209 offset:10240
    v_add_u32 v49, s39, v49
    v_subrev_u32 v49, 2, v49
    v_add_u32 v50, 0, v49
    v_smfmac_f32_16x16x64_bf16 v[8:11], v[236:239], a[16:23], v227
    ds_read_b128 a[116:119], v209 offset:11520
    v_or_b32 v50, v50, v48
    v_cmp_gt_u32 vcc, 0x100, v50
    v_add_u32 v52, 0, v51
    v_smfmac_f32_16x16x64_bf16 v[8:11], v[240:243], a[24:31], v227
    ds_read_b128 a[144:147], v210 offset:5120
    s_nop 0
    v_cndmask_b32 v215, v53, v52, vcc
    v_add_u32 v50, 4, v49
    s_waitcnt lgkmcnt(15)
    v_smfmac_f32_16x16x64_bf16 v[8:11], v[244:247], a[32:39], v227
    ds_read_b128 a[148:151], v211 offset:5120
    v_or_b32 v50, v50, v48
    v_cmp_gt_u32 vcc, 0x100, v50
    v_smfmac_f32_16x16x64_bf16 v[8:11], v[248:251], a[64:71], v227
    ds_read_b128 a[120:123], v209 offset:12800
    v_smfmac_f32_16x16x64_bf16 v[12:15], v[236:239], a[24:31], v227
    ds_read_b128 a[124:127], v209 offset:14080
    v_cndmask_b32_e64 v236, 0, v192, s[42:43]
    v_cndmask_b32_e64 v237, v192, 0, s[42:43]
    v_cndmask_b32_e64 v238, 0, v193, s[42:43]
    v_cndmask_b32_e64 v239, v193, 0, s[42:43]
    v_smfmac_f32_16x16x64_bf16 v[12:15], v[240:243], a[32:39], v227
    ds_read_b128 a[152:155], v210 offset:7680
    v_cndmask_b32_e64 v240, 0, v194, s[42:43]
    v_cndmask_b32_e64 v241, v194, 0, s[42:43]
    v_cndmask_b32_e64 v242, 0, v195, s[42:43]
    v_cndmask_b32_e64 v243, v195, 0, s[42:43]
    v_smfmac_f32_16x16x64_bf16 v[12:15], v[244:247], a[40:47], v227
    ds_read_b128 a[156:159], v211 offset:7680
    v_cndmask_b32_e64 v244, 0, v196, s[42:43]
    v_cndmask_b32_e64 v245, v196, 0, s[42:43]
    v_cndmask_b32_e64 v246, 0, v197, s[42:43]
    v_cndmask_b32_e64 v247, v197, 0, s[42:43]
    v_smfmac_f32_16x16x64_bf16 v[12:15], v[248:251], a[72:79], v227
    v_cndmask_b32_e64 v248, 0, v198, s[42:43]
    v_cndmask_b32_e64 v249, v198, 0, s[42:43]
    v_cndmask_b32_e64 v250, 0, v199, s[42:43]
    v_cndmask_b32_e64 v251, v199, 0, s[42:43]
    v_xor_b32 v209, 32, v206
    v_xor_b32 v210, 32, v207
    v_xor_b32 v211, 32, v208
    v_mfma_f32_16x16x32_bf16 v[32:35], a[248:251], a[248:251], 0
    ds_read_u16 v192, v228 offset:160
    ds_read_u16 v193, v229 offset:160
    v_add_u32 v52, 786432, v51
    s_nop 0
    v_cndmask_b32 v220, v53, v52, vcc
    v_mfma_f32_16x16x32_bf16 v[36:39], a[248:251], a[248:251], 0
    ds_read_u16 v194, v230 offset:160
    ds_read_u16 v195, v231 offset:160
    v_add_u32 v50, 8, v49
    v_or_b32 v50, v50, v48
    v_cmp_gt_u32 vcc, 0x100, v50
    v_mfma_f32_16x16x32_bf16 v[40:43], a[248:251], a[248:251], 0
    ds_read_u16 v196, v232 offset:160
    ds_read_u16 v197, v233 offset:160
    v_add_u32 v52, 1572864, v51
    s_nop 0
    v_cndmask_b32 v225, v53, v52, vcc
    v_mfma_f32_16x16x32_bf16 v[44:47], a[248:251], a[248:251], 0
    ds_read_u16 v198, v234 offset:160
    ds_read_u16 v199, v235 offset:160
    v_lshrrev_b32 v48, 2, v252
    v_add_u32 v48, 64, v48
    v_mul_u32_u24 v49, s37, v48
    s_waitcnt lgkmcnt(15)
    v_smfmac_f32_16x16x64_bf16 v[16:19], v[236:239], a[80:87], v227
    ds_read_b128 a[0:3], v209 offset:0
    ds_read_b128 a[4:7], v209 offset:1280
    v_lshrrev_b32 v49, 12, v49
    v_mul_u32_u24 v50, 20, v49
    v_sub_u32 v48, v48, v50
    v_smfmac_f32_16x16x64_bf16 v[16:19], v[240:243], a[88:95], v227
    ds_read_b128 a[8:11], v209 offset:2560
    ds_read_b128 a[12:15], v209 offset:3840
    v_bfe_u32 v50, v48, 2, 2
    v_and_b32 v51, 3, v252
    v_xor_b32 v50, v50, v51
    v_smfmac_f32_16x16x64_bf16 v[16:19], v[244:247], a[96:103], v227
    ds_read_b128 a[16:19], v209 offset:5120
    ds_read_b128 a[20:23], v209 offset:6400
    v_lshlrev_b32 v50, 4, v50
    v_lshl_add_u32 v51, v49, 8, v48
    v_mul_u32_u24 v51, 0x300, v51
    v_smfmac_f32_16x16x64_bf16 v[16:19], v[248:251], a[128:135], v227
    ds_read_b128 a[48:51], v210 offset:0
    ds_read_b128 a[52:55], v211 offset:0
    v_add3_u32 v51, v51, v50, s41
    v_add_u32 v48, s40, v48
    v_subrev_u32 v48, 2, v48
    v_smfmac_f32_16x16x64_bf16 v[20:23], v[236:239], a[88:95], v227
    ds_read_b128 a[24:27], v209 offset:7680
    ds_read_b128 a[28:31], v209 offset:8960
    v_add_u32 v49, s39, v49
    v_subrev_u32 v49, 2, v49
    v_add_u32 v50, 0, v49
    v_smfmac_f32_16x16x64_bf16 v[20:23], v[240:243], a[96:103], v227
    ds_read_b128 a[56:59], v210 offset:2560
    v_or_b32 v50, v50, v48
    v_cmp_gt_u32 vcc, 0x100, v50
    v_add_u32 v52, 0, v51
    v_smfmac_f32_16x16x64_bf16 v[20:23], v[244:247], a[104:111], v227
    ds_read_b128 a[60:63], v211 offset:2560
    s_nop 0
    v_cndmask_b32 v216, v53, v52, vcc
    v_add_u32 v50, 4, v49
    v_smfmac_f32_16x16x64_bf16 v[20:23], v[248:251], a[136:143], v227
    ds_read_b128 a[32:35], v209 offset:10240
    v_or_b32 v50, v50, v48
    v_cmp_gt_u32 vcc, 0x100, v50
    v_add_u32 v52, 786432, v51
    v_smfmac_f32_16x16x64_bf16 v[24:27], v[236:239], a[96:103], v227
    ds_read_b128 a[36:39], v209 offset:11520
    s_nop 0
    v_cndmask_b32 v221, v53, v52, vcc
    v_add_u32 v50, 8, v49
    v_smfmac_f32_16x16x64_bf16 v[24:27], v[240:243], a[104:111], v227
    ds_read_b128 a[64:67], v210 offset:5120
    v_or_b32 v50, v50, v48
    v_cmp_gt_u32 vcc, 0x100, v50
    v_add_u32 v52, 1572864, v51
    s_waitcnt lgkmcnt(15)
    v_smfmac_f32_16x16x64_bf16 v[24:27], v[244:247], a[112:119], v227
    ds_read_b128 a[68:71], v211 offset:5120
    s_nop 0
    v_cndmask_b32 v226, v53, v52, vcc
    v_smfmac_f32_16x16x64_bf16 v[24:27], v[248:251], a[144:151], v227
    ds_read_b128 a[40:43], v209 offset:12800
    v_smfmac_f32_16x16x64_bf16 v[28:31], v[236:239], a[104:111], v227
    ds_read_b128 a[44:47], v209 offset:14080
    v_cndmask_b32_e64 v236, 0, v192, s[42:43]
    v_cndmask_b32_e64 v237, v192, 0, s[42:43]
    v_cndmask_b32_e64 v238, 0, v193, s[42:43]
    v_cndmask_b32_e64 v239, v193, 0, s[42:43]
    v_smfmac_f32_16x16x64_bf16 v[28:31], v[240:243], a[112:119], v227
    ds_read_b128 a[72:75], v210 offset:7680
    v_cndmask_b32_e64 v240, 0, v194, s[42:43]
    v_cndmask_b32_e64 v241, v194, 0, s[42:43]
    v_cndmask_b32_e64 v242, 0, v195, s[42:43]
    v_cndmask_b32_e64 v243, v195, 0, s[42:43]
    v_smfmac_f32_16x16x64_bf16 v[28:31], v[244:247], a[120:127], v227
    ds_read_b128 a[76:79], v211 offset:7680
    v_cndmask_b32_e64 v244, 0, v196, s[42:43]
    v_cndmask_b32_e64 v245, v196, 0, s[42:43]
    v_cndmask_b32_e64 v246, 0, v197, s[42:43]
    v_cndmask_b32_e64 v247, v197, 0, s[42:43]
    v_smfmac_f32_16x16x64_bf16 v[28:31], v[248:251], a[152:159], v227
    v_cndmask_b32_e64 v248, 0, v198, s[42:43]
    v_cndmask_b32_e64 v249, v198, 0, s[42:43]
    v_cndmask_b32_e64 v250, 0, v199, s[42:43]
    v_cndmask_b32_e64 v251, v199, 0, s[42:43]
    v_xor_b32 v209, 48, v206
    v_xor_b32 v210, 48, v207
    v_xor_b32 v211, 48, v208
    v_mfma_f32_16x16x32_bf16 v[48:51], a[248:251], a[248:251], 0
    ds_read_u16 v192, v228 offset:176
    ds_read_u16 v193, v229 offset:176
    v_mfma_f32_16x16x32_bf16 v[52:55], a[248:251], a[248:251], 0
    ds_read_u16 v194, v230 offset:176
    ds_read_u16 v195, v231 offset:176
    v_mfma_f32_16x16x32_bf16 v[56:59], a[248:251], a[248:251], 0
    ds_read_u16 v196, v232 offset:176
    ds_read_u16 v197, v233 offset:176
    v_mfma_f32_16x16x32_bf16 v[60:63], a[248:251], a[248:251], 0
    ds_read_u16 v198, v234 offset:176
    ds_read_u16 v199, v235 offset:176
    s_waitcnt lgkmcnt(15)
    v_smfmac_f32_16x16x64_bf16 v[32:35], v[236:239], a[0:7], v227
    ds_read_b128 a[80:83], v209 offset:0
    ds_read_b128 a[84:87], v209 offset:1280
    v_smfmac_f32_16x16x64_bf16 v[32:35], v[240:243], a[8:15], v227
    ds_read_b128 a[88:91], v209 offset:2560
    ds_read_b128 a[92:95], v209 offset:3840
    v_smfmac_f32_16x16x64_bf16 v[32:35], v[244:247], a[16:23], v227
    ds_read_b128 a[96:99], v209 offset:5120
    ds_read_b128 a[100:103], v209 offset:6400
    v_smfmac_f32_16x16x64_bf16 v[32:35], v[248:251], a[48:55], v227
    ds_read_b128 a[128:131], v210 offset:0
    ds_read_b128 a[132:135], v211 offset:0
    v_smfmac_f32_16x16x64_bf16 v[36:39], v[236:239], a[8:15], v227
    ds_read_b128 a[104:107], v209 offset:7680
    ds_read_b128 a[108:111], v209 offset:8960
    v_smfmac_f32_16x16x64_bf16 v[36:39], v[240:243], a[16:23], v227
    ds_read_b128 a[136:139], v210 offset:2560
    v_smfmac_f32_16x16x64_bf16 v[36:39], v[244:247], a[24:31], v227
    ds_read_b128 a[140:143], v211 offset:2560
    v_smfmac_f32_16x16x64_bf16 v[36:39], v[248:251], a[56:63], v227
    ds_read_b128 a[112:115], v209 offset:10240
    v_smfmac_f32_16x16x64_bf16 v[40:43], v[236:239], a[16:23], v227
    ds_read_b128 a[116:119], v209 offset:11520
    v_smfmac_f32_16x16x64_bf16 v[40:43], v[240:243], a[24:31], v227
    ds_read_b128 a[144:147], v210 offset:5120
    s_waitcnt lgkmcnt(15)
    v_smfmac_f32_16x16x64_bf16 v[40:43], v[244:247], a[32:39], v227
    ds_read_b128 a[148:151], v211 offset:5120
    v_smfmac_f32_16x16x64_bf16 v[40:43], v[248:251], a[64:71], v227
    ds_read_b128 a[120:123], v209 offset:12800
    v_smfmac_f32_16x16x64_bf16 v[44:47], v[236:239], a[24:31], v227
    ds_read_b128 a[124:127], v209 offset:14080
    v_cndmask_b32_e64 v236, 0, v192, s[42:43]
    v_cndmask_b32_e64 v237, v192, 0, s[42:43]
    v_cndmask_b32_e64 v238, 0, v193, s[42:43]
    v_cndmask_b32_e64 v239, v193, 0, s[42:43]
    v_smfmac_f32_16x16x64_bf16 v[44:47], v[240:243], a[32:39], v227
    ds_read_b128 a[152:155], v210 offset:7680
    v_cndmask_b32_e64 v240, 0, v194, s[42:43]
    v_cndmask_b32_e64 v241, v194, 0, s[42:43]
    v_cndmask_b32_e64 v242, 0, v195, s[42:43]
    v_cndmask_b32_e64 v243, v195, 0, s[42:43]
    v_smfmac_f32_16x16x64_bf16 v[44:47], v[244:247], a[40:47], v227
    ds_read_b128 a[156:159], v211 offset:7680
    v_cndmask_b32_e64 v244, 0, v196, s[42:43]
    v_cndmask_b32_e64 v245, v196, 0, s[42:43]
    v_cndmask_b32_e64 v246, 0, v197, s[42:43]
    v_cndmask_b32_e64 v247, v197, 0, s[42:43]
    v_smfmac_f32_16x16x64_bf16 v[44:47], v[248:251], a[72:79], v227
    v_cndmask_b32_e64 v248, 0, v198, s[42:43]
    v_cndmask_b32_e64 v249, v198, 0, s[42:43]
    v_cndmask_b32_e64 v250, 0, v199, s[42:43]
    v_cndmask_b32_e64 v251, v199, 0, s[42:43]
    s_waitcnt lgkmcnt(15)
    v_smfmac_f32_16x16x64_bf16 v[48:51], v[236:239], a[80:87], v227
    v_smfmac_f32_16x16x64_bf16 v[48:51], v[240:243], a[88:95], v227
    s_waitcnt lgkmcnt(14)
    v_smfmac_f32_16x16x64_bf16 v[48:51], v[244:247], a[96:103], v227
    s_waitcnt lgkmcnt(12)
    v_smfmac_f32_16x16x64_bf16 v[48:51], v[248:251], a[128:135], v227
    v_smfmac_f32_16x16x64_bf16 v[52:55], v[236:239], a[88:95], v227
    v_smfmac_f32_16x16x64_bf16 v[52:55], v[240:243], a[96:103], v227
    s_waitcnt lgkmcnt(10)
    v_smfmac_f32_16x16x64_bf16 v[52:55], v[244:247], a[104:111], v227
    s_waitcnt lgkmcnt(8)
    v_smfmac_f32_16x16x64_bf16 v[52:55], v[248:251], a[136:143], v227
    v_smfmac_f32_16x16x64_bf16 v[56:59], v[236:239], a[96:103], v227
    v_smfmac_f32_16x16x64_bf16 v[56:59], v[240:243], a[104:111], v227
    s_waitcnt lgkmcnt(6)
    v_smfmac_f32_16x16x64_bf16 v[56:59], v[244:247], a[112:119], v227
    s_waitcnt lgkmcnt(4)
    v_smfmac_f32_16x16x64_bf16 v[56:59], v[248:251], a[144:151], v227
    v_smfmac_f32_16x16x64_bf16 v[60:63], v[236:239], a[104:111], v227
    v_smfmac_f32_16x16x64_bf16 v[60:63], v[240:243], a[112:119], v227
    s_waitcnt lgkmcnt(2)
    v_smfmac_f32_16x16x64_bf16 v[60:63], v[244:247], a[120:127], v227
    s_waitcnt lgkmcnt(0)
    v_smfmac_f32_16x16x64_bf16 v[60:63], v[248:251], a[152:159], v227
    s_nop 7
    v_pk_add_f32 v[236:237], v[128:129], v[130:131]
    v_pk_mul_f32 v[244:245], v[128:129], v[128:129]
    v_pk_add_f32 v[238:239], v[132:133], v[134:135]
    v_pk_mul_f32 v[246:247], v[132:133], v[132:133]
    v_pk_add_f32 v[240:241], v[136:137], v[138:139]
    v_pk_mul_f32 v[248:249], v[136:137], v[136:137]
    v_pk_add_f32 v[242:243], v[140:141], v[142:143]
    v_pk_mul_f32 v[250:251], v[140:141], v[140:141]
    v_pk_fma_f32 v[244:245], v[130:131], v[130:131], v[244:245]
    v_pk_fma_f32 v[246:247], v[134:135], v[134:135], v[246:247]
    v_pk_fma_f32 v[248:249], v[138:139], v[138:139], v[248:249]
    v_pk_fma_f32 v[250:251], v[142:143], v[142:143], v[250:251]
    v_pk_add_f32 v[236:237], v[236:237], v[144:145]
    v_pk_add_f32 v[238:239], v[238:239], v[148:149]
    v_pk_add_f32 v[240:241], v[240:241], v[152:153]
    v_pk_add_f32 v[242:243], v[242:243], v[156:157]
    v_pk_fma_f32 v[244:245], v[144:145], v[144:145], v[244:245]
    v_pk_fma_f32 v[246:247], v[148:149], v[148:149], v[246:247]
    v_pk_fma_f32 v[248:249], v[152:153], v[152:153], v[248:249]
    v_pk_fma_f32 v[250:251], v[156:157], v[156:157], v[250:251]
    v_pk_add_f32 v[236:237], v[236:237], v[146:147]
    v_pk_add_f32 v[238:239], v[238:239], v[150:151]
    v_pk_add_f32 v[240:241], v[240:241], v[154:155]
    v_pk_add_f32 v[242:243], v[242:243], v[158:159]
    v_pk_fma_f32 v[244:245], v[146:147], v[146:147], v[244:245]
    v_pk_fma_f32 v[246:247], v[150:151], v[150:151], v[246:247]
    v_pk_fma_f32 v[248:249], v[154:155], v[154:155], v[248:249]
    v_pk_fma_f32 v[250:251], v[158:159], v[158:159], v[250:251]
    v_pk_add_f32 v[236:237], v[236:237], v[160:161]
    v_pk_add_f32 v[238:239], v[238:239], v[164:165]
    v_pk_add_f32 v[240:241], v[240:241], v[168:169]
    v_pk_add_f32 v[242:243], v[242:243], v[172:173]
    v_pk_fma_f32 v[244:245], v[160:161], v[160:161], v[244:245]
    v_pk_fma_f32 v[246:247], v[164:165], v[164:165], v[246:247]
    v_pk_fma_f32 v[248:249], v[168:169], v[168:169], v[248:249]
    v_pk_fma_f32 v[250:251], v[172:173], v[172:173], v[250:251]
    v_pk_add_f32 v[236:237], v[236:237], v[162:163]
    v_pk_add_f32 v[238:239], v[238:239], v[166:167]
    v_pk_add_f32 v[240:241], v[240:241], v[170:171]
    v_pk_add_f32 v[242:243], v[242:243], v[174:175]
    v_pk_fma_f32 v[244:245], v[162:163], v[162:163], v[244:245]
    v_pk_fma_f32 v[246:247], v[166:167], v[166:167], v[246:247]
    v_pk_fma_f32 v[248:249], v[170:171], v[170:171], v[248:249]
    v_pk_fma_f32 v[250:251], v[174:175], v[174:175], v[250:251]
    v_pk_add_f32 v[236:237], v[236:237], v[176:177]
    v_pk_add_f32 v[238:239], v[238:239], v[180:181]
    v_pk_add_f32 v[240:241], v[240:241], v[184:185]
    v_pk_add_f32 v[242:243], v[242:243], v[188:189]
    v_pk_fma_f32 v[244:245], v[176:177], v[176:177], v[244:245]
    v_pk_fma_f32 v[246:247], v[180:181], v[180:181], v[246:247]
    v_pk_fma_f32 v[248:249], v[184:185], v[184:185], v[248:249]
    v_pk_fma_f32 v[250:251], v[188:189], v[188:189], v[250:251]
    v_pk_add_f32 v[236:237], v[236:237], v[178:179]
    v_pk_add_f32 v[238:239], v[238:239], v[182:183]
    v_pk_add_f32 v[240:241], v[240:241], v[186:187]
    v_pk_add_f32 v[242:243], v[242:243], v[190:191]
    v_pk_fma_f32 v[244:245], v[178:179], v[178:179], v[244:245]
    v_pk_fma_f32 v[246:247], v[182:183], v[182:183], v[246:247]
    v_pk_fma_f32 v[248:249], v[186:187], v[186:187], v[248:249]
    v_pk_fma_f32 v[250:251], v[190:191], v[190:191], v[250:251]
    v_pk_add_f32 v[236:237], v[236:237], v[64:65]
    v_pk_add_f32 v[238:239], v[238:239], v[68:69]
    v_pk_add_f32 v[240:241], v[240:241], v[72:73]
    v_pk_add_f32 v[242:243], v[242:243], v[76:77]
    v_pk_fma_f32 v[244:245], v[64:65], v[64:65], v[244:245]
    v_pk_fma_f32 v[246:247], v[68:69], v[68:69], v[246:247]
    v_pk_fma_f32 v[248:249], v[72:73], v[72:73], v[248:249]
    v_pk_fma_f32 v[250:251], v[76:77], v[76:77], v[250:251]
    v_pk_add_f32 v[236:237], v[236:237], v[66:67]
    v_pk_add_f32 v[238:239], v[238:239], v[70:71]
    v_pk_add_f32 v[240:241], v[240:241], v[74:75]
    v_pk_add_f32 v[242:243], v[242:243], v[78:79]
    v_pk_fma_f32 v[244:245], v[66:67], v[66:67], v[244:245]
    v_pk_fma_f32 v[246:247], v[70:71], v[70:71], v[246:247]
    v_pk_fma_f32 v[248:249], v[74:75], v[74:75], v[248:249]
    v_pk_fma_f32 v[250:251], v[78:79], v[78:79], v[250:251]
    v_pk_add_f32 v[236:237], v[236:237], v[80:81]
    v_pk_add_f32 v[238:239], v[238:239], v[84:85]
    v_pk_add_f32 v[240:241], v[240:241], v[88:89]
    v_pk_add_f32 v[242:243], v[242:243], v[92:93]
    v_pk_fma_f32 v[244:245], v[80:81], v[80:81], v[244:245]
    v_pk_fma_f32 v[246:247], v[84:85], v[84:85], v[246:247]
    v_pk_fma_f32 v[248:249], v[88:89], v[88:89], v[248:249]
    v_pk_fma_f32 v[250:251], v[92:93], v[92:93], v[250:251]
    v_pk_add_f32 v[236:237], v[236:237], v[82:83]
    v_pk_add_f32 v[238:239], v[238:239], v[86:87]
    v_pk_add_f32 v[240:241], v[240:241], v[90:91]
    v_pk_add_f32 v[242:243], v[242:243], v[94:95]
    v_pk_fma_f32 v[244:245], v[82:83], v[82:83], v[244:245]
    v_pk_fma_f32 v[246:247], v[86:87], v[86:87], v[246:247]
    v_pk_fma_f32 v[248:249], v[90:91], v[90:91], v[248:249]
    v_pk_fma_f32 v[250:251], v[94:95], v[94:95], v[250:251]
    v_pk_add_f32 v[236:237], v[236:237], v[96:97]
    v_pk_add_f32 v[238:239], v[238:239], v[100:101]
    v_pk_add_f32 v[240:241], v[240:241], v[104:105]
    v_pk_add_f32 v[242:243], v[242:243], v[108:109]
    v_pk_fma_f32 v[244:245], v[96:97], v[96:97], v[244:245]
    v_pk_fma_f32 v[246:247], v[100:101], v[100:101], v[246:247]
    v_pk_fma_f32 v[248:249], v[104:105], v[104:105], v[248:249]
    v_pk_fma_f32 v[250:251], v[108:109], v[108:109], v[250:251]
    v_pk_add_f32 v[236:237], v[236:237], v[98:99]
    v_pk_add_f32 v[238:239], v[238:239], v[102:103]
    v_pk_add_f32 v[240:241], v[240:241], v[106:107]
    v_pk_add_f32 v[242:243], v[242:243], v[110:111]
    v_pk_fma_f32 v[244:245], v[98:99], v[98:99], v[244:245]
    v_pk_fma_f32 v[246:247], v[102:103], v[102:103], v[246:247]
    v_pk_fma_f32 v[248:249], v[106:107], v[106:107], v[248:249]
    v_pk_fma_f32 v[250:251], v[110:111], v[110:111], v[250:251]
    v_pk_add_f32 v[236:237], v[236:237], v[112:113]
    v_pk_add_f32 v[238:239], v[238:239], v[116:117]
    v_pk_add_f32 v[240:241], v[240:241], v[120:121]
    v_pk_add_f32 v[242:243], v[242:243], v[124:125]
    v_pk_fma_f32 v[244:245], v[112:113], v[112:113], v[244:245]
    v_pk_fma_f32 v[246:247], v[116:117], v[116:117], v[246:247]
    v_pk_fma_f32 v[248:249], v[120:121], v[120:121], v[248:249]
    v_pk_fma_f32 v[250:251], v[124:125], v[124:125], v[250:251]
    v_pk_add_f32 v[236:237], v[236:237], v[114:115]
    v_pk_add_f32 v[238:239], v[238:239], v[118:119]
    v_pk_add_f32 v[240:241], v[240:241], v[122:123]
    v_pk_add_f32 v[242:243], v[242:243], v[126:127]
    v_pk_fma_f32 v[244:245], v[114:115], v[114:115], v[244:245]
    v_pk_fma_f32 v[246:247], v[118:119], v[118:119], v[246:247]
    v_pk_fma_f32 v[248:249], v[122:123], v[122:123], v[248:249]
    v_pk_fma_f32 v[250:251], v[126:127], v[126:127], v[250:251]
    v_pk_add_f32 v[236:237], v[236:237], v[0:1]
    v_pk_add_f32 v[238:239], v[238:239], v[4:5]
    v_pk_add_f32 v[240:241], v[240:241], v[8:9]
    v_pk_add_f32 v[242:243], v[242:243], v[12:13]
    v_pk_fma_f32 v[244:245], v[0:1], v[0:1], v[244:245]
    v_pk_fma_f32 v[246:247], v[4:5], v[4:5], v[246:247]
    v_pk_fma_f32 v[248:249], v[8:9], v[8:9], v[248:249]
    v_pk_fma_f32 v[250:251], v[12:13], v[12:13], v[250:251]
    v_pk_add_f32 v[236:237], v[236:237], v[2:3]
    v_pk_add_f32 v[238:239], v[238:239], v[6:7]
    v_pk_add_f32 v[240:241], v[240:241], v[10:11]
    v_pk_add_f32 v[242:243], v[242:243], v[14:15]
    v_pk_fma_f32 v[244:245], v[2:3], v[2:3], v[244:245]
    v_pk_fma_f32 v[246:247], v[6:7], v[6:7], v[246:247]
    v_pk_fma_f32 v[248:249], v[10:11], v[10:11], v[248:249]
    v_pk_fma_f32 v[250:251], v[14:15], v[14:15], v[250:251]
    v_pk_add_f32 v[236:237], v[236:237], v[16:17]
    v_pk_add_f32 v[238:239], v[238:239], v[20:21]
    v_pk_add_f32 v[240:241], v[240:241], v[24:25]
    v_pk_add_f32 v[242:243], v[242:243], v[28:29]
    v_pk_fma_f32 v[244:245], v[16:17], v[16:17], v[244:245]
    v_pk_fma_f32 v[246:247], v[20:21], v[20:21], v[246:247]
    v_pk_fma_f32 v[248:249], v[24:25], v[24:25], v[248:249]
    v_pk_fma_f32 v[250:251], v[28:29], v[28:29], v[250:251]
    v_pk_add_f32 v[236:237], v[236:237], v[18:19]
    v_pk_add_f32 v[238:239], v[238:239], v[22:23]
    v_pk_add_f32 v[240:241], v[240:241], v[26:27]
    v_pk_add_f32 v[242:243], v[242:243], v[30:31]
    v_pk_fma_f32 v[244:245], v[18:19], v[18:19], v[244:245]
    v_pk_fma_f32 v[246:247], v[22:23], v[22:23], v[246:247]
    v_pk_fma_f32 v[248:249], v[26:27], v[26:27], v[248:249]
    v_pk_fma_f32 v[250:251], v[30:31], v[30:31], v[250:251]
    v_pk_add_f32 v[236:237], v[236:237], v[32:33]
    v_pk_add_f32 v[238:239], v[238:239], v[36:37]
    v_pk_add_f32 v[240:241], v[240:241], v[40:41]
    v_pk_add_f32 v[242:243], v[242:243], v[44:45]
    v_pk_fma_f32 v[244:245], v[32:33], v[32:33], v[244:245]
    v_pk_fma_f32 v[246:247], v[36:37], v[36:37], v[246:247]
    v_pk_fma_f32 v[248:249], v[40:41], v[40:41], v[248:249]
    v_pk_fma_f32 v[250:251], v[44:45], v[44:45], v[250:251]
    v_pk_add_f32 v[236:237], v[236:237], v[34:35]
    v_pk_add_f32 v[238:239], v[238:239], v[38:39]
    v_pk_add_f32 v[240:241], v[240:241], v[42:43]
    v_pk_add_f32 v[242:243], v[242:243], v[46:47]
    v_pk_fma_f32 v[244:245], v[34:35], v[34:35], v[244:245]
    v_pk_fma_f32 v[246:247], v[38:39], v[38:39], v[246:247]
    v_pk_fma_f32 v[248:249], v[42:43], v[42:43], v[248:249]
    v_pk_fma_f32 v[250:251], v[46:47], v[46:47], v[250:251]
    v_pk_add_f32 v[236:237], v[236:237], v[48:49]
    v_pk_add_f32 v[238:239], v[238:239], v[52:53]
    v_pk_add_f32 v[240:241], v[240:241], v[56:57]
    v_pk_add_f32 v[242:243], v[242:243], v[60:61]
    v_pk_fma_f32 v[244:245], v[48:49], v[48:49], v[244:245]
    v_pk_fma_f32 v[246:247], v[52:53], v[52:53], v[246:247]
    v_pk_fma_f32 v[248:249], v[56:57], v[56:57], v[248:249]
    v_pk_fma_f32 v[250:251], v[60:61], v[60:61], v[250:251]
    v_pk_add_f32 v[236:237], v[236:237], v[50:51]
    v_pk_add_f32 v[238:239], v[238:239], v[54:55]
    v_pk_add_f32 v[240:241], v[240:241], v[58:59]
    v_pk_add_f32 v[242:243], v[242:243], v[62:63]
    v_pk_fma_f32 v[244:245], v[50:51], v[50:51], v[244:245]
    v_pk_fma_f32 v[246:247], v[54:55], v[54:55], v[246:247]
    v_pk_fma_f32 v[248:249], v[58:59], v[58:59], v[248:249]
    v_pk_fma_f32 v[250:251], v[62:63], v[62:63], v[250:251]
    s_lshl_b32 s35, s20, 10
    v_add_u32 v199, s35, v202
    v_permlane32_swap_b32 v236, v240
    v_permlane32_swap_b32 v238, v242
    v_permlane32_swap_b32 v237, v241
    v_permlane32_swap_b32 v239, v243
    v_permlane32_swap_b32 v244, v248
    v_permlane32_swap_b32 v246, v250
    v_permlane32_swap_b32 v245, v249
    v_permlane32_swap_b32 v247, v251
    v_add_f32 v236, v236, v240
    v_add_f32 v238, v238, v242
    v_add_f32 v237, v237, v241
    v_add_f32 v239, v239, v243
    v_add_f32 v244, v244, v248
    v_add_f32 v246, v246, v250
    v_add_f32 v245, v245, v249
    v_add_f32 v247, v247, v251
    s_nop 1
    v_permlane16_swap_b32 v236, v238
    v_permlane16_swap_b32 v237, v239
    v_permlane16_swap_b32 v244, v246
    v_permlane16_swap_b32 v245, v247
    v_add_f32 v192, v236, v238
    v_add_f32 v193, v237, v239
    v_add_f32 v194, v244, v246
    v_add_f32 v195, v245, v247
    ds_write_b128 v199, v[192:195] offset:61440
    s_or_b32 s35, s21, s20
    s_cmp_eq_u32 s35, 0
    s_cbranch_scc1 L_spin
L_ready:
    s_waitcnt lgkmcnt(0)
    s_barrier
    ds_read_b128 v[196:199], v202 offset:61440
    ds_read_b128 v[236:239], v202 offset:62464
    ds_read_b128 v[240:243], v202 offset:63488
    ds_read_b128 v[244:247], v202 offset:64512
    s_waitcnt lgkmcnt(0)
    v_add_f32 v196, v196, v236
    v_add_f32 v197, v197, v237
    v_add_f32 v198, v198, v238
    v_add_f32 v199, v199, v239
    v_add_f32 v240, v240, v244
    v_add_f32 v241, v241, v245
    v_add_f32 v242, v242, v246
    v_add_f32 v243, v243, v247
    v_add_f32 v196, v196, v240
    v_add_f32 v197, v197, v241
    v_add_f32 v198, v198, v242
    v_add_f32 v199, v199, v243
    v_mul_f32 v196, s30, v196
    v_mul_f32 v197, s30, v197
    v_mul_f32 v198, s30, v198
    v_mul_f32 v199, s30, v199
    v_fma_f32 v198, -v196, v196, v198
    v_fma_f32 v199, -v197, v197, v199
    v_max_f32 v198, 0, v198
    v_max_f32 v199, 0, v199
    v_add_f32 v198, s31, v198
    v_add_f32 v199, s31, v199
    v_rsq_f32 v198, v198
    v_rsq_f32 v199, v199
    s_nop 0
    v_mul_f32 v192, s28, v198
    v_mul_f32 v193, s28, v199
    v_mul_f32_e64 v194, -v196, v192
    v_mul_f32_e64 v195, -v197, v193
    v_mov_b32 v236, v192
    v_mov_b32 v240, v192
    v_mov_b32 v237, v193
    v_mov_b32 v241, v193
    v_mov_b32 v238, v194
    v_mov_b32 v242, v194
    v_mov_b32 v239, v195
    v_mov_b32 v243, v195
    s_nop 1
    v_permlane16_swap_b32 v236, v240
    v_permlane16_swap_b32 v237, v241
    v_permlane16_swap_b32 v238, v242
    v_permlane16_swap_b32 v239, v243
    v_mov_b32 v244, v236
    v_mov_b32 v248, v240
    v_mov_b32 v245, v237
    v_mov_b32 v249, v241
    v_mov_b32 v246, v238
    v_mov_b32 v250, v242
    v_mov_b32 v247, v239
    v_mov_b32 v251, v243
    s_nop 1
    v_permlane32_swap_b32 v236, v244
    v_permlane32_swap_b32 v240, v248
    v_permlane32_swap_b32 v237, v245
    v_permlane32_swap_b32 v241, v249
    v_permlane32_swap_b32 v238, v246
    v_permlane32_swap_b32 v242, v250
    v_permlane32_swap_b32 v239, v247
    v_permlane32_swap_b32 v243, v251
    s_lshl_b32 s35, s20, 10
    v_add_u32 v211, s35, v200
    v_add_u32 v209, s35, v201
    v_pk_fma_f32 v[128:129], v[128:129], v[236:237], v[238:239]
    v_pk_fma_f32 v[130:131], v[130:131], v[236:237], v[238:239]
    v_pk_fma_f32 v[144:145], v[144:145], v[236:237], v[238:239]
    v_pk_fma_f32 v[146:147], v[146:147], v[236:237], v[238:239]
    v_pk_fma_f32 v[160:161], v[160:161], v[236:237], v[238:239]
    v_pk_fma_f32 v[162:163], v[162:163], v[236:237], v[238:239]
    v_pk_fma_f32 v[176:177], v[176:177], v[236:237], v[238:239]
    v_pk_fma_f32 v[178:179], v[178:179], v[236:237], v[238:239]
    s_add_u32 m0, s24, 98304
    s_mov_b32 s25, 0
    v_cvt_pk_bf16_f32 v192, v128, v130
    v_cvt_pk_bf16_f32 v193, v144, v146
    v_cvt_pk_bf16_f32 v194, v160, v162
    v_cvt_pk_bf16_f32 v195, v176, v178
    ds_write_b128 v211, v[192:195] offset:0
    buffer_load_dwordx4 v203, s[8:11], s25 offen offset:0 lds
    buffer_load_dwordx4 v203, s[8:11], s25 offen offset:1024 lds
    v_cvt_pk_bf16_f32 v196, v129, v131
    v_cvt_pk_bf16_f32 v197, v145, v147
    v_cvt_pk_bf16_f32 v198, v161, v163
    v_cvt_pk_bf16_f32 v199, v177, v179
    ds_write_b128 v211, v[196:199] offset:12288
    v_pk_fma_f32 v[132:133], v[132:133], v[240:241], v[242:243]
    v_pk_fma_f32 v[134:135], v[134:135], v[240:241], v[242:243]
    v_pk_fma_f32 v[148:149], v[148:149], v[240:241], v[242:243]
    v_pk_fma_f32 v[150:151], v[150:151], v[240:241], v[242:243]
    v_pk_fma_f32 v[164:165], v[164:165], v[240:241], v[242:243]
    v_pk_fma_f32 v[166:167], v[166:167], v[240:241], v[242:243]
    v_pk_fma_f32 v[180:181], v[180:181], v[240:241], v[242:243]
    v_pk_fma_f32 v[182:183], v[182:183], v[240:241], v[242:243]
    buffer_load_dwordx4 v203, s[8:11], s25 offen offset:2048 lds
    s_add_u32 m0, s24, 110592
    v_cvt_pk_bf16_f32 v192, v132, v134
    v_cvt_pk_bf16_f32 v193, v148, v150
    v_cvt_pk_bf16_f32 v194, v164, v166
    v_cvt_pk_bf16_f32 v195, v180, v182
    ds_write_b128 v211, v[192:195] offset:24576
    s_mov_b32 s25, 24576
    buffer_load_dwordx4 v203, s[8:11], s25 offen offset:0 lds
    v_cvt_pk_bf16_f32 v196, v133, v135
    v_cvt_pk_bf16_f32 v197, v149, v151
    v_cvt_pk_bf16_f32 v198, v165, v167
    v_cvt_pk_bf16_f32 v199, v181, v183
    ds_write_b128 v211, v[196:199] offset:36864
    v_pk_fma_f32 v[136:137], v[136:137], v[244:245], v[246:247]
    v_pk_fma_f32 v[138:139], v[138:139], v[244:245], v[246:247]
    v_pk_fma_f32 v[152:153], v[152:153], v[244:245], v[246:247]
    v_pk_fma_f32 v[154:155], v[154:155], v[244:245], v[246:247]
    v_pk_fma_f32 v[168:169], v[168:169], v[244:245], v[246:247]
    v_pk_fma_f32 v[170:171], v[170:171], v[244:245], v[246:247]
    v_pk_fma_f32 v[184:185], v[184:185], v[244:245], v[246:247]
    v_pk_fma_f32 v[186:187], v[186:187], v[244:245], v[246:247]
    buffer_load_dwordx4 v203, s[8:11], s25 offen offset:1024 lds
    buffer_load_dwordx4 v203, s[8:11], s25 offen offset:2048 lds
    v_cvt_pk_bf16_f32 v192, v136, v138
    v_cvt_pk_bf16_f32 v193, v152, v154
    v_cvt_pk_bf16_f32 v194, v168, v170
    v_cvt_pk_bf16_f32 v195, v184, v186
    ds_write_b128 v209, v[192:195] offset:0
    s_add_u32 m0, s24, 122880
    s_mov_b32 s25, 49152
    v_cvt_pk_bf16_f32 v196, v137, v139
    v_cvt_pk_bf16_f32 v197, v153, v155
    v_cvt_pk_bf16_f32 v198, v169, v171
    v_cvt_pk_bf16_f32 v199, v185, v187
    ds_write_b128 v209, v[196:199] offset:12288
    v_pk_fma_f32 v[140:141], v[140:141], v[248:249], v[250:251]
    v_pk_fma_f32 v[142:143], v[142:143], v[248:249], v[250:251]
    v_pk_fma_f32 v[156:157], v[156:157], v[248:249], v[250:251]
    v_pk_fma_f32 v[158:159], v[158:159], v[248:249], v[250:251]
    v_pk_fma_f32 v[172:173], v[172:173], v[248:249], v[250:251]
    v_pk_fma_f32 v[174:175], v[174:175], v[248:249], v[250:251]
    v_pk_fma_f32 v[188:189], v[188:189], v[248:249], v[250:251]
    v_pk_fma_f32 v[190:191], v[190:191], v[248:249], v[250:251]
    buffer_load_dwordx4 v203, s[8:11], s25 offen offset:0 lds
    buffer_load_dwordx4 v203, s[8:11], s25 offen offset:1024 lds
    v_cvt_pk_bf16_f32 v192, v140, v142
    v_cvt_pk_bf16_f32 v193, v156, v158
    v_cvt_pk_bf16_f32 v194, v172, v174
    v_cvt_pk_bf16_f32 v195, v188, v190
    ds_write_b128 v209, v[192:195] offset:24576
    buffer_load_dwordx4 v203, s[8:11], s25 offen offset:2048 lds
    v_cvt_pk_bf16_f32 v196, v141, v143
    v_cvt_pk_bf16_f32 v197, v157, v159
    v_cvt_pk_bf16_f32 v198, v173, v175
    v_cvt_pk_bf16_f32 v199, v189, v191
    ds_write_b128 v209, v[196:199] offset:36864
    v_pk_fma_f32 v[64:65], v[64:65], v[236:237], v[238:239]
    v_pk_fma_f32 v[66:67], v[66:67], v[236:237], v[238:239]
    v_pk_fma_f32 v[80:81], v[80:81], v[236:237], v[238:239]
    v_pk_fma_f32 v[82:83], v[82:83], v[236:237], v[238:239]
    v_pk_fma_f32 v[96:97], v[96:97], v[236:237], v[238:239]
    v_pk_fma_f32 v[98:99], v[98:99], v[236:237], v[238:239]
    v_pk_fma_f32 v[112:113], v[112:113], v[236:237], v[238:239]
    v_pk_fma_f32 v[114:115], v[114:115], v[236:237], v[238:239]
    v_cvt_pk_bf16_f32 v192, v64, v66
    v_cvt_pk_bf16_f32 v193, v80, v82
    v_cvt_pk_bf16_f32 v194, v96, v98
    v_cvt_pk_bf16_f32 v195, v112, v114
    ds_write_b128 v211, v[192:195] offset:4096
    v_cvt_pk_bf16_f32 v196, v65, v67
    v_cvt_pk_bf16_f32 v197, v81, v83
    v_cvt_pk_bf16_f32 v198, v97, v99
    v_cvt_pk_bf16_f32 v199, v113, v115
    ds_write_b128 v211, v[196:199] offset:16384
    v_pk_fma_f32 v[68:69], v[68:69], v[240:241], v[242:243]
    v_pk_fma_f32 v[70:71], v[70:71], v[240:241], v[242:243]
    v_pk_fma_f32 v[84:85], v[84:85], v[240:241], v[242:243]
    v_pk_fma_f32 v[86:87], v[86:87], v[240:241], v[242:243]
    v_pk_fma_f32 v[100:101], v[100:101], v[240:241], v[242:243]
    v_pk_fma_f32 v[102:103], v[102:103], v[240:241], v[242:243]
    v_pk_fma_f32 v[116:117], v[116:117], v[240:241], v[242:243]
    v_pk_fma_f32 v[118:119], v[118:119], v[240:241], v[242:243]
    v_cvt_pk_bf16_f32 v192, v68, v70
    v_cvt_pk_bf16_f32 v193, v84, v86
    v_cvt_pk_bf16_f32 v194, v100, v102
    v_cvt_pk_bf16_f32 v195, v116, v118
    ds_write_b128 v211, v[192:195] offset:28672
    v_cvt_pk_bf16_f32 v196, v69, v71
    v_cvt_pk_bf16_f32 v197, v85, v87
    v_cvt_pk_bf16_f32 v198, v101, v103
    v_cvt_pk_bf16_f32 v199, v117, v119
    ds_write_b128 v211, v[196:199] offset:40960
    v_pk_fma_f32 v[72:73], v[72:73], v[244:245], v[246:247]
    v_pk_fma_f32 v[74:75], v[74:75], v[244:245], v[246:247]
    v_pk_fma_f32 v[88:89], v[88:89], v[244:245], v[246:247]
    v_pk_fma_f32 v[90:91], v[90:91], v[244:245], v[246:247]
    v_pk_fma_f32 v[104:105], v[104:105], v[244:245], v[246:247]
    v_pk_fma_f32 v[106:107], v[106:107], v[244:245], v[246:247]
    v_pk_fma_f32 v[120:121], v[120:121], v[244:245], v[246:247]
    v_pk_fma_f32 v[122:123], v[122:123], v[244:245], v[246:247]
    v_cvt_pk_bf16_f32 v192, v72, v74
    v_cvt_pk_bf16_f32 v193, v88, v90
    v_cvt_pk_bf16_f32 v194, v104, v106
    v_cvt_pk_bf16_f32 v195, v120, v122
    ds_write_b128 v209, v[192:195] offset:4096
    v_cvt_pk_bf16_f32 v196, v73, v75
    v_cvt_pk_bf16_f32 v197, v89, v91
    v_cvt_pk_bf16_f32 v198, v105, v107
    v_cvt_pk_bf16_f32 v199, v121, v123
    ds_write_b128 v209, v[196:199] offset:16384
    v_pk_fma_f32 v[76:77], v[76:77], v[248:249], v[250:251]
    v_pk_fma_f32 v[78:79], v[78:79], v[248:249], v[250:251]
    v_pk_fma_f32 v[92:93], v[92:93], v[248:249], v[250:251]
    v_pk_fma_f32 v[94:95], v[94:95], v[248:249], v[250:251]
    v_pk_fma_f32 v[108:109], v[108:109], v[248:249], v[250:251]
    v_pk_fma_f32 v[110:111], v[110:111], v[248:249], v[250:251]
    v_pk_fma_f32 v[124:125], v[124:125], v[248:249], v[250:251]
    v_pk_fma_f32 v[126:127], v[126:127], v[248:249], v[250:251]
    v_cvt_pk_bf16_f32 v192, v76, v78
    v_cvt_pk_bf16_f32 v193, v92, v94
    v_cvt_pk_bf16_f32 v194, v108, v110
    v_cvt_pk_bf16_f32 v195, v124, v126
    ds_write_b128 v209, v[192:195] offset:28672
    v_cvt_pk_bf16_f32 v196, v77, v79
    v_cvt_pk_bf16_f32 v197, v93, v95
    v_cvt_pk_bf16_f32 v198, v109, v111
    v_cvt_pk_bf16_f32 v199, v125, v127
    ds_write_b128 v209, v[196:199] offset:40960
    v_pk_fma_f32 v[0:1], v[0:1], v[236:237], v[238:239]
    v_pk_fma_f32 v[2:3], v[2:3], v[236:237], v[238:239]
    v_pk_fma_f32 v[16:17], v[16:17], v[236:237], v[238:239]
    v_pk_fma_f32 v[18:19], v[18:19], v[236:237], v[238:239]
    v_pk_fma_f32 v[32:33], v[32:33], v[236:237], v[238:239]
    v_pk_fma_f32 v[34:35], v[34:35], v[236:237], v[238:239]
    v_pk_fma_f32 v[48:49], v[48:49], v[236:237], v[238:239]
    v_pk_fma_f32 v[50:51], v[50:51], v[236:237], v[238:239]
    v_cvt_pk_bf16_f32 v192, v0, v2
    v_cvt_pk_bf16_f32 v193, v16, v18
    v_cvt_pk_bf16_f32 v194, v32, v34
    v_cvt_pk_bf16_f32 v195, v48, v50
    ds_write_b128 v211, v[192:195] offset:8192
    v_cvt_pk_bf16_f32 v196, v1, v3
    v_cvt_pk_bf16_f32 v197, v17, v19
    v_cvt_pk_bf16_f32 v198, v33, v35
    v_cvt_pk_bf16_f32 v199, v49, v51
    ds_write_b128 v211, v[196:199] offset:20480
    v_pk_fma_f32 v[4:5], v[4:5], v[240:241], v[242:243]
    v_pk_fma_f32 v[6:7], v[6:7], v[240:241], v[242:243]
    v_pk_fma_f32 v[20:21], v[20:21], v[240:241], v[242:243]
    v_pk_fma_f32 v[22:23], v[22:23], v[240:241], v[242:243]
    v_pk_fma_f32 v[36:37], v[36:37], v[240:241], v[242:243]
    v_pk_fma_f32 v[38:39], v[38:39], v[240:241], v[242:243]
    v_pk_fma_f32 v[52:53], v[52:53], v[240:241], v[242:243]
    v_pk_fma_f32 v[54:55], v[54:55], v[240:241], v[242:243]
    v_cvt_pk_bf16_f32 v192, v4, v6
    v_cvt_pk_bf16_f32 v193, v20, v22
    v_cvt_pk_bf16_f32 v194, v36, v38
    v_cvt_pk_bf16_f32 v195, v52, v54
    ds_write_b128 v211, v[192:195] offset:32768
    v_cvt_pk_bf16_f32 v196, v5, v7
    v_cvt_pk_bf16_f32 v197, v21, v23
    v_cvt_pk_bf16_f32 v198, v37, v39
    v_cvt_pk_bf16_f32 v199, v53, v55
    ds_write_b128 v211, v[196:199] offset:45056
    v_pk_fma_f32 v[8:9], v[8:9], v[244:245], v[246:247]
    v_pk_fma_f32 v[10:11], v[10:11], v[244:245], v[246:247]
    v_pk_fma_f32 v[24:25], v[24:25], v[244:245], v[246:247]
    v_pk_fma_f32 v[26:27], v[26:27], v[244:245], v[246:247]
    v_pk_fma_f32 v[40:41], v[40:41], v[244:245], v[246:247]
    v_pk_fma_f32 v[42:43], v[42:43], v[244:245], v[246:247]
    v_pk_fma_f32 v[56:57], v[56:57], v[244:245], v[246:247]
    v_pk_fma_f32 v[58:59], v[58:59], v[244:245], v[246:247]
    v_cvt_pk_bf16_f32 v192, v8, v10
    v_cvt_pk_bf16_f32 v193, v24, v26
    v_cvt_pk_bf16_f32 v194, v40, v42
    v_cvt_pk_bf16_f32 v195, v56, v58
    ds_write_b128 v209, v[192:195] offset:8192
    v_cvt_pk_bf16_f32 v196, v9, v11
    v_cvt_pk_bf16_f32 v197, v25, v27
    v_cvt_pk_bf16_f32 v198, v41, v43
    v_cvt_pk_bf16_f32 v199, v57, v59
    ds_write_b128 v209, v[196:199] offset:20480
    v_pk_fma_f32 v[12:13], v[12:13], v[248:249], v[250:251]
    v_pk_fma_f32 v[14:15], v[14:15], v[248:249], v[250:251]
    v_pk_fma_f32 v[28:29], v[28:29], v[248:249], v[250:251]
    v_pk_fma_f32 v[30:31], v[30:31], v[248:249], v[250:251]
    v_pk_fma_f32 v[44:45], v[44:45], v[248:249], v[250:251]
    v_pk_fma_f32 v[46:47], v[46:47], v[248:249], v[250:251]
    v_pk_fma_f32 v[60:61], v[60:61], v[248:249], v[250:251]
    v_pk_fma_f32 v[62:63], v[62:63], v[248:249], v[250:251]
    v_cvt_pk_bf16_f32 v192, v12, v14
    v_cvt_pk_bf16_f32 v193, v28, v30
    v_cvt_pk_bf16_f32 v194, v44, v46
    v_cvt_pk_bf16_f32 v195, v60, v62
    ds_write_b128 v209, v[192:195] offset:32768
    v_cvt_pk_bf16_f32 v196, v13, v15
    v_cvt_pk_bf16_f32 v197, v29, v31
    v_cvt_pk_bf16_f32 v198, v45, v47
    v_cvt_pk_bf16_f32 v199, v61, v63
    ds_write_b128 v209, v[196:199] offset:45056
    s_waitcnt vmcnt(3) lgkmcnt(0)
    s_barrier
    v_add_u32 v210, s47, v200
    ds_read_b128 a[192:195], v202 offset:0
    ds_read_b128 a[196:199], v202 offset:1024
    ds_read_b128 a[200:203], v202 offset:2048
    ds_read_b128 a[204:207], v202 offset:3072
    ds_read_b128 v[0:3], v210 offset:0
    ds_read_b128 v[48:51], v210 offset:12288
    ds_read_b128 v[4:7], v210 offset:1024
    ds_read_b128 v[52:55], v210 offset:13312
    ds_read_b128 v[8:11], v210 offset:2048
    ds_read_b128 v[56:59], v210 offset:14336
    ds_read_b128 v[12:15], v210 offset:3072
    ds_read_b128 v[60:63], v210 offset:15360
    ds_read_b128 a[208:211], v202 offset:4096
    ds_read_b128 a[212:215], v202 offset:5120
    ds_read_b128 a[216:219], v202 offset:6144
    ds_read_b128 a[220:223], v202 offset:7168
    ds_read_b128 v[16:19], v210 offset:4096
    ds_read_b128 v[64:67], v210 offset:16384
    ds_read_b128 v[20:23], v210 offset:5120
    ds_read_b128 v[68:71], v210 offset:17408
    ds_read_b128 v[24:27], v210 offset:6144
    ds_read_b128 v[72:75], v210 offset:18432
    ds_read_b128 v[28:31], v210 offset:7168
    ds_read_b128 v[76:79], v210 offset:19456
    ds_read_b128 v[32:35], v210 offset:8192
    ds_read_b128 v[80:83], v210 offset:20480
    ds_read_b128 v[36:39], v210 offset:9216
    ds_read_b128 v[84:87], v210 offset:21504
    ds_read_b128 v[40:43], v210 offset:10240
    ds_read_b128 v[88:91], v210 offset:22528
    ds_read_b128 v[44:47], v210 offset:11264
    ds_read_b128 v[92:95], v210 offset:23552
    s_waitcnt lgkmcnt(15)
    v_mfma_f32_16x16x32_bf16 v[160:163], a[192:195], v[0:3], 0
    ds_read_b128 a[224:227], v202 offset:8192
    v_mfma_f32_16x16x32_bf16 v[160:163], a[196:199], v[4:7], v[160:163]
    s_add_u32 m0, s24, 135168
    v_mfma_f32_16x16x32_bf16 v[160:163], a[200:203], v[8:11], v[160:163]
    ds_read_b128 a[228:231], v202 offset:9216
    v_mfma_f32_16x16x32_bf16 v[160:163], a[204:207], v[12:15], v[160:163]
    s_mov_b32 s25, 73728
    v_mfma_f32_16x16x32_bf16 v[164:167], a[204:207], v[60:63], 0
    ds_read_b128 a[232:235], v202 offset:10240
    v_mfma_f32_16x16x32_bf16 v[164:167], a[200:203], v[56:59], v[164:167]
    buffer_load_dwordx4 v203, s[8:11], s25 offen offset:0 lds
    v_mfma_f32_16x16x32_bf16 v[164:167], a[196:199], v[52:55], v[164:167]
    ds_read_b128 a[236:239], v202 offset:11264
    v_mfma_f32_16x16x32_bf16 v[164:167], a[192:195], v[48:51], v[164:167]
    buffer_load_dwordx4 v203, s[8:11], s25 offen offset:1024 lds
    v_mfma_f32_16x16x32_bf16 v[160:163], a[208:211], v[16:19], v[160:163]
    ds_read_b128 a[192:195], v202 offset:12288
    s_waitcnt lgkmcnt(15)
    v_mfma_f32_16x16x32_bf16 v[160:163], a[212:215], v[20:23], v[160:163]
    buffer_load_dwordx4 v203, s[8:11], s25 offen offset:2048 lds
    v_mfma_f32_16x16x32_bf16 v[160:163], a[216:219], v[24:27], v[160:163]
    ds_read_b128 a[196:199], v202 offset:13312
    s_waitcnt lgkmcnt(15)
    v_mfma_f32_16x16x32_bf16 v[160:163], a[220:223], v[28:31], v[160:163]
    s_add_u32 m0, s24, 147456
    s_waitcnt lgkmcnt(14)
    v_mfma_f32_16x16x32_bf16 v[164:167], a[220:223], v[76:79], v[164:167]
    ds_read_b128 a[200:203], v202 offset:14336
    v_mfma_f32_16x16x32_bf16 v[164:167], a[216:219], v[72:75], v[164:167]
    s_mov_b32 s25, 98304
    v_mfma_f32_16x16x32_bf16 v[164:167], a[212:215], v[68:71], v[164:167]
    ds_read_b128 a[204:207], v202 offset:15360
    v_mfma_f32_16x16x32_bf16 v[164:167], a[208:211], v[64:67], v[164:167]
    s_waitcnt lgkmcnt(4)
    v_mfma_f32_16x16x32_bf16 v[160:163], a[224:227], v[32:35], v[160:163]
    ds_read_b128 a[208:211], v202 offset:16384
    v_mfma_f32_16x16x32_bf16 v[160:163], a[228:231], v[36:39], v[160:163]
    buffer_load_dwordx4 v203, s[8:11], s25 offen offset:0 lds
    v_mfma_f32_16x16x32_bf16 v[160:163], a[232:235], v[40:43], v[160:163]
    ds_read_b128 a[212:215], v202 offset:17408
    v_mfma_f32_16x16x32_bf16 v[160:163], a[236:239], v[44:47], v[160:163]
    buffer_load_dwordx4 v203, s[8:11], s25 offen offset:1024 lds
    v_mfma_f32_16x16x32_bf16 v[164:167], a[236:239], v[92:95], v[164:167]
    ds_read_b128 a[216:219], v202 offset:18432
    v_mfma_f32_16x16x32_bf16 v[164:167], a[232:235], v[88:91], v[164:167]
    buffer_load_dwordx4 v203, s[8:11], s25 offen offset:2048 lds
    v_mfma_f32_16x16x32_bf16 v[164:167], a[228:231], v[84:87], v[164:167]
    ds_read_b128 a[220:223], v202 offset:19456
    v_mfma_f32_16x16x32_bf16 v[164:167], a[224:227], v[80:83], v[164:167]
    s_waitcnt vmcnt(6)
    s_barrier
    s_waitcnt lgkmcnt(4)
    v_mfma_f32_16x16x32_bf16 v[168:171], a[192:195], v[0:3], 0
    ds_read_b128 a[224:227], v202 offset:20480
    s_add_u32 m0, s24, 0
    v_mfma_f32_16x16x32_bf16 v[168:171], a[196:199], v[4:7], v[168:171]
    s_mov_b32 s25, 122880
    v_mfma_f32_16x16x32_bf16 v[168:171], a[200:203], v[8:11], v[168:171]
    ds_read_b128 a[228:231], v202 offset:21504
    buffer_load_dwordx4 v203, s[8:11], s25 offen offset:0 lds
    v_fma_f32 v176, v160, v160, s27
    v_fma_f32 v177, v161, v161, s27
    v_fma_f32 v178, v162, v162, s27
    v_fma_f32 v179, v163, v163, s27
    v_mfma_f32_16x16x32_bf16 v[168:171], a[204:207], v[12:15], v[168:171]
    buffer_load_dwordx4 v203, s[8:11], s25 offen offset:1024 lds
    v_fma_f32 v180, v164, v164, s27
    v_fma_f32 v181, v165, v165, s27
    v_fma_f32 v182, v166, v166, s27
    v_fma_f32 v183, v167, v167, s27
    v_mfma_f32_16x16x32_bf16 v[172:175], a[204:207], v[60:63], 0
    ds_read_b128 a[232:235], v202 offset:22528
    buffer_load_dwordx4 v203, s[8:11], s25 offen offset:2048 lds
    v_mul_f32 v176, v176, v160
    v_mul_f32 v177, v177, v161
    v_mul_f32 v178, v178, v162
    v_mfma_f32_16x16x32_bf16 v[172:175], a[200:203], v[56:59], v[172:175]
    s_add_u32 m0, s24, 24576
    v_mul_f32 v179, v179, v163
    v_mul_f32 v180, v180, v164
    v_mul_f32 v181, v181, v165
    v_mfma_f32_16x16x32_bf16 v[172:175], a[196:199], v[52:55], v[172:175]
    ds_read_b128 a[236:239], v202 offset:23552
    v_mul_f32 v182, v182, v166
    v_mul_f32 v183, v183, v167
    v_mfma_f32_16x16x32_bf16 v[172:175], a[192:195], v[48:51], v[172:175]
    s_mov_b32 s25, 147456
    v_exp_f32 v176, v176
    v_exp_f32 v177, v177
    s_waitcnt lgkmcnt(4)
    v_mfma_f32_16x16x32_bf16 v[168:171], a[208:211], v[16:19], v[168:171]
    ds_read_b128 a[192:195], v202 offset:24576
    buffer_load_dwordx4 v203, s[8:11], s25 offen offset:0 lds
    v_exp_f32 v178, v178
    v_mfma_f32_16x16x32_bf16 v[168:171], a[212:215], v[20:23], v[168:171]
    buffer_load_dwordx4 v203, s[8:11], s25 offen offset:1024 lds
    v_exp_f32 v179, v179
    v_exp_f32 v180, v180
    v_mfma_f32_16x16x32_bf16 v[168:171], a[216:219], v[24:27], v[168:171]
    ds_read_b128 a[196:199], v202 offset:25600
    buffer_load_dwordx4 v203, s[8:11], s25 offen offset:2048 lds
    v_exp_f32 v181, v181
    v_mfma_f32_16x16x32_bf16 v[168:171], a[220:223], v[28:31], v[168:171]
    s_add_u32 m0, s24, 12288
    v_exp_f32 v182, v182
    v_exp_f32 v183, v183
    v_mfma_f32_16x16x32_bf16 v[172:175], a[220:223], v[76:79], v[172:175]
    ds_read_b128 a[200:203], v202 offset:26624
    v_fma_f32 v176, v176, s28, s28
    v_fma_f32 v177, v177, s28, s28
    v_fma_f32 v178, v178, s28, s28
    v_mfma_f32_16x16x32_bf16 v[172:175], a[216:219], v[72:75], v[172:175]
    s_add_u32 s35, s23, 0
    v_fma_f32 v179, v179, s28, s28
    v_fma_f32 v180, v180, s28, s28
    v_fma_f32 v181, v181, s28, s28
    v_mfma_f32_16x16x32_bf16 v[172:175], a[212:215], v[68:71], v[172:175]
    ds_read_b128 a[204:207], v202 offset:27648
    v_fma_f32 v182, v182, s28, s28
    v_fma_f32 v183, v183, s28, s28
    v_mfma_f32_16x16x32_bf16 v[172:175], a[208:211], v[64:67], v[172:175]
    buffer_load_dwordx4 v204, s[4:7], s35 offen lds
    v_rcp_f32 v176, v176
    v_rcp_f32 v177, v177
    s_waitcnt lgkmcnt(4)
    v_mfma_f32_16x16x32_bf16 v[168:171], a[224:227], v[32:35], v[168:171]
    ds_read_b128 a[208:211], v202 offset:28672
    s_add_u32 m0, s24, 13312
    v_rcp_f32 v178, v178
    v_mfma_f32_16x16x32_bf16 v[168:171], a[228:231], v[36:39], v[168:171]
    s_add_u32 s35, s23, 0
    v_rcp_f32 v179, v179
    v_rcp_f32 v180, v180
    v_mfma_f32_16x16x32_bf16 v[168:171], a[232:235], v[40:43], v[168:171]
    ds_read_b128 a[212:215], v202 offset:29696
    buffer_load_dwordx4 v205, s[4:7], s35 offen lds
    v_rcp_f32 v181, v181
    v_mfma_f32_16x16x32_bf16 v[168:171], a[236:239], v[44:47], v[168:171]
    s_add_u32 m0, s24, 14336
    v_rcp_f32 v182, v182
    v_rcp_f32 v183, v183
    v_mfma_f32_16x16x32_bf16 v[172:175], a[236:239], v[92:95], v[172:175]
    ds_read_b128 a[216:219], v202 offset:30720
    v_mul_f32 v176, v176, v160
    v_mul_f32 v177, v177, v161
    v_mul_f32 v178, v178, v162
    v_mfma_f32_16x16x32_bf16 v[172:175], a[232:235], v[88:91], v[172:175]
    s_add_u32 s35, s23, 64
    v_mul_f32 v179, v179, v163
    v_mul_f32 v180, v180, v164
    v_mul_f32 v181, v181, v165
    v_mfma_f32_16x16x32_bf16 v[172:175], a[228:231], v[84:87], v[172:175]
    ds_read_b128 a[220:223], v202 offset:31744
    v_mul_f32 v182, v182, v166
    v_mul_f32 v183, v183, v167
    v_cvt_pk_bf16_f32 v96, v176, v177
    v_mfma_f32_16x16x32_bf16 v[172:175], a[224:227], v[80:83], v[172:175]
    buffer_load_dwordx4 v204, s[4:7], s35 offen lds
    v_cvt_pk_bf16_f32 v97, v178, v179
    v_cvt_pk_bf16_f32 v112, v180, v181
    v_cvt_pk_bf16_f32 v113, v182, v183
    s_waitcnt vmcnt(12)
    s_barrier
    s_waitcnt lgkmcnt(4)
    v_mfma_f32_16x16x32_bf16 v[160:163], a[192:195], v[0:3], 0
    ds_read_b128 a[224:227], v202 offset:32768
    s_add_u32 m0, s24, 49152
    v_mfma_f32_16x16x32_bf16 v[160:163], a[196:199], v[4:7], v[160:163]
    s_mov_b32 s25, 172032
    v_mfma_f32_16x16x32_bf16 v[160:163], a[200:203], v[8:11], v[160:163]
    ds_read_b128 a[228:231], v202 offset:33792
    buffer_load_dwordx4 v203, s[8:11], s25 offen offset:0 lds
    v_fma_f32 v176, v168, v168, s27
    v_fma_f32 v177, v169, v169, s27
    v_fma_f32 v178, v170, v170, s27
    v_fma_f32 v179, v171, v171, s27
    v_mfma_f32_16x16x32_bf16 v[160:163], a[204:207], v[12:15], v[160:163]
    buffer_load_dwordx4 v203, s[8:11], s25 offen offset:1024 lds
    v_fma_f32 v180, v172, v172, s27
    v_fma_f32 v181, v173, v173, s27
    v_fma_f32 v182, v174, v174, s27
    v_fma_f32 v183, v175, v175, s27
    v_mfma_f32_16x16x32_bf16 v[164:167], a[204:207], v[60:63], 0
    ds_read_b128 a[232:235], v202 offset:34816
    buffer_load_dwordx4 v203, s[8:11], s25 offen offset:2048 lds
    v_mul_f32 v176, v176, v168
    v_mul_f32 v177, v177, v169
    v_mul_f32 v178, v178, v170
    v_mfma_f32_16x16x32_bf16 v[164:167], a[200:203], v[56:59], v[164:167]
    s_add_u32 m0, s24, 73728
    v_mul_f32 v179, v179, v171
    v_mul_f32 v180, v180, v172
    v_mul_f32 v181, v181, v173
    v_mfma_f32_16x16x32_bf16 v[164:167], a[196:199], v[52:55], v[164:167]
    ds_read_b128 a[236:239], v202 offset:35840
    v_mul_f32 v182, v182, v174
    v_mul_f32 v183, v183, v175
    v_mfma_f32_16x16x32_bf16 v[164:167], a[192:195], v[48:51], v[164:167]
    s_mov_b32 s25, 196608
    v_exp_f32 v176, v176
    v_exp_f32 v177, v177
    s_waitcnt lgkmcnt(4)
    v_mfma_f32_16x16x32_bf16 v[160:163], a[208:211], v[16:19], v[160:163]
    ds_read_b128 a[192:195], v202 offset:36864
    buffer_load_dwordx4 v203, s[8:11], s25 offen offset:0 lds
    v_exp_f32 v178, v178
    v_mfma_f32_16x16x32_bf16 v[160:163], a[212:215], v[20:23], v[160:163]
    buffer_load_dwordx4 v203, s[8:11], s25 offen offset:1024 lds
    v_exp_f32 v179, v179
    v_exp_f32 v180, v180
    v_mfma_f32_16x16x32_bf16 v[160:163], a[216:219], v[24:27], v[160:163]
    ds_read_b128 a[196:199], v202 offset:37888
    buffer_load_dwordx4 v203, s[8:11], s25 offen offset:2048 lds
    v_exp_f32 v181, v181
    v_mfma_f32_16x16x32_bf16 v[160:163], a[220:223], v[28:31], v[160:163]
    s_add_u32 m0, s24, 36864
    v_exp_f32 v182, v182
    v_exp_f32 v183, v183
    v_mfma_f32_16x16x32_bf16 v[164:167], a[220:223], v[76:79], v[164:167]
    ds_read_b128 a[200:203], v202 offset:38912
    v_fma_f32 v176, v176, s28, s28
    v_fma_f32 v177, v177, s28, s28
    v_fma_f32 v178, v178, s28, s28
    v_mfma_f32_16x16x32_bf16 v[164:167], a[216:219], v[72:75], v[164:167]
    s_add_u32 s35, s23, 64
    v_fma_f32 v179, v179, s28, s28
    v_fma_f32 v180, v180, s28, s28
    v_fma_f32 v181, v181, s28, s28
    v_mfma_f32_16x16x32_bf16 v[164:167], a[212:215], v[68:71], v[164:167]
    ds_read_b128 a[204:207], v202 offset:39936
    v_fma_f32 v182, v182, s28, s28
    v_fma_f32 v183, v183, s28, s28
    v_mfma_f32_16x16x32_bf16 v[164:167], a[208:211], v[64:67], v[164:167]
    buffer_load_dwordx4 v205, s[4:7], s35 offen lds
    v_rcp_f32 v176, v176
    v_rcp_f32 v177, v177
    s_waitcnt lgkmcnt(4)
    v_mfma_f32_16x16x32_bf16 v[160:163], a[224:227], v[32:35], v[160:163]
    ds_read_b128 a[208:211], v202 offset:40960
    s_add_u32 m0, s24, 37888
    v_rcp_f32 v178, v178
    v_mfma_f32_16x16x32_bf16 v[160:163], a[228:231], v[36:39], v[160:163]
    s_add_u32 s35, s23, 128
    v_rcp_f32 v179, v179
    v_rcp_f32 v180, v180
    v_mfma_f32_16x16x32_bf16 v[160:163], a[232:235], v[40:43], v[160:163]
    ds_read_b128 a[212:215], v202 offset:41984
    buffer_load_dwordx4 v204, s[4:7], s35 offen lds
    v_rcp_f32 v181, v181
    v_mfma_f32_16x16x32_bf16 v[160:163], a[236:239], v[44:47], v[160:163]
    s_add_u32 m0, s24, 38912
    v_rcp_f32 v182, v182
    v_rcp_f32 v183, v183
    v_mfma_f32_16x16x32_bf16 v[164:167], a[236:239], v[92:95], v[164:167]
    ds_read_b128 a[216:219], v202 offset:43008
    v_mul_f32 v176, v176, v168
    v_mul_f32 v177, v177, v169
    v_mul_f32 v178, v178, v170
    v_mfma_f32_16x16x32_bf16 v[164:167], a[232:235], v[88:91], v[164:167]
    s_add_u32 s35, s23, 128
    v_mul_f32 v179, v179, v171
    v_mul_f32 v180, v180, v172
    v_mul_f32 v181, v181, v173
    v_mfma_f32_16x16x32_bf16 v[164:167], a[228:231], v[84:87], v[164:167]
    ds_read_b128 a[220:223], v202 offset:44032
    v_mul_f32 v182, v182, v174
    v_mul_f32 v183, v183, v175
    v_cvt_pk_bf16_f32 v98, v176, v177
    v_mfma_f32_16x16x32_bf16 v[164:167], a[224:227], v[80:83], v[164:167]
    buffer_load_dwordx4 v205, s[4:7], s35 offen lds
    v_cvt_pk_bf16_f32 v99, v178, v179
    v_cvt_pk_bf16_f32 v114, v180, v181
    v_cvt_pk_bf16_f32 v115, v182, v183
    s_waitcnt vmcnt(18)
    s_barrier
    s_waitcnt lgkmcnt(4)
    v_mfma_f32_16x16x32_bf16 v[168:171], a[192:195], v[0:3], 0
    ds_read_b128 a[224:227], v202 offset:45056
    v_mfma_f32_16x16x32_bf16 v[168:171], a[196:199], v[4:7], v[168:171]
    v_mfma_f32_16x16x32_bf16 v[168:171], a[200:203], v[8:11], v[168:171]
    ds_read_b128 a[228:231], v202 offset:46080
    v_fma_f32 v176, v160, v160, s27
    v_fma_f32 v177, v161, v161, s27
    v_fma_f32 v178, v162, v162, s27
    v_fma_f32 v179, v163, v163, s27
    v_mfma_f32_16x16x32_bf16 v[168:171], a[204:207], v[12:15], v[168:171]
    s_nop 0
    v_fma_f32 v180, v164, v164, s27
    v_fma_f32 v181, v165, v165, s27
    v_fma_f32 v182, v166, v166, s27
    v_fma_f32 v183, v167, v167, s27
    v_mfma_f32_16x16x32_bf16 v[172:175], a[204:207], v[60:63], 0
    ds_read_b128 a[232:235], v202 offset:47104
    v_mul_f32 v176, v176, v160
    v_mul_f32 v177, v177, v161
    v_mul_f32 v178, v178, v162
    v_mul_f32 v179, v179, v163
    v_mfma_f32_16x16x32_bf16 v[172:175], a[200:203], v[56:59], v[172:175]
    s_nop 0
    v_mul_f32 v180, v180, v164
    v_mul_f32 v181, v181, v165
    v_mul_f32 v182, v182, v166
    v_mul_f32 v183, v183, v167
    v_mfma_f32_16x16x32_bf16 v[172:175], a[196:199], v[52:55], v[172:175]
    ds_read_b128 a[236:239], v202 offset:48128
    v_exp_f32 v176, v176
    v_exp_f32 v177, v177
    v_mfma_f32_16x16x32_bf16 v[172:175], a[192:195], v[48:51], v[172:175]
    v_exp_f32 v178, v178
    v_exp_f32 v179, v179
    s_waitcnt lgkmcnt(4)
    v_mfma_f32_16x16x32_bf16 v[168:171], a[208:211], v[16:19], v[168:171]
    ds_read_b128 a[192:195], v202 offset:49152
    v_exp_f32 v180, v180
    v_exp_f32 v181, v181
    v_mfma_f32_16x16x32_bf16 v[168:171], a[212:215], v[20:23], v[168:171]
    v_exp_f32 v182, v182
    v_exp_f32 v183, v183
    v_mfma_f32_16x16x32_bf16 v[168:171], a[216:219], v[24:27], v[168:171]
    ds_read_b128 a[196:199], v202 offset:50176
    v_fma_f32 v176, v176, s28, s28
    v_fma_f32 v177, v177, s28, s28
    v_fma_f32 v178, v178, s28, s28
    v_fma_f32 v179, v179, s28, s28
    v_mfma_f32_16x16x32_bf16 v[168:171], a[220:223], v[28:31], v[168:171]
    s_nop 0
    v_fma_f32 v180, v180, s28, s28
    v_fma_f32 v181, v181, s28, s28
    v_fma_f32 v182, v182, s28, s28
    v_fma_f32 v183, v183, s28, s28
    v_mfma_f32_16x16x32_bf16 v[172:175], a[220:223], v[76:79], v[172:175]
    ds_read_b128 a[200:203], v202 offset:51200
    v_rcp_f32 v176, v176
    v_rcp_f32 v177, v177
    v_mfma_f32_16x16x32_bf16 v[172:175], a[216:219], v[72:75], v[172:175]
    v_rcp_f32 v178, v178
    v_mfma_f32_16x16x32_bf16 v[172:175], a[212:215], v[68:71], v[172:175]
    ds_read_b128 a[204:207], v202 offset:52224
    v_rcp_f32 v179, v179
    v_rcp_f32 v180, v180
    v_mfma_f32_16x16x32_bf16 v[172:175], a[208:211], v[64:67], v[172:175]
    v_rcp_f32 v181, v181
    s_waitcnt lgkmcnt(4)
    v_mfma_f32_16x16x32_bf16 v[168:171], a[224:227], v[32:35], v[168:171]
    ds_read_b128 a[208:211], v202 offset:53248
    v_rcp_f32 v182, v182
    v_rcp_f32 v183, v183
    v_mfma_f32_16x16x32_bf16 v[168:171], a[228:231], v[36:39], v[168:171]
    s_nop 0
    v_mul_f32 v176, v176, v160
    v_mul_f32 v177, v177, v161
    v_mul_f32 v178, v178, v162
    v_mfma_f32_16x16x32_bf16 v[168:171], a[232:235], v[40:43], v[168:171]
    ds_read_b128 a[212:215], v202 offset:54272
    v_mul_f32 v179, v179, v163
    v_mul_f32 v180, v180, v164
    v_mul_f32 v181, v181, v165
    v_mfma_f32_16x16x32_bf16 v[168:171], a[236:239], v[44:47], v[168:171]
    s_nop 0
    v_mul_f32 v182, v182, v166
    v_mul_f32 v183, v183, v167
    v_cvt_pk_bf16_f32 v100, v176, v177
    v_mfma_f32_16x16x32_bf16 v[172:175], a[236:239], v[92:95], v[172:175]
    ds_read_b128 a[216:219], v202 offset:55296
    v_cvt_pk_bf16_f32 v101, v178, v179
    v_cvt_pk_bf16_f32 v116, v180, v181
    v_cvt_pk_bf16_f32 v117, v182, v183
    v_mfma_f32_16x16x32_bf16 v[172:175], a[232:235], v[88:91], v[172:175]
    s_nop 0
    v_and_b32 v184, 15, v252
    v_lshrrev_b32 v185, 4, v252
    v_lshrrev_b32 v186, 3, v184
    v_mfma_f32_16x16x32_bf16 v[172:175], a[228:231], v[84:87], v[172:175]
    ds_read_b128 a[220:223], v202 offset:56320
    v_lshlrev_b32 v186, 1, v186
    v_xor_b32 v185, v185, v186
    v_lshlrev_b32 v185, 4, v185
    v_mfma_f32_16x16x32_bf16 v[172:175], a[224:227], v[80:83], v[172:175]
    s_nop 0
    v_lshl_add_u32 v185, v184, 6, v185
    v_add_u32 v199, s32, v185
    v_add_u32 v198, s24, v185
    s_waitcnt vmcnt(15)
    s_barrier
    s_waitcnt lgkmcnt(4)
    v_mfma_f32_16x16x32_bf16 v[160:163], a[192:195], v[0:3], 0
    ds_read_b128 a[224:227], v202 offset:57344
    v_mfma_f32_16x16x32_bf16 v[160:163], a[196:199], v[4:7], v[160:163]
    s_waitcnt vmcnt(11)
    v_mfma_f32_16x16x32_bf16 v[160:163], a[200:203], v[8:11], v[160:163]
    ds_read_b128 a[228:231], v202 offset:58368
    v_fma_f32 v176, v168, v168, s27
    v_fma_f32 v177, v169, v169, s27
    v_fma_f32 v178, v170, v170, s27
    v_fma_f32 v179, v171, v171, s27
    v_mfma_f32_16x16x32_bf16 v[160:163], a[204:207], v[12:15], v[160:163]
    ds_read_b128 a[0:3], v198 offset:12288
    v_fma_f32 v180, v172, v172, s27
    v_fma_f32 v181, v173, v173, s27
    v_fma_f32 v182, v174, v174, s27
    v_fma_f32 v183, v175, v175, s27
    v_mfma_f32_16x16x32_bf16 v[164:167], a[204:207], v[60:63], 0
    ds_read_b128 a[232:235], v202 offset:59392
    v_mul_f32 v176, v176, v168
    v_mul_f32 v177, v177, v169
    v_mul_f32 v178, v178, v170
    v_mfma_f32_16x16x32_bf16 v[164:167], a[200:203], v[56:59], v[164:167]
    s_nop 0
    v_mul_f32 v179, v179, v171
    v_mul_f32 v180, v180, v172
    v_mul_f32 v181, v181, v173
    v_mfma_f32_16x16x32_bf16 v[164:167], a[196:199], v[52:55], v[164:167]
    ds_read_b128 a[236:239], v202 offset:60416
    v_mul_f32 v182, v182, v174
    v_mul_f32 v183, v183, v175
    v_mfma_f32_16x16x32_bf16 v[164:167], a[192:195], v[48:51], v[164:167]
    v_exp_f32 v176, v176
    v_exp_f32 v177, v177
    s_waitcnt lgkmcnt(5)
    v_mfma_f32_16x16x32_bf16 v[160:163], a[208:211], v[16:19], v[160:163]
    ds_read_b128 a[192:195], v200 offset:0
    v_exp_f32 v178, v178
    v_mfma_f32_16x16x32_bf16 v[160:163], a[212:215], v[20:23], v[160:163]
    s_waitcnt vmcnt(10)
    v_exp_f32 v179, v179
    v_exp_f32 v180, v180
    v_mfma_f32_16x16x32_bf16 v[160:163], a[216:219], v[24:27], v[160:163]
    ds_read_b128 a[196:199], v200 offset:1024
    v_exp_f32 v181, v181
    v_mfma_f32_16x16x32_bf16 v[160:163], a[220:223], v[28:31], v[160:163]
    ds_read_b128 a[4:7], v198 offset:13312
    v_exp_f32 v182, v182
    v_exp_f32 v183, v183
    v_mfma_f32_16x16x32_bf16 v[164:167], a[220:223], v[76:79], v[164:167]
    ds_read_b128 a[200:203], v200 offset:2048
    v_fma_f32 v176, v176, s28, s28
    v_fma_f32 v177, v177, s28, s28
    v_fma_f32 v178, v178, s28, s28
    v_mfma_f32_16x16x32_bf16 v[164:167], a[216:219], v[72:75], v[164:167]
    s_nop 0
    v_fma_f32 v179, v179, s28, s28
    v_fma_f32 v180, v180, s28, s28
    v_fma_f32 v181, v181, s28, s28
    v_mfma_f32_16x16x32_bf16 v[164:167], a[212:215], v[68:71], v[164:167]
    ds_read_b128 a[204:207], v200 offset:3072
    v_fma_f32 v182, v182, s28, s28
    v_fma_f32 v183, v183, s28, s28
    v_mfma_f32_16x16x32_bf16 v[164:167], a[208:211], v[64:67], v[164:167]
    v_rcp_f32 v176, v176
    v_rcp_f32 v177, v177
    s_waitcnt lgkmcnt(5)
    v_mfma_f32_16x16x32_bf16 v[160:163], a[224:227], v[32:35], v[160:163]
    ds_read_b128 a[208:211], v200 offset:4096
    v_rcp_f32 v178, v178
    v_mfma_f32_16x16x32_bf16 v[160:163], a[228:231], v[36:39], v[160:163]
    s_waitcnt vmcnt(9)
    v_rcp_f32 v179, v179
    v_rcp_f32 v180, v180
    v_mfma_f32_16x16x32_bf16 v[160:163], a[232:235], v[40:43], v[160:163]
    ds_read_b128 a[212:215], v200 offset:5120
    v_rcp_f32 v181, v181
    v_mfma_f32_16x16x32_bf16 v[160:163], a[236:239], v[44:47], v[160:163]
    ds_read_b128 a[16:19], v198 offset:14336
    v_rcp_f32 v182, v182
    v_rcp_f32 v183, v183
    v_mfma_f32_16x16x32_bf16 v[164:167], a[236:239], v[92:95], v[164:167]
    ds_read_b128 a[216:219], v200 offset:6144
    v_mul_f32 v176, v176, v168
    v_mul_f32 v177, v177, v169
    v_mul_f32 v178, v178, v170
    v_mfma_f32_16x16x32_bf16 v[164:167], a[232:235], v[88:91], v[164:167]
    s_nop 0
    v_mul_f32 v179, v179, v171
    v_mul_f32 v180, v180, v172
    v_mul_f32 v181, v181, v173
    v_mfma_f32_16x16x32_bf16 v[164:167], a[228:231], v[84:87], v[164:167]
    ds_read_b128 a[220:223], v200 offset:7168
    v_mul_f32 v182, v182, v174
    v_mul_f32 v183, v183, v175
    v_cvt_pk_bf16_f32 v102, v176, v177
    v_mfma_f32_16x16x32_bf16 v[164:167], a[224:227], v[80:83], v[164:167]
    s_nop 0
    v_cvt_pk_bf16_f32 v103, v178, v179
    v_cvt_pk_bf16_f32 v118, v180, v181
    v_cvt_pk_bf16_f32 v119, v182, v183
    s_barrier
    s_waitcnt lgkmcnt(5)
    v_mfma_f32_16x16x32_bf16 v[168:171], a[192:195], v[0:3], 0
    ds_read_b128 a[224:227], v200 offset:8192
    s_add_u32 m0, s32, 0
    v_mfma_f32_16x16x32_bf16 v[168:171], a[196:199], v[4:7], v[168:171]
    s_add_u32 s35, s23, 192
    v_mfma_f32_16x16x32_bf16 v[168:171], a[200:203], v[8:11], v[168:171]
    ds_read_b128 a[228:231], v200 offset:9216
    buffer_load_dwordx4 v204, s[4:7], s35 offen lds
    v_fma_f32 v176, v160, v160, s27
    v_fma_f32 v177, v161, v161, s27
    v_fma_f32 v178, v162, v162, s27
    v_mfma_f32_16x16x32_bf16 v[168:171], a[204:207], v[12:15], v[168:171]
    s_add_u32 m0, s32, 1024
    v_fma_f32 v179, v163, v163, s27
    v_fma_f32 v180, v164, v164, s27
    v_fma_f32 v181, v165, v165, s27
    v_mfma_f32_16x16x32_bf16 v[172:175], a[204:207], v[60:63], 0
    ds_read_b128 a[232:235], v200 offset:10240
    v_fma_f32 v182, v166, v166, s27
    v_fma_f32 v183, v167, v167, s27
    v_mul_f32 v176, v176, v160
    v_mfma_f32_16x16x32_bf16 v[172:175], a[200:203], v[56:59], v[172:175]
    s_add_u32 s35, s23, 192
    v_mul_f32 v177, v177, v161
    v_mul_f32 v178, v178, v162
    v_mul_f32 v179, v179, v163
    v_mfma_f32_16x16x32_bf16 v[172:175], a[196:199], v[52:55], v[172:175]
    ds_read_b128 a[236:239], v200 offset:11264
    v_mul_f32 v180, v180, v164
    v_mul_f32 v181, v181, v165
    v_mul_f32 v182, v182, v166
    v_mfma_f32_16x16x32_bf16 v[172:175], a[192:195], v[48:51], v[172:175]
    buffer_load_dwordx4 v205, s[4:7], s35 offen lds
    v_mul_f32 v183, v183, v167
    v_exp_f32 v176, v176
    s_waitcnt lgkmcnt(4)
    v_mfma_f32_16x16x32_bf16 v[168:171], a[208:211], v[16:19], v[168:171]
    ds_read_b128 a[192:195], v200 offset:24576
    v_exp_f32 v177, v177
    v_mfma_f32_16x16x32_bf16 v[168:171], a[212:215], v[20:23], v[168:171]
    s_add_u32 m0, s32, 2048
    v_exp_f32 v178, v178
    v_mfma_f32_16x16x32_bf16 v[168:171], a[216:219], v[24:27], v[168:171]
    s_add_u32 s35, s23, 256
    v_exp_f32 v179, v179
    v_mfma_f32_16x16x32_bf16 v[168:171], a[220:223], v[28:31], v[168:171]
    ds_read_b128 a[196:199], v200 offset:25600
    v_exp_f32 v180, v180
    v_mfma_f32_16x16x32_bf16 v[172:175], a[220:223], v[76:79], v[172:175]
    buffer_load_dwordx4 v204, s[4:7], s35 offen lds
    v_exp_f32 v181, v181
    v_mfma_f32_16x16x32_bf16 v[172:175], a[216:219], v[72:75], v[172:175]
    s_add_u32 m0, s32, 3072
    v_exp_f32 v182, v182
    v_mfma_f32_16x16x32_bf16 v[172:175], a[212:215], v[68:71], v[172:175]
    ds_read_b128 a[200:203], v200 offset:26624
    v_exp_f32 v183, v183
    v_fma_f32 v176, v176, s28, s28
    v_mfma_f32_16x16x32_bf16 v[172:175], a[208:211], v[64:67], v[172:175]
    s_add_u32 s35, s23, 256
    v_fma_f32 v177, v177, s28, s28
    v_fma_f32 v178, v178, s28, s28
    v_fma_f32 v179, v179, s28, s28
    s_waitcnt lgkmcnt(3)
    v_mfma_f32_16x16x32_bf16 v[168:171], a[224:227], v[32:35], v[168:171]
    ds_read_b128 a[204:207], v200 offset:27648
    v_fma_f32 v180, v180, s28, s28
    v_fma_f32 v181, v181, s28, s28
    v_fma_f32 v182, v182, s28, s28
    v_mfma_f32_16x16x32_bf16 v[168:171], a[228:231], v[36:39], v[168:171]
    buffer_load_dwordx4 v205, s[4:7], s35 offen lds
    v_fma_f32 v183, v183, s28, s28
    v_rcp_f32 v176, v176
    v_mfma_f32_16x16x32_bf16 v[168:171], a[232:235], v[40:43], v[168:171]
    ds_read_b128 a[208:211], v200 offset:28672
    v_rcp_f32 v177, v177
    v_mfma_f32_16x16x32_bf16 v[168:171], a[236:239], v[44:47], v[168:171]
    s_waitcnt vmcnt(6)
    v_rcp_f32 v178, v178
    v_mfma_f32_16x16x32_bf16 v[172:175], a[236:239], v[92:95], v[172:175]
    ds_read_b128 a[20:23], v198 offset:36864
    v_rcp_f32 v179, v179
    v_mfma_f32_16x16x32_bf16 v[172:175], a[232:235], v[88:91], v[172:175]
    ds_read_b128 a[212:215], v200 offset:29696
    v_rcp_f32 v180, v180
    v_mfma_f32_16x16x32_bf16 v[172:175], a[228:231], v[84:87], v[172:175]
    s_waitcnt vmcnt(5)
    v_rcp_f32 v181, v181
    v_mfma_f32_16x16x32_bf16 v[172:175], a[224:227], v[80:83], v[172:175]
    ds_read_b128 a[32:35], v198 offset:37888
    v_rcp_f32 v182, v182
    v_rcp_f32 v183, v183
    v_mfma_f32_16x16x32_bf16 a[8:11], a[244:247], a[0:3], 0
    ds_read_b128 a[216:219], v200 offset:30720
    v_mul_f32 v176, v176, v160
    v_mul_f32 v177, v177, v161
    v_mul_f32 v178, v178, v162
    v_mfma_f32_16x16x32_bf16 a[0:3], a[240:243], a[0:3], 0
    s_waitcnt vmcnt(4)
    v_mul_f32 v179, v179, v163
    v_mul_f32 v180, v180, v164
    v_mul_f32 v181, v181, v165
    v_mfma_f32_16x16x32_bf16 a[12:15], a[244:247], a[4:7], 0
    ds_read_b128 a[220:223], v200 offset:31744
    v_mul_f32 v182, v182, v166
    v_mul_f32 v183, v183, v167
    v_cvt_pk_bf16_f32 v104, v176, v177
    v_mfma_f32_16x16x32_bf16 a[4:7], a[240:243], a[4:7], 0
    ds_read_b128 a[36:39], v198 offset:38912
    v_cvt_pk_bf16_f32 v105, v178, v179
    v_cvt_pk_bf16_f32 v120, v180, v181
    v_cvt_pk_bf16_f32 v121, v182, v183
    s_barrier
    s_waitcnt lgkmcnt(7)
    v_mfma_f32_16x16x32_bf16 v[160:163], a[192:195], v[0:3], 0
    ds_read_b128 a[224:227], v200 offset:32768
    s_add_u32 m0, s24, 0
    v_mfma_f32_16x16x32_bf16 v[160:163], a[196:199], v[4:7], v[160:163]
    s_mov_b32 s25, 221184
    v_mfma_f32_16x16x32_bf16 v[160:163], a[200:203], v[8:11], v[160:163]
    ds_read_b128 a[228:231], v200 offset:33792
    buffer_load_dwordx4 v203, s[8:11], s25 offen offset:0 lds
    v_fma_f32 v176, v168, v168, s27
    v_fma_f32 v177, v169, v169, s27
    v_fma_f32 v178, v170, v170, s27
    v_mfma_f32_16x16x32_bf16 v[160:163], a[204:207], v[12:15], v[160:163]
    buffer_load_dwordx4 v203, s[8:11], s25 offen offset:1024 lds
    v_fma_f32 v179, v171, v171, s27
    v_fma_f32 v180, v172, v172, s27
    v_fma_f32 v181, v173, v173, s27
    v_mfma_f32_16x16x32_bf16 v[164:167], a[204:207], v[60:63], 0
    ds_read_b128 a[232:235], v200 offset:34816
    buffer_load_dwordx4 v203, s[8:11], s25 offen offset:2048 lds
    v_fma_f32 v182, v174, v174, s27
    v_fma_f32 v183, v175, v175, s27
    v_mul_f32 v176, v176, v168
    v_mfma_f32_16x16x32_bf16 v[164:167], a[200:203], v[56:59], v[164:167]
    s_add_u32 m0, s24, 12288
    v_mul_f32 v177, v177, v169
    v_mul_f32 v178, v178, v170
    v_mul_f32 v179, v179, v171
    v_mfma_f32_16x16x32_bf16 v[164:167], a[196:199], v[52:55], v[164:167]
    ds_read_b128 a[236:239], v200 offset:35840
    s_mov_b32 s26, 233472
    v_mul_f32 v180, v180, v172
    v_mul_f32 v181, v181, v173
    v_mul_f32 v182, v182, v174
    v_mfma_f32_16x16x32_bf16 v[164:167], a[192:195], v[48:51], v[164:167]
    buffer_load_dwordx4 v203, s[8:11], s26 offen offset:0 lds
    v_mul_f32 v183, v183, v175
    v_exp_f32 v176, v176
    s_waitcnt lgkmcnt(5)
    v_mfma_f32_16x16x32_bf16 v[160:163], a[208:211], v[16:19], v[160:163]
    ds_read_b128 a[192:195], v201 offset:0
    buffer_load_dwordx4 v203, s[8:11], s26 offen offset:1024 lds
    v_exp_f32 v177, v177
    v_mfma_f32_16x16x32_bf16 v[160:163], a[212:215], v[20:23], v[160:163]
    buffer_load_dwordx4 v203, s[8:11], s26 offen offset:2048 lds
    v_exp_f32 v178, v178
    v_mfma_f32_16x16x32_bf16 v[160:163], a[216:219], v[24:27], v[160:163]
    ds_read_b128 a[196:199], v201 offset:1024
    s_add_u32 m0, s32, 4096
    v_exp_f32 v179, v179
    v_mfma_f32_16x16x32_bf16 v[160:163], a[220:223], v[28:31], v[160:163]
    s_add_u32 s35, s23, 320
    v_exp_f32 v180, v180
    v_mfma_f32_16x16x32_bf16 v[164:167], a[220:223], v[76:79], v[164:167]
    ds_read_b128 a[200:203], v201 offset:2048
    v_exp_f32 v181, v181
    v_mfma_f32_16x16x32_bf16 v[164:167], a[216:219], v[72:75], v[164:167]
    buffer_load_dwordx4 v204, s[4:7], s35 offen lds
    v_exp_f32 v182, v182
    v_mfma_f32_16x16x32_bf16 v[164:167], a[212:215], v[68:71], v[164:167]
    s_add_u32 m0, s32, 5120
    v_exp_f32 v183, v183
    v_fma_f32 v176, v176, s28, s28
    v_mfma_f32_16x16x32_bf16 v[164:167], a[208:211], v[64:67], v[164:167]
    ds_read_b128 a[204:207], v201 offset:3072
    v_fma_f32 v177, v177, s28, s28
    v_fma_f32 v178, v178, s28, s28
    v_fma_f32 v179, v179, s28, s28
    s_waitcnt lgkmcnt(4)
    v_mfma_f32_16x16x32_bf16 v[160:163], a[224:227], v[32:35], v[160:163]
    s_add_u32 s35, s23, 320
    v_fma_f32 v180, v180, s28, s28
    v_fma_f32 v181, v181, s28, s28
    v_fma_f32 v182, v182, s28, s28
    v_mfma_f32_16x16x32_bf16 v[160:163], a[228:231], v[36:39], v[160:163]
    ds_read_b128 a[208:211], v201 offset:4096
    v_fma_f32 v183, v183, s28, s28
    v_rcp_f32 v176, v176
    v_mfma_f32_16x16x32_bf16 v[160:163], a[232:235], v[40:43], v[160:163]
    buffer_load_dwordx4 v205, s[4:7], s35 offen lds
    v_rcp_f32 v177, v177
    v_mfma_f32_16x16x32_bf16 v[160:163], a[236:239], v[44:47], v[160:163]
    s_add_u32 m0, s32, 6144
    v_rcp_f32 v178, v178
    v_mfma_f32_16x16x32_bf16 v[164:167], a[236:239], v[92:95], v[164:167]
    ds_read_b128 a[212:215], v201 offset:5120
    v_rcp_f32 v179, v179
    v_mfma_f32_16x16x32_bf16 v[164:167], a[232:235], v[88:91], v[164:167]
    s_add_u32 s35, s23, 384
    v_rcp_f32 v180, v180
    v_mfma_f32_16x16x32_bf16 v[164:167], a[228:231], v[84:87], v[164:167]
    buffer_load_dwordx4 v204, s[4:7], s35 offen lds
    v_rcp_f32 v181, v181
    v_mfma_f32_16x16x32_bf16 v[164:167], a[224:227], v[80:83], v[164:167]
    ds_read_b128 a[216:219], v201 offset:6144
    v_rcp_f32 v182, v182
    v_rcp_f32 v183, v183
    v_mfma_f32_16x16x32_bf16 a[24:27], a[244:247], a[16:19], 0
    s_add_u32 m0, s32, 7168
    v_mul_f32 v176, v176, v168
    v_mul_f32 v177, v177, v169
    v_mul_f32 v178, v178, v170
    v_mfma_f32_16x16x32_bf16 a[16:19], a[240:243], a[16:19], 0
    s_add_u32 s35, s23, 384
    v_mul_f32 v179, v179, v171
    v_mul_f32 v180, v180, v172
    v_mul_f32 v181, v181, v173
    v_mfma_f32_16x16x32_bf16 a[28:31], a[244:247], a[20:23], 0
    ds_read_b128 a[220:223], v201 offset:7168
    v_mul_f32 v182, v182, v174
    v_mul_f32 v183, v183, v175
    v_cvt_pk_bf16_f32 v106, v176, v177
    v_mfma_f32_16x16x32_bf16 a[20:23], a[240:243], a[20:23], 0
    buffer_load_dwordx4 v205, s[4:7], s35 offen lds
    v_cvt_pk_bf16_f32 v107, v178, v179
    v_cvt_pk_bf16_f32 v122, v180, v181
    v_cvt_pk_bf16_f32 v123, v182, v183
    s_barrier
    s_waitcnt lgkmcnt(4)
    v_mfma_f32_16x16x32_bf16 v[168:171], a[192:195], v[0:3], 0
    ds_read_b128 a[224:227], v201 offset:8192
    s_add_u32 m0, s24, 24576
    v_mfma_f32_16x16x32_bf16 v[168:171], a[196:199], v[4:7], v[168:171]
    s_mov_b32 s25, 245760
    v_mfma_f32_16x16x32_bf16 v[168:171], a[200:203], v[8:11], v[168:171]
    ds_read_b128 a[228:231], v201 offset:9216
    buffer_load_dwordx4 v203, s[8:11], s25 offen offset:0 lds
    v_fma_f32 v176, v160, v160, s27
    v_fma_f32 v177, v161, v161, s27
    v_fma_f32 v178, v162, v162, s27
    v_mfma_f32_16x16x32_bf16 v[168:171], a[204:207], v[12:15], v[168:171]
    buffer_load_dwordx4 v203, s[8:11], s25 offen offset:1024 lds
    v_fma_f32 v179, v163, v163, s27
    v_fma_f32 v180, v164, v164, s27
    v_fma_f32 v181, v165, v165, s27
    v_mfma_f32_16x16x32_bf16 v[172:175], a[204:207], v[60:63], 0
    ds_read_b128 a[232:235], v201 offset:10240
    buffer_load_dwordx4 v203, s[8:11], s25 offen offset:2048 lds
    v_fma_f32 v182, v166, v166, s27
    v_fma_f32 v183, v167, v167, s27
    v_mul_f32 v176, v176, v160
    v_mfma_f32_16x16x32_bf16 v[172:175], a[200:203], v[56:59], v[172:175]
    s_add_u32 m0, s24, 36864
    v_mul_f32 v177, v177, v161
    v_mul_f32 v178, v178, v162
    v_mul_f32 v179, v179, v163
    v_mfma_f32_16x16x32_bf16 v[172:175], a[196:199], v[52:55], v[172:175]
    ds_read_b128 a[236:239], v201 offset:11264
    s_mov_b32 s26, 258048
    v_mul_f32 v180, v180, v164
    v_mul_f32 v181, v181, v165
    v_mul_f32 v182, v182, v166
    v_mfma_f32_16x16x32_bf16 v[172:175], a[192:195], v[48:51], v[172:175]
    buffer_load_dwordx4 v203, s[8:11], s26 offen offset:0 lds
    v_mul_f32 v183, v183, v167
    v_exp_f32 v176, v176
    s_waitcnt lgkmcnt(4)
    v_mfma_f32_16x16x32_bf16 v[168:171], a[208:211], v[16:19], v[168:171]
    ds_read_b128 a[192:195], v201 offset:24576
    buffer_load_dwordx4 v203, s[8:11], s26 offen offset:1024 lds
    v_exp_f32 v177, v177
    v_mfma_f32_16x16x32_bf16 v[168:171], a[212:215], v[20:23], v[168:171]
    buffer_load_dwordx4 v203, s[8:11], s26 offen offset:2048 lds
    v_exp_f32 v178, v178
    v_mfma_f32_16x16x32_bf16 v[168:171], a[216:219], v[24:27], v[168:171]
    ds_read_b128 a[196:199], v201 offset:25600
    s_add_u32 m0, s32, 8192
    v_exp_f32 v179, v179
    v_mfma_f32_16x16x32_bf16 v[168:171], a[220:223], v[28:31], v[168:171]
    s_add_u32 s35, s23, 448
    v_exp_f32 v180, v180
    v_mfma_f32_16x16x32_bf16 v[172:175], a[220:223], v[76:79], v[172:175]
    ds_read_b128 a[200:203], v201 offset:26624
    v_exp_f32 v181, v181
    v_mfma_f32_16x16x32_bf16 v[172:175], a[216:219], v[72:75], v[172:175]
    buffer_load_dwordx4 v204, s[4:7], s35 offen lds
    v_exp_f32 v182, v182
    v_mfma_f32_16x16x32_bf16 v[172:175], a[212:215], v[68:71], v[172:175]
    s_add_u32 m0, s32, 9216
    v_exp_f32 v183, v183
    v_fma_f32 v176, v176, s28, s28
    v_mfma_f32_16x16x32_bf16 v[172:175], a[208:211], v[64:67], v[172:175]
    ds_read_b128 a[204:207], v201 offset:27648
    v_fma_f32 v177, v177, s28, s28
    v_fma_f32 v178, v178, s28, s28
    v_fma_f32 v179, v179, s28, s28
    s_waitcnt lgkmcnt(4)
    v_mfma_f32_16x16x32_bf16 v[168:171], a[224:227], v[32:35], v[168:171]
    s_add_u32 s35, s23, 448
    v_fma_f32 v180, v180, s28, s28
    v_fma_f32 v181, v181, s28, s28
    v_fma_f32 v182, v182, s28, s28
    v_mfma_f32_16x16x32_bf16 v[168:171], a[228:231], v[36:39], v[168:171]
    ds_read_b128 a[208:211], v201 offset:28672
    v_fma_f32 v183, v183, s28, s28
    v_rcp_f32 v176, v176
    v_mfma_f32_16x16x32_bf16 v[168:171], a[232:235], v[40:43], v[168:171]
    buffer_load_dwordx4 v205, s[4:7], s35 offen lds
    v_rcp_f32 v177, v177
    v_mfma_f32_16x16x32_bf16 v[168:171], a[236:239], v[44:47], v[168:171]
    s_add_u32 m0, s32, 10240
    v_rcp_f32 v178, v178
    v_mfma_f32_16x16x32_bf16 v[172:175], a[236:239], v[92:95], v[172:175]
    ds_read_b128 a[212:215], v201 offset:29696
    v_rcp_f32 v179, v179
    v_mfma_f32_16x16x32_bf16 v[172:175], a[232:235], v[88:91], v[172:175]
    s_add_u32 s35, s23, 512
    v_rcp_f32 v180, v180
    v_mfma_f32_16x16x32_bf16 v[172:175], a[228:231], v[84:87], v[172:175]
    buffer_load_dwordx4 v204, s[4:7], s35 offen lds
    v_rcp_f32 v181, v181
    v_mfma_f32_16x16x32_bf16 v[172:175], a[224:227], v[80:83], v[172:175]
    ds_read_b128 a[216:219], v201 offset:30720
    v_rcp_f32 v182, v182
    v_rcp_f32 v183, v183
    v_mfma_f32_16x16x32_bf16 a[40:43], a[244:247], a[32:35], 0
    s_add_u32 m0, s32, 11264
    v_mul_f32 v176, v176, v160
    v_mul_f32 v177, v177, v161
    v_mul_f32 v178, v178, v162
    v_mfma_f32_16x16x32_bf16 a[32:35], a[240:243], a[32:35], 0
    s_add_u32 s35, s23, 512
    v_mul_f32 v179, v179, v163
    v_mul_f32 v180, v180, v164
    v_mul_f32 v181, v181, v165
    v_mfma_f32_16x16x32_bf16 a[44:47], a[244:247], a[36:39], 0
    ds_read_b128 a[220:223], v201 offset:31744
    v_mul_f32 v182, v182, v166
    v_mul_f32 v183, v183, v167
    v_cvt_pk_bf16_f32 v108, v176, v177
    v_mfma_f32_16x16x32_bf16 a[36:39], a[240:243], a[36:39], 0
    buffer_load_dwordx4 v205, s[4:7], s35 offen lds
    v_cvt_pk_bf16_f32 v109, v178, v179
    v_cvt_pk_bf16_f32 v124, v180, v181
    v_cvt_pk_bf16_f32 v125, v182, v183
    s_waitcnt vmcnt(14)
    s_barrier
    s_waitcnt lgkmcnt(4)
    v_mfma_f32_16x16x32_bf16 v[160:163], a[192:195], v[0:3], 0
    ds_read_b128 a[224:227], v201 offset:32768
    s_add_u32 m0, s24, 49152
    v_mfma_f32_16x16x32_bf16 v[160:163], a[196:199], v[4:7], v[160:163]
    s_mov_b32 s25, 270336
    buffer_load_dwordx4 v203, s[8:11], s25 offen offset:0 lds
    v_mfma_f32_16x16x32_bf16 v[160:163], a[200:203], v[8:11], v[160:163]
    ds_read_b128 a[228:231], v201 offset:33792
    buffer_load_dwordx4 v203, s[8:11], s25 offen offset:1024 lds
    v_fma_f32 v176, v168, v168, s27
    v_fma_f32 v177, v169, v169, s27
    v_fma_f32 v178, v170, v170, s27
    v_fma_f32 v179, v171, v171, s27
    v_mfma_f32_16x16x32_bf16 v[160:163], a[204:207], v[12:15], v[160:163]
    buffer_load_dwordx4 v203, s[8:11], s25 offen offset:2048 lds
    v_fma_f32 v180, v172, v172, s27
    v_fma_f32 v181, v173, v173, s27
    v_fma_f32 v182, v174, v174, s27
    v_fma_f32 v183, v175, v175, s27
    v_mfma_f32_16x16x32_bf16 v[164:167], a[204:207], v[60:63], 0
    ds_read_b128 a[232:235], v201 offset:34816
    s_add_u32 m0, s24, 61440
    v_mul_f32 v176, v176, v168
    v_mul_f32 v177, v177, v169
    v_mul_f32 v178, v178, v170
    v_mfma_f32_16x16x32_bf16 v[164:167], a[200:203], v[56:59], v[164:167]
    s_mov_b32 s26, 282624
    v_mul_f32 v179, v179, v171
    v_mul_f32 v180, v180, v172
    v_mul_f32 v181, v181, v173
    v_mfma_f32_16x16x32_bf16 v[164:167], a[196:199], v[52:55], v[164:167]
    ds_read_b128 a[236:239], v201 offset:35840
    buffer_load_dwordx4 v203, s[8:11], s26 offen offset:0 lds
    v_mul_f32 v182, v182, v174
    v_mul_f32 v183, v183, v175
    v_mfma_f32_16x16x32_bf16 v[164:167], a[192:195], v[48:51], v[164:167]
    buffer_load_dwordx4 v203, s[8:11], s26 offen offset:1024 lds
    v_exp_f32 v176, v176
    v_exp_f32 v177, v177
    s_waitcnt lgkmcnt(4)
    v_mfma_f32_16x16x32_bf16 v[160:163], a[208:211], v[16:19], v[160:163]
    ds_read_b128 a[192:195], v200 offset:0
    buffer_load_dwordx4 v203, s[8:11], s26 offen offset:2048 lds
    v_exp_f32 v178, v178
    v_mfma_f32_16x16x32_bf16 v[160:163], a[212:215], v[20:23], v[160:163]
    s_add_u32 m0, s32, 12288
    s_add_u32 s35, s23, 576
    v_exp_f32 v179, v179
    v_exp_f32 v180, v180
    v_mfma_f32_16x16x32_bf16 v[160:163], a[216:219], v[24:27], v[160:163]
    ds_read_b128 a[196:199], v200 offset:1024
    buffer_load_dwordx4 v204, s[4:7], s35 offen lds
    v_exp_f32 v181, v181
    v_mfma_f32_16x16x32_bf16 v[160:163], a[220:223], v[28:31], v[160:163]
    s_add_u32 m0, s32, 13312
    v_exp_f32 v182, v182
    v_exp_f32 v183, v183
    v_mfma_f32_16x16x32_bf16 v[164:167], a[220:223], v[76:79], v[164:167]
    ds_read_b128 a[200:203], v200 offset:2048
    s_add_u32 s35, s23, 576
    v_fma_f32 v176, v176, s28, s28
    v_fma_f32 v177, v177, s28, s28
    v_fma_f32 v178, v178, s28, s28
    v_mfma_f32_16x16x32_bf16 v[164:167], a[216:219], v[72:75], v[164:167]
    buffer_load_dwordx4 v205, s[4:7], s35 offen lds
    v_fma_f32 v179, v179, s28, s28
    v_fma_f32 v180, v180, s28, s28
    v_fma_f32 v181, v181, s28, s28
    v_mfma_f32_16x16x32_bf16 v[164:167], a[212:215], v[68:71], v[164:167]
    ds_read_b128 a[204:207], v200 offset:3072
    s_add_u32 m0, s32, 14336
    v_fma_f32 v182, v182, s28, s28
    v_fma_f32 v183, v183, s28, s28
    v_mfma_f32_16x16x32_bf16 v[164:167], a[208:211], v[64:67], v[164:167]
    s_add_u32 s35, s23, 640
    v_rcp_f32 v176, v176
    v_rcp_f32 v177, v177
    s_waitcnt lgkmcnt(4)
    v_mfma_f32_16x16x32_bf16 v[160:163], a[224:227], v[32:35], v[160:163]
    ds_read_b128 a[208:211], v200 offset:12288
    buffer_load_dwordx4 v204, s[4:7], s35 offen lds
    v_rcp_f32 v178, v178
    v_mfma_f32_16x16x32_bf16 v[160:163], a[228:231], v[36:39], v[160:163]
    ds_read_b128 a[48:51], v199 offset:0
    v_rcp_f32 v179, v179
    v_rcp_f32 v180, v180
    v_mfma_f32_16x16x32_bf16 v[160:163], a[232:235], v[40:43], v[160:163]
    ds_read_b128 a[212:215], v200 offset:13312
    v_rcp_f32 v181, v181
    v_mfma_f32_16x16x32_bf16 v[160:163], a[236:239], v[44:47], v[160:163]
    ds_read_b128 a[52:55], v199 offset:1024
    v_rcp_f32 v182, v182
    v_rcp_f32 v183, v183
    v_mfma_f32_16x16x32_bf16 v[164:167], a[236:239], v[92:95], v[164:167]
    ds_read_b128 a[216:219], v200 offset:14336
    v_mul_f32 v176, v176, v168
    v_mul_f32 v177, v177, v169
    v_mul_f32 v178, v178, v170
    v_mfma_f32_16x16x32_bf16 v[164:167], a[232:235], v[88:91], v[164:167]
    ds_read_b128 a[64:67], v199 offset:2048
    v_mul_f32 v179, v179, v171
    v_mul_f32 v180, v180, v172
    v_mul_f32 v181, v181, v173
    v_mfma_f32_16x16x32_bf16 v[164:167], a[228:231], v[84:87], v[164:167]
    ds_read_b128 a[220:223], v200 offset:15360
    v_mul_f32 v182, v182, v174
    v_mul_f32 v183, v183, v175
    v_cvt_pk_bf16_f32 v110, v176, v177
    v_mfma_f32_16x16x32_bf16 v[164:167], a[224:227], v[80:83], v[164:167]
    ds_read_b128 a[68:71], v199 offset:3072
    v_cvt_pk_bf16_f32 v111, v178, v179
    v_cvt_pk_bf16_f32 v126, v180, v181
    v_cvt_pk_bf16_f32 v127, v182, v183
    s_waitcnt vmcnt(13)
    s_waitcnt lgkmcnt(8)
    v_mfma_f32_16x16x32_bf16 v[168:171], a[192:195], v[0:3], 0
    ds_read_b128 a[224:227], v200 offset:4096
    v_fma_f32 v176, v160, v160, s27
    v_mfma_f32_16x16x32_bf16 v[168:171], a[196:199], v[4:7], v[168:171]
    ds_read_b128 a[228:231], v200 offset:5120
    v_mul_f32 v176, v176, v160
    v_mfma_f32_16x16x32_bf16 v[168:171], a[200:203], v[8:11], v[168:171]
    s_barrier
    v_exp_f32 v176, v176
    v_mfma_f32_16x16x32_bf16 v[168:171], a[204:207], v[12:15], v[168:171]
    ds_read_b128 a[232:235], v200 offset:6144
    v_fma_f32 v176, v176, s28, s28
    v_mfma_f32_16x16x32_bf16 v[172:175], a[204:207], v[60:63], 0
    s_waitcnt lgkmcnt(4)
    v_rcp_f32 v176, v176
    v_mfma_f32_16x16x32_bf16 v[172:175], a[200:203], v[56:59], v[172:175]
    s_add_u32 m0, s24, 73728
    v_mul_f32 v176, v176, v160
    v_mfma_f32_16x16x32_bf16 v[172:175], a[196:199], v[52:55], v[172:175]
    ds_read_b128 a[236:239], v200 offset:7168
    v_fma_f32 v177, v161, v161, s27
    v_mfma_f32_16x16x32_bf16 v[172:175], a[192:195], v[48:51], v[172:175]
    ds_read_b128 a[192:195], v200 offset:16384
    v_mul_f32 v177, v177, v161
    v_mfma_f32_16x16x32_bf16 a[0:3], a[208:211], v[96:99], a[0:3]
    s_mov_b32 s25, 294912
    v_exp_f32 v177, v177
    v_mfma_f32_16x16x32_bf16 a[0:3], a[212:215], v[100:103], a[0:3]
    ds_read_b128 a[196:199], v200 offset:17408
    v_fma_f32 v177, v177, s28, s28
    v_mfma_f32_16x16x32_bf16 a[0:3], a[216:219], v[104:107], a[0:3]
    v_rcp_f32 v177, v177
    v_mfma_f32_16x16x32_bf16 a[0:3], a[220:223], v[108:111], a[0:3]
    buffer_load_dwordx4 v203, s[8:11], s25 offen offset:0 lds
    v_mul_f32 v177, v177, v161
    v_cvt_pk_bf16_f32 v128, v176, v177
    v_mfma_f32_16x16x32_bf16 a[4:7], a[220:223], v[124:127], a[4:7]
    ds_read_b128 a[200:203], v200 offset:18432
    v_fma_f32 v178, v162, v162, s27
    v_mfma_f32_16x16x32_bf16 a[4:7], a[216:219], v[120:123], a[4:7]
    ds_read_b128 a[204:207], v200 offset:19456
    v_mul_f32 v178, v178, v162
    v_mfma_f32_16x16x32_bf16 a[4:7], a[212:215], v[116:119], a[4:7]
    s_waitcnt lgkmcnt(4)
    v_exp_f32 v178, v178
    v_mfma_f32_16x16x32_bf16 a[4:7], a[208:211], v[112:115], a[4:7]
    ds_read_b128 a[208:211], v200 offset:8192
    v_fma_f32 v178, v178, s28, s28
    v_mfma_f32_16x16x32_bf16 v[168:171], a[224:227], v[16:19], v[168:171]
    s_mov_b32 s26, 307200
    v_rcp_f32 v178, v178
    v_mfma_f32_16x16x32_bf16 v[168:171], a[228:231], v[20:23], v[168:171]
    buffer_load_dwordx4 v203, s[8:11], s25 offen offset:1024 lds
    v_mul_f32 v178, v178, v162
    v_mfma_f32_16x16x32_bf16 v[168:171], a[232:235], v[24:27], v[168:171]
    ds_read_b128 a[212:215], v200 offset:9216
    v_fma_f32 v179, v163, v163, s27
    v_mfma_f32_16x16x32_bf16 v[168:171], a[236:239], v[28:31], v[168:171]
    ds_read_b128 a[216:219], v200 offset:10240
    v_mul_f32 v179, v179, v163
    v_mfma_f32_16x16x32_bf16 v[172:175], a[236:239], v[76:79], v[172:175]
    v_exp_f32 v179, v179
    v_mfma_f32_16x16x32_bf16 v[172:175], a[232:235], v[72:75], v[172:175]
    ds_read_b128 a[220:223], v200 offset:11264
    v_fma_f32 v179, v179, s28, s28
    v_mfma_f32_16x16x32_bf16 v[172:175], a[228:231], v[68:71], v[172:175]
    s_waitcnt lgkmcnt(4)
    v_rcp_f32 v179, v179
    v_mfma_f32_16x16x32_bf16 v[172:175], a[224:227], v[64:67], v[172:175]
    buffer_load_dwordx4 v203, s[8:11], s25 offen offset:2048 lds
    v_mul_f32 v179, v179, v163
    v_cvt_pk_bf16_f32 v129, v178, v179
    v_mfma_f32_16x16x32_bf16 a[8:11], a[192:195], v[96:99], a[8:11]
    ds_read_b128 a[224:227], v200 offset:20480
    v_fma_f32 v180, v164, v164, s27
    v_mfma_f32_16x16x32_bf16 a[8:11], a[196:199], v[100:103], a[8:11]
    ds_read_b128 a[228:231], v200 offset:21504
    v_mul_f32 v180, v180, v164
    v_mfma_f32_16x16x32_bf16 a[8:11], a[200:203], v[104:107], a[8:11]
    s_add_u32 m0, s24, 86016
    v_exp_f32 v180, v180
    v_mfma_f32_16x16x32_bf16 a[8:11], a[204:207], v[108:111], a[8:11]
    ds_read_b128 a[232:235], v200 offset:22528
    v_fma_f32 v180, v180, s28, s28
    v_mfma_f32_16x16x32_bf16 a[12:15], a[204:207], v[124:127], a[12:15]
    s_waitcnt lgkmcnt(3)
    v_rcp_f32 v180, v180
    v_mfma_f32_16x16x32_bf16 a[12:15], a[200:203], v[120:123], a[12:15]
    buffer_load_dwordx4 v203, s[8:11], s26 offen offset:0 lds
    v_mul_f32 v180, v180, v164
    v_mfma_f32_16x16x32_bf16 a[12:15], a[196:199], v[116:119], a[12:15]
    ds_read_b128 a[236:239], v200 offset:23552
    v_fma_f32 v181, v165, v165, s27
    v_mfma_f32_16x16x32_bf16 a[12:15], a[192:195], v[112:115], a[12:15]
    ds_read_b128 a[192:195], v200 offset:24576
    v_mul_f32 v181, v181, v165
    v_mfma_f32_16x16x32_bf16 v[168:171], a[208:211], v[32:35], v[168:171]
    v_exp_f32 v181, v181
    v_mfma_f32_16x16x32_bf16 v[168:171], a[212:215], v[36:39], v[168:171]
    ds_read_b128 a[196:199], v200 offset:25600
    v_fma_f32 v181, v181, s28, s28
    v_mfma_f32_16x16x32_bf16 v[168:171], a[216:219], v[40:43], v[168:171]
    v_rcp_f32 v181, v181
    v_mfma_f32_16x16x32_bf16 v[168:171], a[220:223], v[44:47], v[168:171]
    buffer_load_dwordx4 v203, s[8:11], s26 offen offset:1024 lds
    v_mul_f32 v181, v181, v165
    v_cvt_pk_bf16_f32 v144, v180, v181
    v_mfma_f32_16x16x32_bf16 v[172:175], a[220:223], v[92:95], v[172:175]
    ds_read_b128 a[200:203], v200 offset:26624
    v_fma_f32 v182, v166, v166, s27
    v_mfma_f32_16x16x32_bf16 v[172:175], a[216:219], v[88:91], v[172:175]
    ds_read_b128 a[204:207], v200 offset:27648
    v_mul_f32 v182, v182, v166
    v_mfma_f32_16x16x32_bf16 v[172:175], a[212:215], v[84:87], v[172:175]
    s_waitcnt lgkmcnt(4)
    v_exp_f32 v182, v182
    v_mfma_f32_16x16x32_bf16 v[172:175], a[208:211], v[80:83], v[172:175]
    ds_read_b128 a[208:211], v200 offset:36864
    v_fma_f32 v182, v182, s28, s28
    v_mfma_f32_16x16x32_bf16 a[16:19], a[224:227], v[96:99], a[16:19]
    v_rcp_f32 v182, v182
    v_mfma_f32_16x16x32_bf16 a[16:19], a[228:231], v[100:103], a[16:19]
    buffer_load_dwordx4 v203, s[8:11], s26 offen offset:2048 lds
    v_mul_f32 v182, v182, v166
    v_mfma_f32_16x16x32_bf16 a[16:19], a[232:235], v[104:107], a[16:19]
    ds_read_b128 a[212:215], v200 offset:37888
    v_fma_f32 v183, v167, v167, s27
    v_mfma_f32_16x16x32_bf16 a[16:19], a[236:239], v[108:111], a[16:19]
    ds_read_b128 a[216:219], v200 offset:38912
    v_mul_f32 v183, v183, v167
    v_mfma_f32_16x16x32_bf16 a[20:23], a[236:239], v[124:127], a[20:23]
    s_waitcnt vmcnt(9)
    v_exp_f32 v183, v183
    v_mfma_f32_16x16x32_bf16 a[20:23], a[232:235], v[120:123], a[20:23]
    ds_read_b128 a[220:223], v200 offset:39936
    v_fma_f32 v183, v183, s28, s28
    v_mfma_f32_16x16x32_bf16 a[20:23], a[228:231], v[116:119], a[20:23]
    s_waitcnt lgkmcnt(4)
    v_rcp_f32 v183, v183
    v_mfma_f32_16x16x32_bf16 a[20:23], a[224:227], v[112:115], a[20:23]
    s_nop 0
    v_mul_f32 v183, v183, v167
    v_cvt_pk_bf16_f32 v145, v182, v183
    v_mfma_f32_16x16x32_bf16 a[56:59], a[244:247], a[48:51], 0
    s_add_u32 m0, s32, 0
    s_add_u32 s35, s23, 640
    buffer_load_dwordx4 v205, s[4:7], s35 offen lds
    v_mfma_f32_16x16x32_bf16 a[48:51], a[240:243], a[48:51], 0
    s_add_u32 m0, s32, 1024
    s_add_u32 s35, s23, 704
    buffer_load_dwordx4 v204, s[4:7], s35 offen lds
    v_mfma_f32_16x16x32_bf16 a[60:63], a[244:247], a[52:55], 0
    s_add_u32 m0, s32, 2048
    s_add_u32 s35, s23, 704
    buffer_load_dwordx4 v205, s[4:7], s35 offen lds
    v_mfma_f32_16x16x32_bf16 a[52:55], a[240:243], a[52:55], 0
    ds_read_b128 a[80:83], v199 offset:4096
    v_mfma_f32_16x16x32_bf16 a[72:75], a[244:247], a[64:67], 0
    ds_read_b128 a[84:87], v199 offset:5120
    ds_read_b128 a[96:99], v199 offset:6144
    v_mfma_f32_16x16x32_bf16 a[64:67], a[240:243], a[64:67], 0
    ds_read_b128 a[100:103], v199 offset:7168
    v_mfma_f32_16x16x32_bf16 a[76:79], a[244:247], a[68:71], 0
    v_mfma_f32_16x16x32_bf16 a[68:71], a[240:243], a[68:71], 0
    v_mfma_f32_16x16x32_bf16 v[160:163], a[192:195], v[0:3], 0
    ds_read_b128 a[224:227], v200 offset:28672
    v_fma_f32 v176, v168, v168, s27
    v_mfma_f32_16x16x32_bf16 v[160:163], a[196:199], v[4:7], v[160:163]
    ds_read_b128 a[228:231], v200 offset:29696
    v_mul_f32 v176, v176, v168
    v_mfma_f32_16x16x32_bf16 v[160:163], a[200:203], v[8:11], v[160:163]
    s_barrier
    v_exp_f32 v176, v176
    v_mfma_f32_16x16x32_bf16 v[160:163], a[204:207], v[12:15], v[160:163]
    ds_read_b128 a[232:235], v200 offset:30720
    v_fma_f32 v176, v176, s28, s28
    v_mfma_f32_16x16x32_bf16 v[164:167], a[204:207], v[60:63], 0
    s_waitcnt lgkmcnt(7)
    v_rcp_f32 v176, v176
    v_mfma_f32_16x16x32_bf16 v[164:167], a[200:203], v[56:59], v[164:167]
    s_add_u32 m0, s24, 0
    v_mul_f32 v176, v176, v168
    v_mfma_f32_16x16x32_bf16 v[164:167], a[196:199], v[52:55], v[164:167]
    ds_read_b128 a[236:239], v200 offset:31744
    v_fma_f32 v177, v169, v169, s27
    v_mfma_f32_16x16x32_bf16 v[164:167], a[192:195], v[48:51], v[164:167]
    ds_read_b128 a[192:195], v200 offset:40960
    v_mul_f32 v177, v177, v169
    v_mfma_f32_16x16x32_bf16 a[24:27], a[208:211], v[96:99], a[24:27]
    s_mov_b32 s25, 319488
    v_exp_f32 v177, v177
    v_mfma_f32_16x16x32_bf16 a[24:27], a[212:215], v[100:103], a[24:27]
    ds_read_b128 a[196:199], v200 offset:41984
    v_fma_f32 v177, v177, s28, s28
    v_mfma_f32_16x16x32_bf16 a[24:27], a[216:219], v[104:107], a[24:27]
    v_rcp_f32 v177, v177
    v_mfma_f32_16x16x32_bf16 a[24:27], a[220:223], v[108:111], a[24:27]
    buffer_load_dwordx4 v203, s[8:11], s25 offen offset:0 lds
    v_mul_f32 v177, v177, v169
    v_cvt_pk_bf16_f32 v130, v176, v177
    v_mfma_f32_16x16x32_bf16 a[28:31], a[220:223], v[124:127], a[28:31]
    ds_read_b128 a[200:203], v200 offset:43008
    v_fma_f32 v178, v170, v170, s27
    v_mfma_f32_16x16x32_bf16 a[28:31], a[216:219], v[120:123], a[28:31]
    ds_read_b128 a[204:207], v200 offset:44032
    v_mul_f32 v178, v178, v170
    v_mfma_f32_16x16x32_bf16 a[28:31], a[212:215], v[116:119], a[28:31]
    s_waitcnt lgkmcnt(4)
    v_exp_f32 v178, v178
    v_mfma_f32_16x16x32_bf16 a[28:31], a[208:211], v[112:115], a[28:31]
    ds_read_b128 a[208:211], v200 offset:32768
    v_fma_f32 v178, v178, s28, s28
    v_mfma_f32_16x16x32_bf16 v[160:163], a[224:227], v[16:19], v[160:163]
    s_mov_b32 s26, 331776
    v_rcp_f32 v178, v178
    v_mfma_f32_16x16x32_bf16 v[160:163], a[228:231], v[20:23], v[160:163]
    buffer_load_dwordx4 v203, s[8:11], s25 offen offset:1024 lds
    v_mul_f32 v178, v178, v170
    v_mfma_f32_16x16x32_bf16 v[160:163], a[232:235], v[24:27], v[160:163]
    ds_read_b128 a[212:215], v200 offset:33792
    v_fma_f32 v179, v171, v171, s27
    v_mfma_f32_16x16x32_bf16 v[160:163], a[236:239], v[28:31], v[160:163]
    ds_read_b128 a[216:219], v200 offset:34816
    v_mul_f32 v179, v179, v171
    v_mfma_f32_16x16x32_bf16 v[164:167], a[236:239], v[76:79], v[164:167]
    v_exp_f32 v179, v179
    v_mfma_f32_16x16x32_bf16 v[164:167], a[232:235], v[72:75], v[164:167]
    ds_read_b128 a[220:223], v200 offset:35840
    v_fma_f32 v179, v179, s28, s28
    v_mfma_f32_16x16x32_bf16 v[164:167], a[228:231], v[68:71], v[164:167]
    s_waitcnt lgkmcnt(4)
    v_rcp_f32 v179, v179
    v_mfma_f32_16x16x32_bf16 v[164:167], a[224:227], v[64:67], v[164:167]
    buffer_load_dwordx4 v203, s[8:11], s25 offen offset:2048 lds
    v_mul_f32 v179, v179, v171
    v_cvt_pk_bf16_f32 v131, v178, v179
    v_mfma_f32_16x16x32_bf16 a[32:35], a[192:195], v[96:99], a[32:35]
    ds_read_b128 a[224:227], v200 offset:45056
    v_fma_f32 v180, v172, v172, s27
    v_mfma_f32_16x16x32_bf16 a[32:35], a[196:199], v[100:103], a[32:35]
    ds_read_b128 a[228:231], v200 offset:46080
    v_mul_f32 v180, v180, v172
    v_mfma_f32_16x16x32_bf16 a[32:35], a[200:203], v[104:107], a[32:35]
    s_add_u32 m0, s24, 12288
    v_exp_f32 v180, v180
    v_mfma_f32_16x16x32_bf16 a[32:35], a[204:207], v[108:111], a[32:35]
    ds_read_b128 a[232:235], v200 offset:47104
    v_fma_f32 v180, v180, s28, s28
    v_mfma_f32_16x16x32_bf16 a[36:39], a[204:207], v[124:127], a[36:39]
    s_waitcnt lgkmcnt(3)
    v_rcp_f32 v180, v180
    v_mfma_f32_16x16x32_bf16 a[36:39], a[200:203], v[120:123], a[36:39]
    buffer_load_dwordx4 v203, s[8:11], s26 offen offset:0 lds
    v_mul_f32 v180, v180, v172
    v_mfma_f32_16x16x32_bf16 a[36:39], a[196:199], v[116:119], a[36:39]
    ds_read_b128 a[236:239], v200 offset:48128
    v_fma_f32 v181, v173, v173, s27
    v_mfma_f32_16x16x32_bf16 a[36:39], a[192:195], v[112:115], a[36:39]
    ds_read_b128 a[192:195], v201 offset:0
    v_mul_f32 v181, v181, v173
    v_mfma_f32_16x16x32_bf16 v[160:163], a[208:211], v[32:35], v[160:163]
    v_exp_f32 v181, v181
    v_mfma_f32_16x16x32_bf16 v[160:163], a[212:215], v[36:39], v[160:163]
    ds_read_b128 a[196:199], v201 offset:1024
    v_fma_f32 v181, v181, s28, s28
    v_mfma_f32_16x16x32_bf16 v[160:163], a[216:219], v[40:43], v[160:163]
    v_rcp_f32 v181, v181
    v_mfma_f32_16x16x32_bf16 v[160:163], a[220:223], v[44:47], v[160:163]
    buffer_load_dwordx4 v203, s[8:11], s26 offen offset:1024 lds
    v_mul_f32 v181, v181, v173
    v_cvt_pk_bf16_f32 v146, v180, v181
    v_mfma_f32_16x16x32_bf16 v[164:167], a[220:223], v[92:95], v[164:167]
    ds_read_b128 a[200:203], v201 offset:2048
    v_fma_f32 v182, v174, v174, s27
    v_mfma_f32_16x16x32_bf16 v[164:167], a[216:219], v[88:91], v[164:167]
    ds_read_b128 a[204:207], v201 offset:3072
    v_mul_f32 v182, v182, v174
    v_mfma_f32_16x16x32_bf16 v[164:167], a[212:215], v[84:87], v[164:167]
    s_waitcnt lgkmcnt(4)
    v_exp_f32 v182, v182
    v_mfma_f32_16x16x32_bf16 v[164:167], a[208:211], v[80:83], v[164:167]
    ds_read_b128 a[208:211], v201 offset:12288
    v_fma_f32 v182, v182, s28, s28
    v_mfma_f32_16x16x32_bf16 a[40:43], a[224:227], v[96:99], a[40:43]
    v_rcp_f32 v182, v182
    v_mfma_f32_16x16x32_bf16 a[40:43], a[228:231], v[100:103], a[40:43]
    buffer_load_dwordx4 v203, s[8:11], s26 offen offset:2048 lds
    v_mul_f32 v182, v182, v174
    v_mfma_f32_16x16x32_bf16 a[40:43], a[232:235], v[104:107], a[40:43]
    ds_read_b128 a[212:215], v201 offset:13312
    v_fma_f32 v183, v175, v175, s27
    v_mfma_f32_16x16x32_bf16 a[40:43], a[236:239], v[108:111], a[40:43]
    ds_read_b128 a[216:219], v201 offset:14336
    v_mul_f32 v183, v183, v175
    v_mfma_f32_16x16x32_bf16 a[44:47], a[236:239], v[124:127], a[44:47]
    s_waitcnt vmcnt(9)
    v_exp_f32 v183, v183
    v_mfma_f32_16x16x32_bf16 a[44:47], a[232:235], v[120:123], a[44:47]
    ds_read_b128 a[220:223], v201 offset:15360
    v_fma_f32 v183, v183, s28, s28
    v_mfma_f32_16x16x32_bf16 a[44:47], a[228:231], v[116:119], a[44:47]
    s_waitcnt lgkmcnt(4)
    v_rcp_f32 v183, v183
    v_mfma_f32_16x16x32_bf16 a[44:47], a[224:227], v[112:115], a[44:47]
    s_nop 0
    v_mul_f32 v183, v183, v175
    v_cvt_pk_bf16_f32 v147, v182, v183
    v_mfma_f32_16x16x32_bf16 a[88:91], a[244:247], a[80:83], 0
    v_mfma_f32_16x16x32_bf16 a[80:83], a[240:243], a[80:83], 0
    ds_read_b128 a[112:115], v199 offset:8192
    v_mfma_f32_16x16x32_bf16 a[92:95], a[244:247], a[84:87], 0
    v_mfma_f32_16x16x32_bf16 a[84:87], a[240:243], a[84:87], 0
    ds_read_b128 a[116:119], v199 offset:9216
    v_mfma_f32_16x16x32_bf16 a[104:107], a[244:247], a[96:99], 0
    v_mfma_f32_16x16x32_bf16 a[96:99], a[240:243], a[96:99], 0
    ds_read_b128 a[128:131], v199 offset:10240
    v_mfma_f32_16x16x32_bf16 a[108:111], a[244:247], a[100:103], 0
    v_mfma_f32_16x16x32_bf16 a[100:103], a[240:243], a[100:103], 0
    ds_read_b128 a[132:135], v199 offset:11264
    v_mfma_f32_16x16x32_bf16 v[168:171], a[192:195], v[0:3], 0
    ds_read_b128 a[224:227], v201 offset:4096
    v_fma_f32 v176, v160, v160, s27
    v_mfma_f32_16x16x32_bf16 v[168:171], a[196:199], v[4:7], v[168:171]
    ds_read_b128 a[228:231], v201 offset:5120
    v_mul_f32 v176, v176, v160
    v_mfma_f32_16x16x32_bf16 v[168:171], a[200:203], v[8:11], v[168:171]
    s_barrier
    v_exp_f32 v176, v176
    v_mfma_f32_16x16x32_bf16 v[168:171], a[204:207], v[12:15], v[168:171]
    ds_read_b128 a[232:235], v201 offset:6144
    v_fma_f32 v176, v176, s28, s28
    v_mfma_f32_16x16x32_bf16 v[172:175], a[204:207], v[60:63], 0
    s_waitcnt lgkmcnt(7)
    v_rcp_f32 v176, v176
    v_mfma_f32_16x16x32_bf16 v[172:175], a[200:203], v[56:59], v[172:175]
    s_add_u32 m0, s24, 24576
    v_mul_f32 v176, v176, v160
    v_mfma_f32_16x16x32_bf16 v[172:175], a[196:199], v[52:55], v[172:175]
    ds_read_b128 a[236:239], v201 offset:7168
    v_fma_f32 v177, v161, v161, s27
    v_mfma_f32_16x16x32_bf16 v[172:175], a[192:195], v[48:51], v[172:175]
    ds_read_b128 a[192:195], v201 offset:16384
    v_mul_f32 v177, v177, v161
    v_mfma_f32_16x16x32_bf16 a[48:51], a[208:211], v[96:99], a[48:51]
    s_mov_b32 s25, 344064
    v_exp_f32 v177, v177
    v_mfma_f32_16x16x32_bf16 a[48:51], a[212:215], v[100:103], a[48:51]
    ds_read_b128 a[196:199], v201 offset:17408
    v_fma_f32 v177, v177, s28, s28
    v_mfma_f32_16x16x32_bf16 a[48:51], a[216:219], v[104:107], a[48:51]
    v_rcp_f32 v177, v177
    v_mfma_f32_16x16x32_bf16 a[48:51], a[220:223], v[108:111], a[48:51]
    buffer_load_dwordx4 v203, s[8:11], s25 offen offset:0 lds
    v_mul_f32 v177, v177, v161
    v_cvt_pk_bf16_f32 v132, v176, v177
    v_mfma_f32_16x16x32_bf16 a[52:55], a[220:223], v[124:127], a[52:55]
    ds_read_b128 a[200:203], v201 offset:18432
    v_fma_f32 v178, v162, v162, s27
    v_mfma_f32_16x16x32_bf16 a[52:55], a[216:219], v[120:123], a[52:55]
    ds_read_b128 a[204:207], v201 offset:19456
    v_mul_f32 v178, v178, v162
    v_mfma_f32_16x16x32_bf16 a[52:55], a[212:215], v[116:119], a[52:55]
    s_waitcnt lgkmcnt(4)
    v_exp_f32 v178, v178
    v_mfma_f32_16x16x32_bf16 a[52:55], a[208:211], v[112:115], a[52:55]
    ds_read_b128 a[208:211], v201 offset:8192
    v_fma_f32 v178, v178, s28, s28
    v_mfma_f32_16x16x32_bf16 v[168:171], a[224:227], v[16:19], v[168:171]
    s_mov_b32 s26, 356352
    v_rcp_f32 v178, v178
    v_mfma_f32_16x16x32_bf16 v[168:171], a[228:231], v[20:23], v[168:171]
    buffer_load_dwordx4 v203, s[8:11], s25 offen offset:1024 lds
    v_mul_f32 v178, v178, v162
    v_mfma_f32_16x16x32_bf16 v[168:171], a[232:235], v[24:27], v[168:171]
    ds_read_b128 a[212:215], v201 offset:9216
    v_fma_f32 v179, v163, v163, s27
    v_mfma_f32_16x16x32_bf16 v[168:171], a[236:239], v[28:31], v[168:171]
    ds_read_b128 a[216:219], v201 offset:10240
    v_mul_f32 v179, v179, v163
    v_mfma_f32_16x16x32_bf16 v[172:175], a[236:239], v[76:79], v[172:175]
    v_exp_f32 v179, v179
    v_mfma_f32_16x16x32_bf16 v[172:175], a[232:235], v[72:75], v[172:175]
    ds_read_b128 a[220:223], v201 offset:11264
    v_fma_f32 v179, v179, s28, s28
    v_mfma_f32_16x16x32_bf16 v[172:175], a[228:231], v[68:71], v[172:175]
    s_waitcnt lgkmcnt(4)
    v_rcp_f32 v179, v179
    v_mfma_f32_16x16x32_bf16 v[172:175], a[224:227], v[64:67], v[172:175]
    buffer_load_dwordx4 v203, s[8:11], s25 offen offset:2048 lds
    v_mul_f32 v179, v179, v163
    v_cvt_pk_bf16_f32 v133, v178, v179
    v_mfma_f32_16x16x32_bf16 a[56:59], a[192:195], v[96:99], a[56:59]
    ds_read_b128 a[224:227], v201 offset:20480
    v_fma_f32 v180, v164, v164, s27
    v_mfma_f32_16x16x32_bf16 a[56:59], a[196:199], v[100:103], a[56:59]
    ds_read_b128 a[228:231], v201 offset:21504
    v_mul_f32 v180, v180, v164
    v_mfma_f32_16x16x32_bf16 a[56:59], a[200:203], v[104:107], a[56:59]
    s_add_u32 m0, s24, 36864
    v_exp_f32 v180, v180
    v_mfma_f32_16x16x32_bf16 a[56:59], a[204:207], v[108:111], a[56:59]
    ds_read_b128 a[232:235], v201 offset:22528
    v_fma_f32 v180, v180, s28, s28
    v_mfma_f32_16x16x32_bf16 a[60:63], a[204:207], v[124:127], a[60:63]
    s_waitcnt lgkmcnt(3)
    v_rcp_f32 v180, v180
    v_mfma_f32_16x16x32_bf16 a[60:63], a[200:203], v[120:123], a[60:63]
    buffer_load_dwordx4 v203, s[8:11], s26 offen offset:0 lds
    v_mul_f32 v180, v180, v164
    v_mfma_f32_16x16x32_bf16 a[60:63], a[196:199], v[116:119], a[60:63]
    ds_read_b128 a[236:239], v201 offset:23552
    v_fma_f32 v181, v165, v165, s27
    v_mfma_f32_16x16x32_bf16 a[60:63], a[192:195], v[112:115], a[60:63]
    ds_read_b128 a[192:195], v201 offset:24576
    v_mul_f32 v181, v181, v165
    v_mfma_f32_16x16x32_bf16 v[168:171], a[208:211], v[32:35], v[168:171]
    v_exp_f32 v181, v181
    v_mfma_f32_16x16x32_bf16 v[168:171], a[212:215], v[36:39], v[168:171]
    ds_read_b128 a[196:199], v201 offset:25600
    v_fma_f32 v181, v181, s28, s28
    v_mfma_f32_16x16x32_bf16 v[168:171], a[216:219], v[40:43], v[168:171]
    v_rcp_f32 v181, v181
    v_mfma_f32_16x16x32_bf16 v[168:171], a[220:223], v[44:47], v[168:171]
    buffer_load_dwordx4 v203, s[8:11], s26 offen offset:1024 lds
    v_mul_f32 v181, v181, v165
    v_cvt_pk_bf16_f32 v148, v180, v181
    v_mfma_f32_16x16x32_bf16 v[172:175], a[220:223], v[92:95], v[172:175]
    ds_read_b128 a[200:203], v201 offset:26624
    v_fma_f32 v182, v166, v166, s27
    v_mfma_f32_16x16x32_bf16 v[172:175], a[216:219], v[88:91], v[172:175]
    ds_read_b128 a[204:207], v201 offset:27648
    v_mul_f32 v182, v182, v166
    v_mfma_f32_16x16x32_bf16 v[172:175], a[212:215], v[84:87], v[172:175]
    s_waitcnt lgkmcnt(4)
    v_exp_f32 v182, v182
    v_mfma_f32_16x16x32_bf16 v[172:175], a[208:211], v[80:83], v[172:175]
    ds_read_b128 a[208:211], v201 offset:36864
    v_fma_f32 v182, v182, s28, s28
    v_mfma_f32_16x16x32_bf16 a[64:67], a[224:227], v[96:99], a[64:67]
    v_rcp_f32 v182, v182
    v_mfma_f32_16x16x32_bf16 a[64:67], a[228:231], v[100:103], a[64:67]
    buffer_load_dwordx4 v203, s[8:11], s26 offen offset:2048 lds
    v_mul_f32 v182, v182, v166
    v_mfma_f32_16x16x32_bf16 a[64:67], a[232:235], v[104:107], a[64:67]
    ds_read_b128 a[212:215], v201 offset:37888
    v_fma_f32 v183, v167, v167, s27
    v_mfma_f32_16x16x32_bf16 a[64:67], a[236:239], v[108:111], a[64:67]
    ds_read_b128 a[216:219], v201 offset:38912
    v_mul_f32 v183, v183, v167
    v_mfma_f32_16x16x32_bf16 a[68:71], a[236:239], v[124:127], a[68:71]
    s_waitcnt vmcnt(6)
    v_exp_f32 v183, v183
    v_mfma_f32_16x16x32_bf16 a[68:71], a[232:235], v[120:123], a[68:71]
    ds_read_b128 a[220:223], v201 offset:39936
    v_fma_f32 v183, v183, s28, s28
    v_mfma_f32_16x16x32_bf16 a[68:71], a[228:231], v[116:119], a[68:71]
    s_waitcnt lgkmcnt(4)
    v_rcp_f32 v183, v183
    v_mfma_f32_16x16x32_bf16 a[68:71], a[224:227], v[112:115], a[68:71]
    s_nop 0
    v_mul_f32 v183, v183, v167
    v_cvt_pk_bf16_f32 v149, v182, v183
    v_mfma_f32_16x16x32_bf16 a[120:123], a[244:247], a[112:115], 0
    v_mfma_f32_16x16x32_bf16 a[112:115], a[240:243], a[112:115], 0
    ds_read_b128 a[144:147], v199 offset:12288
    v_mfma_f32_16x16x32_bf16 a[124:127], a[244:247], a[116:119], 0
    v_mfma_f32_16x16x32_bf16 a[116:119], a[240:243], a[116:119], 0
    ds_read_b128 a[148:151], v199 offset:13312
    v_mfma_f32_16x16x32_bf16 a[136:139], a[244:247], a[128:131], 0
    v_mfma_f32_16x16x32_bf16 a[128:131], a[240:243], a[128:131], 0
    ds_read_b128 a[160:163], v199 offset:14336
    v_mfma_f32_16x16x32_bf16 a[140:143], a[244:247], a[132:135], 0
    v_mfma_f32_16x16x32_bf16 a[132:135], a[240:243], a[132:135], 0
    v_mfma_f32_16x16x32_bf16 v[160:163], a[192:195], v[0:3], 0
    ds_read_b128 a[224:227], v201 offset:28672
    v_fma_f32 v176, v168, v168, s27
    v_mfma_f32_16x16x32_bf16 v[160:163], a[196:199], v[4:7], v[160:163]
    ds_read_b128 a[228:231], v201 offset:29696
    v_mul_f32 v176, v176, v168
    v_mfma_f32_16x16x32_bf16 v[160:163], a[200:203], v[8:11], v[160:163]
    s_barrier
    v_exp_f32 v176, v176
    v_mfma_f32_16x16x32_bf16 v[160:163], a[204:207], v[12:15], v[160:163]
    ds_read_b128 a[232:235], v201 offset:30720
    v_fma_f32 v176, v176, s28, s28
    v_mfma_f32_16x16x32_bf16 v[164:167], a[204:207], v[60:63], 0
    s_waitcnt lgkmcnt(6)
    v_rcp_f32 v176, v176
    v_mfma_f32_16x16x32_bf16 v[164:167], a[200:203], v[56:59], v[164:167]
    s_add_u32 m0, s24, 49152
    v_mul_f32 v176, v176, v168
    v_mfma_f32_16x16x32_bf16 v[164:167], a[196:199], v[52:55], v[164:167]
    ds_read_b128 a[236:239], v201 offset:31744
    v_fma_f32 v177, v169, v169, s27
    v_mfma_f32_16x16x32_bf16 v[164:167], a[192:195], v[48:51], v[164:167]
    ds_read_b128 a[192:195], v201 offset:40960
    v_mul_f32 v177, v177, v169
    v_mfma_f32_16x16x32_bf16 a[72:75], a[208:211], v[96:99], a[72:75]
    s_mov_b32 s25, 368640
    v_exp_f32 v177, v177
    v_mfma_f32_16x16x32_bf16 a[72:75], a[212:215], v[100:103], a[72:75]
    ds_read_b128 a[196:199], v201 offset:41984
    v_fma_f32 v177, v177, s28, s28
    v_mfma_f32_16x16x32_bf16 a[72:75], a[216:219], v[104:107], a[72:75]
    v_rcp_f32 v177, v177
    v_mfma_f32_16x16x32_bf16 a[72:75], a[220:223], v[108:111], a[72:75]
    buffer_load_dwordx4 v203, s[8:11], s25 offen offset:0 lds
    v_mul_f32 v177, v177, v169
    v_cvt_pk_bf16_f32 v134, v176, v177
    v_mfma_f32_16x16x32_bf16 a[76:79], a[220:223], v[124:127], a[76:79]
    ds_read_b128 a[200:203], v201 offset:43008
    v_fma_f32 v178, v170, v170, s27
    v_mfma_f32_16x16x32_bf16 a[76:79], a[216:219], v[120:123], a[76:79]
    ds_read_b128 a[204:207], v201 offset:44032
    v_mul_f32 v178, v178, v170
    v_mfma_f32_16x16x32_bf16 a[76:79], a[212:215], v[116:119], a[76:79]
    s_waitcnt lgkmcnt(4)
    v_exp_f32 v178, v178
    v_mfma_f32_16x16x32_bf16 a[76:79], a[208:211], v[112:115], a[76:79]
    ds_read_b128 a[208:211], v201 offset:32768
    v_fma_f32 v178, v178, s28, s28
    v_mfma_f32_16x16x32_bf16 v[160:163], a[224:227], v[16:19], v[160:163]
    s_mov_b32 s26, 380928
    v_rcp_f32 v178, v178
    v_mfma_f32_16x16x32_bf16 v[160:163], a[228:231], v[20:23], v[160:163]
    buffer_load_dwordx4 v203, s[8:11], s25 offen offset:1024 lds
    v_mul_f32 v178, v178, v170
    v_mfma_f32_16x16x32_bf16 v[160:163], a[232:235], v[24:27], v[160:163]
    ds_read_b128 a[212:215], v201 offset:33792
    v_fma_f32 v179, v171, v171, s27
    v_mfma_f32_16x16x32_bf16 v[160:163], a[236:239], v[28:31], v[160:163]
    ds_read_b128 a[216:219], v201 offset:34816
    v_mul_f32 v179, v179, v171
    v_mfma_f32_16x16x32_bf16 v[164:167], a[236:239], v[76:79], v[164:167]
    v_exp_f32 v179, v179
    v_mfma_f32_16x16x32_bf16 v[164:167], a[232:235], v[72:75], v[164:167]
    ds_read_b128 a[220:223], v201 offset:35840
    v_fma_f32 v179, v179, s28, s28
    v_mfma_f32_16x16x32_bf16 v[164:167], a[228:231], v[68:71], v[164:167]
    s_waitcnt lgkmcnt(4)
    v_rcp_f32 v179, v179
    v_mfma_f32_16x16x32_bf16 v[164:167], a[224:227], v[64:67], v[164:167]
    buffer_load_dwordx4 v203, s[8:11], s25 offen offset:2048 lds
    v_mul_f32 v179, v179, v171
    v_cvt_pk_bf16_f32 v135, v178, v179
    v_mfma_f32_16x16x32_bf16 a[80:83], a[192:195], v[96:99], a[80:83]
    ds_read_b128 a[224:227], v201 offset:45056
    v_fma_f32 v180, v172, v172, s27
    v_mfma_f32_16x16x32_bf16 a[80:83], a[196:199], v[100:103], a[80:83]
    ds_read_b128 a[228:231], v201 offset:46080
    v_mul_f32 v180, v180, v172
    v_mfma_f32_16x16x32_bf16 a[80:83], a[200:203], v[104:107], a[80:83]
    s_add_u32 m0, s24, 61440
    v_exp_f32 v180, v180
    v_mfma_f32_16x16x32_bf16 a[80:83], a[204:207], v[108:111], a[80:83]
    ds_read_b128 a[232:235], v201 offset:47104
    v_fma_f32 v180, v180, s28, s28
    v_mfma_f32_16x16x32_bf16 a[84:87], a[204:207], v[124:127], a[84:87]
    s_waitcnt lgkmcnt(3)
    v_rcp_f32 v180, v180
    v_mfma_f32_16x16x32_bf16 a[84:87], a[200:203], v[120:123], a[84:87]
    buffer_load_dwordx4 v203, s[8:11], s26 offen offset:0 lds
    v_mul_f32 v180, v180, v172
    v_mfma_f32_16x16x32_bf16 a[84:87], a[196:199], v[116:119], a[84:87]
    ds_read_b128 a[236:239], v201 offset:48128
    v_fma_f32 v181, v173, v173, s27
    v_mfma_f32_16x16x32_bf16 a[84:87], a[192:195], v[112:115], a[84:87]
    ds_read_b128 a[192:195], v200 offset:0
    v_mul_f32 v181, v181, v173
    v_mfma_f32_16x16x32_bf16 v[160:163], a[208:211], v[32:35], v[160:163]
    v_exp_f32 v181, v181
    v_mfma_f32_16x16x32_bf16 v[160:163], a[212:215], v[36:39], v[160:163]
    ds_read_b128 a[196:199], v200 offset:1024
    v_fma_f32 v181, v181, s28, s28
    v_mfma_f32_16x16x32_bf16 v[160:163], a[216:219], v[40:43], v[160:163]
    v_rcp_f32 v181, v181
    v_mfma_f32_16x16x32_bf16 v[160:163], a[220:223], v[44:47], v[160:163]
    buffer_load_dwordx4 v203, s[8:11], s26 offen offset:1024 lds
    v_mul_f32 v181, v181, v173
    v_cvt_pk_bf16_f32 v150, v180, v181
    v_mfma_f32_16x16x32_bf16 v[164:167], a[220:223], v[92:95], v[164:167]
    ds_read_b128 a[200:203], v200 offset:2048
    v_fma_f32 v182, v174, v174, s27
    v_mfma_f32_16x16x32_bf16 v[164:167], a[216:219], v[88:91], v[164:167]
    ds_read_b128 a[204:207], v200 offset:3072
    v_mul_f32 v182, v182, v174
    v_mfma_f32_16x16x32_bf16 v[164:167], a[212:215], v[84:87], v[164:167]
    s_waitcnt lgkmcnt(4)
    v_exp_f32 v182, v182
    v_mfma_f32_16x16x32_bf16 v[164:167], a[208:211], v[80:83], v[164:167]
    ds_read_b128 a[208:211], v200 offset:12288
    v_fma_f32 v182, v182, s28, s28
    v_mfma_f32_16x16x32_bf16 a[88:91], a[224:227], v[96:99], a[88:91]
    v_rcp_f32 v182, v182
    v_mfma_f32_16x16x32_bf16 a[88:91], a[228:231], v[100:103], a[88:91]
    buffer_load_dwordx4 v203, s[8:11], s26 offen offset:2048 lds
    v_mul_f32 v182, v182, v174
    v_mfma_f32_16x16x32_bf16 a[88:91], a[232:235], v[104:107], a[88:91]
    ds_read_b128 a[212:215], v200 offset:13312
    v_fma_f32 v183, v175, v175, s27
    v_mfma_f32_16x16x32_bf16 a[88:91], a[236:239], v[108:111], a[88:91]
    ds_read_b128 a[216:219], v200 offset:14336
    v_mul_f32 v183, v183, v175
    v_mfma_f32_16x16x32_bf16 a[92:95], a[236:239], v[124:127], a[92:95]
    s_waitcnt vmcnt(6)
    v_exp_f32 v183, v183
    v_mfma_f32_16x16x32_bf16 a[92:95], a[232:235], v[120:123], a[92:95]
    ds_read_b128 a[220:223], v200 offset:15360
    v_fma_f32 v183, v183, s28, s28
    v_mfma_f32_16x16x32_bf16 a[92:95], a[228:231], v[116:119], a[92:95]
    s_waitcnt lgkmcnt(4)
    v_rcp_f32 v183, v183
    v_mfma_f32_16x16x32_bf16 a[92:95], a[224:227], v[112:115], a[92:95]
    s_nop 0
    v_mul_f32 v183, v183, v175
    v_cvt_pk_bf16_f32 v151, v182, v183
    v_mfma_f32_16x16x32_bf16 a[152:155], a[244:247], a[144:147], 0
    ds_read_b128 a[164:167], v199 offset:0
    v_mfma_f32_16x16x32_bf16 a[144:147], a[240:243], a[144:147], 0
    ds_read_b128 a[176:179], v199 offset:1024
    v_mfma_f32_16x16x32_bf16 a[156:159], a[244:247], a[148:151], 0
    ds_read_b128 a[180:183], v199 offset:2048
    v_mfma_f32_16x16x32_bf16 a[148:151], a[240:243], a[148:151], 0
    v_mfma_f32_16x16x32_bf16 v[168:171], a[192:195], v[0:3], 0
    ds_read_b128 a[224:227], v200 offset:4096
    v_fma_f32 v176, v160, v160, s27
    v_mfma_f32_16x16x32_bf16 v[168:171], a[196:199], v[4:7], v[168:171]
    ds_read_b128 a[228:231], v200 offset:5120
    v_mul_f32 v176, v176, v160
    v_mfma_f32_16x16x32_bf16 v[168:171], a[200:203], v[8:11], v[168:171]
    s_barrier
    v_exp_f32 v176, v176
    v_mfma_f32_16x16x32_bf16 v[168:171], a[204:207], v[12:15], v[168:171]
    ds_read_b128 a[232:235], v200 offset:6144
    v_fma_f32 v176, v176, s28, s28
    v_mfma_f32_16x16x32_bf16 v[172:175], a[204:207], v[60:63], 0
    s_waitcnt lgkmcnt(6)
    v_rcp_f32 v176, v176
    v_mfma_f32_16x16x32_bf16 v[172:175], a[200:203], v[56:59], v[172:175]
    s_add_u32 m0, s24, 73728
    v_mul_f32 v176, v176, v160
    v_mfma_f32_16x16x32_bf16 v[172:175], a[196:199], v[52:55], v[172:175]
    ds_read_b128 a[236:239], v200 offset:7168
    v_fma_f32 v177, v161, v161, s27
    v_mfma_f32_16x16x32_bf16 v[172:175], a[192:195], v[48:51], v[172:175]
    ds_read_b128 a[192:195], v200 offset:16384
    v_mul_f32 v177, v177, v161
    v_mfma_f32_16x16x32_bf16 a[96:99], a[208:211], v[96:99], a[96:99]
    s_mov_b32 s25, 393216
    v_exp_f32 v177, v177
    v_mfma_f32_16x16x32_bf16 a[96:99], a[212:215], v[100:103], a[96:99]
    ds_read_b128 a[196:199], v200 offset:17408
    v_fma_f32 v177, v177, s28, s28
    v_mfma_f32_16x16x32_bf16 a[96:99], a[216:219], v[104:107], a[96:99]
    v_rcp_f32 v177, v177
    v_mfma_f32_16x16x32_bf16 a[96:99], a[220:223], v[108:111], a[96:99]
    buffer_load_dwordx4 v203, s[8:11], s25 offen offset:0 lds
    v_mul_f32 v177, v177, v161
    v_cvt_pk_bf16_f32 v136, v176, v177
    v_mfma_f32_16x16x32_bf16 a[100:103], a[220:223], v[124:127], a[100:103]
    ds_read_b128 a[200:203], v200 offset:18432
    v_fma_f32 v178, v162, v162, s27
    v_mfma_f32_16x16x32_bf16 a[100:103], a[216:219], v[120:123], a[100:103]
    ds_read_b128 a[204:207], v200 offset:19456
    v_mul_f32 v178, v178, v162
    v_mfma_f32_16x16x32_bf16 a[100:103], a[212:215], v[116:119], a[100:103]
    s_waitcnt lgkmcnt(4)
    v_exp_f32 v178, v178
    v_mfma_f32_16x16x32_bf16 a[100:103], a[208:211], v[112:115], a[100:103]
    ds_read_b128 a[208:211], v200 offset:8192
    v_fma_f32 v178, v178, s28, s28
    v_mfma_f32_16x16x32_bf16 v[168:171], a[224:227], v[16:19], v[168:171]
    s_mov_b32 s26, 405504
    v_rcp_f32 v178, v178
    v_mfma_f32_16x16x32_bf16 v[168:171], a[228:231], v[20:23], v[168:171]
    buffer_load_dwordx4 v203, s[8:11], s25 offen offset:1024 lds
    v_mul_f32 v178, v178, v162
    v_mfma_f32_16x16x32_bf16 v[168:171], a[232:235], v[24:27], v[168:171]
    ds_read_b128 a[212:215], v200 offset:9216
    v_fma_f32 v179, v163, v163, s27
    v_mfma_f32_16x16x32_bf16 v[168:171], a[236:239], v[28:31], v[168:171]
    ds_read_b128 a[216:219], v200 offset:10240
    v_mul_f32 v179, v179, v163
    v_mfma_f32_16x16x32_bf16 v[172:175], a[236:239], v[76:79], v[172:175]
    v_exp_f32 v179, v179
    v_mfma_f32_16x16x32_bf16 v[172:175], a[232:235], v[72:75], v[172:175]
    ds_read_b128 a[220:223], v200 offset:11264
    v_fma_f32 v179, v179, s28, s28
    v_mfma_f32_16x16x32_bf16 v[172:175], a[228:231], v[68:71], v[172:175]
    s_waitcnt lgkmcnt(4)
    v_rcp_f32 v179, v179
    v_mfma_f32_16x16x32_bf16 v[172:175], a[224:227], v[64:67], v[172:175]
    buffer_load_dwordx4 v203, s[8:11], s25 offen offset:2048 lds
    v_mul_f32 v179, v179, v163
    v_cvt_pk_bf16_f32 v137, v178, v179
    v_mfma_f32_16x16x32_bf16 a[104:107], a[192:195], v[96:99], a[104:107]
    ds_read_b128 a[224:227], v200 offset:20480
    v_fma_f32 v180, v164, v164, s27
    v_mfma_f32_16x16x32_bf16 a[104:107], a[196:199], v[100:103], a[104:107]
    ds_read_b128 a[228:231], v200 offset:21504
    v_mul_f32 v180, v180, v164
    v_mfma_f32_16x16x32_bf16 a[104:107], a[200:203], v[104:107], a[104:107]
    s_add_u32 m0, s24, 86016
    v_exp_f32 v180, v180
    v_mfma_f32_16x16x32_bf16 a[104:107], a[204:207], v[108:111], a[104:107]
    ds_read_b128 a[232:235], v200 offset:22528
    v_fma_f32 v180, v180, s28, s28
    v_mfma_f32_16x16x32_bf16 a[108:111], a[204:207], v[124:127], a[108:111]
    s_waitcnt lgkmcnt(3)
    v_rcp_f32 v180, v180
    v_mfma_f32_16x16x32_bf16 a[108:111], a[200:203], v[120:123], a[108:111]
    buffer_load_dwordx4 v203, s[8:11], s26 offen offset:0 lds
    v_mul_f32 v180, v180, v164
    v_mfma_f32_16x16x32_bf16 a[108:111], a[196:199], v[116:119], a[108:111]
    ds_read_b128 a[236:239], v200 offset:23552
    v_fma_f32 v181, v165, v165, s27
    v_mfma_f32_16x16x32_bf16 a[108:111], a[192:195], v[112:115], a[108:111]
    ds_read_b128 a[192:195], v200 offset:24576
    v_mul_f32 v181, v181, v165
    v_mfma_f32_16x16x32_bf16 v[168:171], a[208:211], v[32:35], v[168:171]
    v_exp_f32 v181, v181
    v_mfma_f32_16x16x32_bf16 v[168:171], a[212:215], v[36:39], v[168:171]
    ds_read_b128 a[196:199], v200 offset:25600
    v_fma_f32 v181, v181, s28, s28
    v_mfma_f32_16x16x32_bf16 v[168:171], a[216:219], v[40:43], v[168:171]
    v_rcp_f32 v181, v181
    v_mfma_f32_16x16x32_bf16 v[168:171], a[220:223], v[44:47], v[168:171]
    buffer_load_dwordx4 v203, s[8:11], s26 offen offset:1024 lds
    v_mul_f32 v181, v181, v165
    v_cvt_pk_bf16_f32 v152, v180, v181
    v_mfma_f32_16x16x32_bf16 v[172:175], a[220:223], v[92:95], v[172:175]
    ds_read_b128 a[200:203], v200 offset:26624
    v_fma_f32 v182, v166, v166, s27
    v_mfma_f32_16x16x32_bf16 v[172:175], a[216:219], v[88:91], v[172:175]
    ds_read_b128 a[204:207], v200 offset:27648
    v_mul_f32 v182, v182, v166
    v_mfma_f32_16x16x32_bf16 v[172:175], a[212:215], v[84:87], v[172:175]
    s_waitcnt lgkmcnt(4)
    v_exp_f32 v182, v182
    v_mfma_f32_16x16x32_bf16 v[172:175], a[208:211], v[80:83], v[172:175]
    ds_read_b128 a[208:211], v200 offset:36864
    v_fma_f32 v182, v182, s28, s28
    v_mfma_f32_16x16x32_bf16 a[112:115], a[224:227], v[96:99], a[112:115]
    v_rcp_f32 v182, v182
    v_mfma_f32_16x16x32_bf16 a[112:115], a[228:231], v[100:103], a[112:115]
    buffer_load_dwordx4 v203, s[8:11], s26 offen offset:2048 lds
    v_mul_f32 v182, v182, v166
    v_mfma_f32_16x16x32_bf16 a[112:115], a[232:235], v[104:107], a[112:115]
    ds_read_b128 a[212:215], v200 offset:37888
    v_fma_f32 v183, v167, v167, s27
    v_mfma_f32_16x16x32_bf16 a[112:115], a[236:239], v[108:111], a[112:115]
    ds_read_b128 a[216:219], v200 offset:38912
    v_mul_f32 v183, v183, v167
    v_mfma_f32_16x16x32_bf16 a[116:119], a[236:239], v[124:127], a[116:119]
    s_waitcnt vmcnt(6)
    v_exp_f32 v183, v183
    v_mfma_f32_16x16x32_bf16 a[116:119], a[232:235], v[120:123], a[116:119]
    ds_read_b128 a[220:223], v200 offset:39936
    v_fma_f32 v183, v183, s28, s28
    v_mfma_f32_16x16x32_bf16 a[116:119], a[228:231], v[116:119], a[116:119]
    s_waitcnt lgkmcnt(4)
    v_rcp_f32 v183, v183
    v_mfma_f32_16x16x32_bf16 a[116:119], a[224:227], v[112:115], a[116:119]
    s_nop 0
    v_mul_f32 v183, v183, v167
    v_cvt_pk_bf16_f32 v153, v182, v183
    v_mfma_f32_16x16x32_bf16 a[168:171], a[244:247], a[160:163], 0
    v_mfma_f32_16x16x32_bf16 a[160:163], a[240:243], a[160:163], 0
    v_mfma_f32_16x16x32_bf16 a[172:175], a[244:247], a[164:167], 0
    v_mfma_f32_16x16x32_bf16 a[164:167], a[240:243], a[164:167], 0
    v_mfma_f32_16x16x32_bf16 a[184:187], a[244:247], a[176:179], 0
    v_mfma_f32_16x16x32_bf16 a[176:179], a[240:243], a[176:179], 0
    v_mfma_f32_16x16x32_bf16 a[188:191], a[244:247], a[180:183], 0
    v_mfma_f32_16x16x32_bf16 a[180:183], a[240:243], a[180:183], 0
    v_mfma_f32_16x16x32_bf16 v[160:163], a[192:195], v[0:3], 0
    ds_read_b128 a[224:227], v200 offset:28672
    v_fma_f32 v176, v168, v168, s27
    v_mfma_f32_16x16x32_bf16 v[160:163], a[196:199], v[4:7], v[160:163]
    ds_read_b128 a[228:231], v200 offset:29696
    v_mul_f32 v176, v176, v168
    v_mfma_f32_16x16x32_bf16 v[160:163], a[200:203], v[8:11], v[160:163]
    s_barrier
    v_exp_f32 v176, v176
    v_mfma_f32_16x16x32_bf16 v[160:163], a[204:207], v[12:15], v[160:163]
    ds_read_b128 a[232:235], v200 offset:30720
    v_fma_f32 v176, v176, s28, s28
    v_mfma_f32_16x16x32_bf16 v[164:167], a[204:207], v[60:63], 0
    s_waitcnt lgkmcnt(3)
    v_rcp_f32 v176, v176
    v_mfma_f32_16x16x32_bf16 v[164:167], a[200:203], v[56:59], v[164:167]
    s_add_u32 m0, s24, 0
    v_mul_f32 v176, v176, v168
    v_mfma_f32_16x16x32_bf16 v[164:167], a[196:199], v[52:55], v[164:167]
    ds_read_b128 a[236:239], v200 offset:31744
    v_fma_f32 v177, v169, v169, s27
    v_mfma_f32_16x16x32_bf16 v[164:167], a[192:195], v[48:51], v[164:167]
    ds_read_b128 a[192:195], v200 offset:40960
    v_mul_f32 v177, v177, v169
    v_mfma_f32_16x16x32_bf16 a[120:123], a[208:211], v[96:99], a[120:123]
    s_mov_b32 s25, 417792
    v_exp_f32 v177, v177
    v_mfma_f32_16x16x32_bf16 a[120:123], a[212:215], v[100:103], a[120:123]
    ds_read_b128 a[196:199], v200 offset:41984
    v_fma_f32 v177, v177, s28, s28
    v_mfma_f32_16x16x32_bf16 a[120:123], a[216:219], v[104:107], a[120:123]
    v_rcp_f32 v177, v177
    v_mfma_f32_16x16x32_bf16 a[120:123], a[220:223], v[108:111], a[120:123]
    buffer_load_dwordx4 v203, s[8:11], s25 offen offset:0 lds
    v_mul_f32 v177, v177, v169
    v_cvt_pk_bf16_f32 v138, v176, v177
    v_mfma_f32_16x16x32_bf16 a[124:127], a[220:223], v[124:127], a[124:127]
    ds_read_b128 a[200:203], v200 offset:43008
    v_fma_f32 v178, v170, v170, s27
    v_mfma_f32_16x16x32_bf16 a[124:127], a[216:219], v[120:123], a[124:127]
    ds_read_b128 a[204:207], v200 offset:44032
    v_mul_f32 v178, v178, v170
    v_mfma_f32_16x16x32_bf16 a[124:127], a[212:215], v[116:119], a[124:127]
    s_waitcnt lgkmcnt(4)
    v_exp_f32 v178, v178
    v_mfma_f32_16x16x32_bf16 a[124:127], a[208:211], v[112:115], a[124:127]
    ds_read_b128 a[208:211], v200 offset:32768
    v_fma_f32 v178, v178, s28, s28
    v_mfma_f32_16x16x32_bf16 v[160:163], a[224:227], v[16:19], v[160:163]
    s_mov_b32 s26, 430080
    v_rcp_f32 v178, v178
    v_mfma_f32_16x16x32_bf16 v[160:163], a[228:231], v[20:23], v[160:163]
    buffer_load_dwordx4 v203, s[8:11], s25 offen offset:1024 lds
    v_mul_f32 v178, v178, v170
    v_mfma_f32_16x16x32_bf16 v[160:163], a[232:235], v[24:27], v[160:163]
    ds_read_b128 a[212:215], v200 offset:33792
    v_fma_f32 v179, v171, v171, s27
    v_mfma_f32_16x16x32_bf16 v[160:163], a[236:239], v[28:31], v[160:163]
    ds_read_b128 a[216:219], v200 offset:34816
    v_mul_f32 v179, v179, v171
    v_mfma_f32_16x16x32_bf16 v[164:167], a[236:239], v[76:79], v[164:167]
    v_exp_f32 v179, v179
    v_mfma_f32_16x16x32_bf16 v[164:167], a[232:235], v[72:75], v[164:167]
    ds_read_b128 a[220:223], v200 offset:35840
    v_fma_f32 v179, v179, s28, s28
    v_mfma_f32_16x16x32_bf16 v[164:167], a[228:231], v[68:71], v[164:167]
    s_waitcnt lgkmcnt(4)
    v_rcp_f32 v179, v179
    v_mfma_f32_16x16x32_bf16 v[164:167], a[224:227], v[64:67], v[164:167]
    buffer_load_dwordx4 v203, s[8:11], s25 offen offset:2048 lds
    v_mul_f32 v179, v179, v171
    v_cvt_pk_bf16_f32 v139, v178, v179
    v_mfma_f32_16x16x32_bf16 a[128:131], a[192:195], v[96:99], a[128:131]
    ds_read_b128 a[224:227], v200 offset:45056
    v_fma_f32 v180, v172, v172, s27
    v_mfma_f32_16x16x32_bf16 a[128:131], a[196:199], v[100:103], a[128:131]
    ds_read_b128 a[228:231], v200 offset:46080
    v_mul_f32 v180, v180, v172
    v_mfma_f32_16x16x32_bf16 a[128:131], a[200:203], v[104:107], a[128:131]
    s_add_u32 m0, s24, 12288
    v_exp_f32 v180, v180
    v_mfma_f32_16x16x32_bf16 a[128:131], a[204:207], v[108:111], a[128:131]
    ds_read_b128 a[232:235], v200 offset:47104
    v_fma_f32 v180, v180, s28, s28
    v_mfma_f32_16x16x32_bf16 a[132:135], a[204:207], v[124:127], a[132:135]
    s_waitcnt lgkmcnt(3)
    v_rcp_f32 v180, v180
    v_mfma_f32_16x16x32_bf16 a[132:135], a[200:203], v[120:123], a[132:135]
    buffer_load_dwordx4 v203, s[8:11], s26 offen offset:0 lds
    v_mul_f32 v180, v180, v172
    v_mfma_f32_16x16x32_bf16 a[132:135], a[196:199], v[116:119], a[132:135]
    ds_read_b128 a[236:239], v200 offset:48128
    v_fma_f32 v181, v173, v173, s27
    v_mfma_f32_16x16x32_bf16 a[132:135], a[192:195], v[112:115], a[132:135]
    ds_read_b128 a[192:195], v201 offset:0
    v_mul_f32 v181, v181, v173
    v_mfma_f32_16x16x32_bf16 v[160:163], a[208:211], v[32:35], v[160:163]
    v_exp_f32 v181, v181
    v_mfma_f32_16x16x32_bf16 v[160:163], a[212:215], v[36:39], v[160:163]
    ds_read_b128 a[196:199], v201 offset:1024
    v_fma_f32 v181, v181, s28, s28
    v_mfma_f32_16x16x32_bf16 v[160:163], a[216:219], v[40:43], v[160:163]
    v_rcp_f32 v181, v181
    v_mfma_f32_16x16x32_bf16 v[160:163], a[220:223], v[44:47], v[160:163]
    buffer_load_dwordx4 v203, s[8:11], s26 offen offset:1024 lds
    v_mul_f32 v181, v181, v173
    v_cvt_pk_bf16_f32 v154, v180, v181
    v_mfma_f32_16x16x32_bf16 v[164:167], a[220:223], v[92:95], v[164:167]
    ds_read_b128 a[200:203], v201 offset:2048
    v_fma_f32 v182, v174, v174, s27
    v_mfma_f32_16x16x32_bf16 v[164:167], a[216:219], v[88:91], v[164:167]
    ds_read_b128 a[204:207], v201 offset:3072
    v_mul_f32 v182, v182, v174
    v_mfma_f32_16x16x32_bf16 v[164:167], a[212:215], v[84:87], v[164:167]
    s_waitcnt lgkmcnt(4)
    v_exp_f32 v182, v182
    v_mfma_f32_16x16x32_bf16 v[164:167], a[208:211], v[80:83], v[164:167]
    ds_read_b128 a[208:211], v201 offset:12288
    v_fma_f32 v182, v182, s28, s28
    v_mfma_f32_16x16x32_bf16 a[136:139], a[224:227], v[96:99], a[136:139]
    v_rcp_f32 v182, v182
    v_mfma_f32_16x16x32_bf16 a[136:139], a[228:231], v[100:103], a[136:139]
    buffer_load_dwordx4 v203, s[8:11], s26 offen offset:2048 lds
    v_mul_f32 v182, v182, v174
    v_mfma_f32_16x16x32_bf16 a[136:139], a[232:235], v[104:107], a[136:139]
    ds_read_b128 a[212:215], v201 offset:13312
    v_fma_f32 v183, v175, v175, s27
    v_mfma_f32_16x16x32_bf16 a[136:139], a[236:239], v[108:111], a[136:139]
    ds_read_b128 a[216:219], v201 offset:14336
    v_mul_f32 v183, v183, v175
    v_mfma_f32_16x16x32_bf16 a[140:143], a[236:239], v[124:127], a[140:143]
    s_waitcnt vmcnt(6)
    v_exp_f32 v183, v183
    v_mfma_f32_16x16x32_bf16 a[140:143], a[232:235], v[120:123], a[140:143]
    ds_read_b128 a[220:223], v201 offset:15360
    v_fma_f32 v183, v183, s28, s28
    v_mfma_f32_16x16x32_bf16 a[140:143], a[228:231], v[116:119], a[140:143]
    s_waitcnt lgkmcnt(4)
    v_rcp_f32 v183, v183
    v_mfma_f32_16x16x32_bf16 a[140:143], a[224:227], v[112:115], a[140:143]
    s_nop 0
    v_mul_f32 v183, v183, v175
    v_cvt_pk_bf16_f32 v155, v182, v183
    s_mov_b32 s25, 417792
    s_mov_b32 s26, 430080
    s_mov_b32 s33, s32
    s_mov_b32 s29, 5
.p2align 6
L_loop:
    v_mfma_f32_16x16x32_bf16 v[168:171], a[192:195], v[0:3], 0
    ds_read_b128 a[224:227], v201 offset:4096
    v_fma_f32 v176, v160, v160, s27
    v_mfma_f32_16x16x32_bf16 v[168:171], a[196:199], v[4:7], v[168:171]
    ds_read_b128 a[228:231], v201 offset:5120
    v_mul_f32 v176, v176, v160
    v_mfma_f32_16x16x32_bf16 v[168:171], a[200:203], v[8:11], v[168:171]
    s_barrier
    v_exp_f32 v176, v176
    v_mfma_f32_16x16x32_bf16 v[168:171], a[204:207], v[12:15], v[168:171]
    ds_read_b128 a[232:235], v201 offset:6144
    v_fma_f32 v176, v176, s28, s28
    v_mfma_f32_16x16x32_bf16 v[172:175], a[204:207], v[60:63], 0
    s_waitcnt lgkmcnt(3)
    v_rcp_f32 v176, v176
    v_mfma_f32_16x16x32_bf16 v[172:175], a[200:203], v[56:59], v[172:175]
    s_add_u32 m0, s24, 24576
    v_mul_f32 v176, v176, v160
    v_mfma_f32_16x16x32_bf16 v[172:175], a[196:199], v[52:55], v[172:175]
    ds_read_b128 a[236:239], v201 offset:7168
    v_fma_f32 v177, v161, v161, s27
    v_mfma_f32_16x16x32_bf16 v[172:175], a[192:195], v[48:51], v[172:175]
    ds_read_b128 a[192:195], v201 offset:16384
    v_mul_f32 v177, v177, v161
    v_mfma_f32_16x16x32_bf16 a[144:147], a[208:211], v[96:99], a[144:147]
    s_add_u32 s25, s25, 24576
    v_exp_f32 v177, v177
    v_mfma_f32_16x16x32_bf16 a[144:147], a[212:215], v[100:103], a[144:147]
    ds_read_b128 a[196:199], v201 offset:17408
    v_fma_f32 v177, v177, s28, s28
    v_mfma_f32_16x16x32_bf16 a[144:147], a[216:219], v[104:107], a[144:147]
    v_rcp_f32 v177, v177
    v_mfma_f32_16x16x32_bf16 a[144:147], a[220:223], v[108:111], a[144:147]
    buffer_load_dwordx4 v203, s[8:11], s25 offen offset:0 lds
    v_mul_f32 v177, v177, v161
    v_cvt_pk_bf16_f32 v140, v176, v177
    v_mfma_f32_16x16x32_bf16 a[148:151], a[220:223], v[124:127], a[148:151]
    ds_read_b128 a[200:203], v201 offset:18432
    v_fma_f32 v178, v162, v162, s27
    v_mfma_f32_16x16x32_bf16 a[148:151], a[216:219], v[120:123], a[148:151]
    ds_read_b128 a[204:207], v201 offset:19456
    v_mul_f32 v178, v178, v162
    v_mfma_f32_16x16x32_bf16 a[148:151], a[212:215], v[116:119], a[148:151]
    s_waitcnt lgkmcnt(4)
    v_exp_f32 v178, v178
    v_mfma_f32_16x16x32_bf16 a[148:151], a[208:211], v[112:115], a[148:151]
    ds_read_b128 a[208:211], v201 offset:8192
    v_fma_f32 v178, v178, s28, s28
    v_mfma_f32_16x16x32_bf16 v[168:171], a[224:227], v[16:19], v[168:171]
    s_add_u32 s26, s26, 24576
    v_rcp_f32 v178, v178
    v_mfma_f32_16x16x32_bf16 v[168:171], a[228:231], v[20:23], v[168:171]
    buffer_load_dwordx4 v203, s[8:11], s25 offen offset:1024 lds
    v_mul_f32 v178, v178, v162
    v_mfma_f32_16x16x32_bf16 v[168:171], a[232:235], v[24:27], v[168:171]
    ds_read_b128 a[212:215], v201 offset:9216
    v_fma_f32 v179, v163, v163, s27
    v_mfma_f32_16x16x32_bf16 v[168:171], a[236:239], v[28:31], v[168:171]
    ds_read_b128 a[216:219], v201 offset:10240
    v_mul_f32 v179, v179, v163
    v_mfma_f32_16x16x32_bf16 v[172:175], a[236:239], v[76:79], v[172:175]
    v_exp_f32 v179, v179
    v_mfma_f32_16x16x32_bf16 v[172:175], a[232:235], v[72:75], v[172:175]
    ds_read_b128 a[220:223], v201 offset:11264
    v_fma_f32 v179, v179, s28, s28
    v_mfma_f32_16x16x32_bf16 v[172:175], a[228:231], v[68:71], v[172:175]
    s_waitcnt lgkmcnt(4)
    v_rcp_f32 v179, v179
    v_mfma_f32_16x16x32_bf16 v[172:175], a[224:227], v[64:67], v[172:175]
    buffer_load_dwordx4 v203, s[8:11], s25 offen offset:2048 lds
    v_mul_f32 v179, v179, v163
    v_cvt_pk_bf16_f32 v141, v178, v179
    v_mfma_f32_16x16x32_bf16 a[152:155], a[192:195], v[96:99], a[152:155]
    ds_read_b128 a[224:227], v201 offset:20480
    v_fma_f32 v180, v164, v164, s27
    v_mfma_f32_16x16x32_bf16 a[152:155], a[196:199], v[100:103], a[152:155]
    ds_read_b128 a[228:231], v201 offset:21504
    v_mul_f32 v180, v180, v164
    v_mfma_f32_16x16x32_bf16 a[152:155], a[200:203], v[104:107], a[152:155]
    s_add_u32 m0, s24, 36864
    v_exp_f32 v180, v180
    v_mfma_f32_16x16x32_bf16 a[152:155], a[204:207], v[108:111], a[152:155]
    ds_read_b128 a[232:235], v201 offset:22528
    v_fma_f32 v180, v180, s28, s28
    v_mfma_f32_16x16x32_bf16 a[156:159], a[204:207], v[124:127], a[156:159]
    s_waitcnt lgkmcnt(3)
    v_rcp_f32 v180, v180
    v_mfma_f32_16x16x32_bf16 a[156:159], a[200:203], v[120:123], a[156:159]
    buffer_load_dwordx4 v203, s[8:11], s26 offen offset:0 lds
    v_mul_f32 v180, v180, v164
    v_mfma_f32_16x16x32_bf16 a[156:159], a[196:199], v[116:119], a[156:159]
    ds_read_b128 a[236:239], v201 offset:23552
    v_fma_f32 v181, v165, v165, s27
    v_mfma_f32_16x16x32_bf16 a[156:159], a[192:195], v[112:115], a[156:159]
    ds_read_b128 a[192:195], v201 offset:24576
    v_mul_f32 v181, v181, v165
    v_mfma_f32_16x16x32_bf16 v[168:171], a[208:211], v[32:35], v[168:171]
    v_exp_f32 v181, v181
    v_mfma_f32_16x16x32_bf16 v[168:171], a[212:215], v[36:39], v[168:171]
    ds_read_b128 a[196:199], v201 offset:25600
    v_fma_f32 v181, v181, s28, s28
    v_mfma_f32_16x16x32_bf16 v[168:171], a[216:219], v[40:43], v[168:171]
    v_rcp_f32 v181, v181
    v_mfma_f32_16x16x32_bf16 v[168:171], a[220:223], v[44:47], v[168:171]
    buffer_load_dwordx4 v203, s[8:11], s26 offen offset:1024 lds
    v_mul_f32 v181, v181, v165
    v_cvt_pk_bf16_f32 v156, v180, v181
    v_mfma_f32_16x16x32_bf16 v[172:175], a[220:223], v[92:95], v[172:175]
    ds_read_b128 a[200:203], v201 offset:26624
    v_fma_f32 v182, v166, v166, s27
    v_mfma_f32_16x16x32_bf16 v[172:175], a[216:219], v[88:91], v[172:175]
    ds_read_b128 a[204:207], v201 offset:27648
    v_mul_f32 v182, v182, v166
    v_mfma_f32_16x16x32_bf16 v[172:175], a[212:215], v[84:87], v[172:175]
    s_waitcnt lgkmcnt(4)
    v_exp_f32 v182, v182
    v_mfma_f32_16x16x32_bf16 v[172:175], a[208:211], v[80:83], v[172:175]
    ds_read_b128 a[208:211], v201 offset:36864
    v_fma_f32 v182, v182, s28, s28
    v_mfma_f32_16x16x32_bf16 a[160:163], a[224:227], v[96:99], a[160:163]
    v_rcp_f32 v182, v182
    v_mfma_f32_16x16x32_bf16 a[160:163], a[228:231], v[100:103], a[160:163]
    buffer_load_dwordx4 v203, s[8:11], s26 offen offset:2048 lds
    v_mul_f32 v182, v182, v166
    v_mfma_f32_16x16x32_bf16 a[160:163], a[232:235], v[104:107], a[160:163]
    ds_read_b128 a[212:215], v201 offset:37888
    v_fma_f32 v183, v167, v167, s27
    v_mfma_f32_16x16x32_bf16 a[160:163], a[236:239], v[108:111], a[160:163]
    ds_read_b128 a[216:219], v201 offset:38912
    v_mul_f32 v183, v183, v167
    v_mfma_f32_16x16x32_bf16 a[164:167], a[236:239], v[124:127], a[164:167]
    s_waitcnt vmcnt(6)
    v_exp_f32 v183, v183
    v_mfma_f32_16x16x32_bf16 a[164:167], a[232:235], v[120:123], a[164:167]
    ds_read_b128 a[220:223], v201 offset:39936
    v_fma_f32 v183, v183, s28, s28
    v_mfma_f32_16x16x32_bf16 a[164:167], a[228:231], v[116:119], a[164:167]
    s_waitcnt lgkmcnt(4)
    v_rcp_f32 v183, v183
    v_mfma_f32_16x16x32_bf16 a[164:167], a[224:227], v[112:115], a[164:167]
    s_nop 0
    v_mul_f32 v183, v183, v167
    v_cvt_pk_bf16_f32 v157, v182, v183
    v_mfma_f32_16x16x32_bf16 v[160:163], a[192:195], v[0:3], 0
    ds_read_b128 a[224:227], v201 offset:28672
    v_fma_f32 v176, v168, v168, s27
    v_mfma_f32_16x16x32_bf16 v[160:163], a[196:199], v[4:7], v[160:163]
    ds_read_b128 a[228:231], v201 offset:29696
    v_mul_f32 v176, v176, v168
    v_mfma_f32_16x16x32_bf16 v[160:163], a[200:203], v[8:11], v[160:163]
    s_barrier
    v_exp_f32 v176, v176
    v_mfma_f32_16x16x32_bf16 v[160:163], a[204:207], v[12:15], v[160:163]
    ds_read_b128 a[232:235], v201 offset:30720
    v_fma_f32 v176, v176, s28, s28
    v_mfma_f32_16x16x32_bf16 v[164:167], a[204:207], v[60:63], 0
    s_waitcnt lgkmcnt(3)
    v_rcp_f32 v176, v176
    v_mfma_f32_16x16x32_bf16 v[164:167], a[200:203], v[56:59], v[164:167]
    s_add_u32 m0, s24, 49152
    v_mul_f32 v176, v176, v168
    v_mfma_f32_16x16x32_bf16 v[164:167], a[196:199], v[52:55], v[164:167]
    ds_read_b128 a[236:239], v201 offset:31744
    v_fma_f32 v177, v169, v169, s27
    v_mfma_f32_16x16x32_bf16 v[164:167], a[192:195], v[48:51], v[164:167]
    ds_read_b128 a[192:195], v201 offset:40960
    v_mul_f32 v177, v177, v169
    v_mfma_f32_16x16x32_bf16 a[168:171], a[208:211], v[96:99], a[168:171]
    s_add_u32 s25, s25, 24576
    v_exp_f32 v177, v177
    v_mfma_f32_16x16x32_bf16 a[168:171], a[212:215], v[100:103], a[168:171]
    ds_read_b128 a[196:199], v201 offset:41984
    v_fma_f32 v177, v177, s28, s28
    v_mfma_f32_16x16x32_bf16 a[168:171], a[216:219], v[104:107], a[168:171]
    v_rcp_f32 v177, v177
    v_mfma_f32_16x16x32_bf16 a[168:171], a[220:223], v[108:111], a[168:171]
    buffer_load_dwordx4 v203, s[8:11], s25 offen offset:0 lds
    v_mul_f32 v177, v177, v169
    v_cvt_pk_bf16_f32 v142, v176, v177
    v_mfma_f32_16x16x32_bf16 a[172:175], a[220:223], v[124:127], a[172:175]
    ds_read_b128 a[200:203], v201 offset:43008
    v_fma_f32 v178, v170, v170, s27
    v_mfma_f32_16x16x32_bf16 a[172:175], a[216:219], v[120:123], a[172:175]
    ds_read_b128 a[204:207], v201 offset:44032
    v_mul_f32 v178, v178, v170
    v_mfma_f32_16x16x32_bf16 a[172:175], a[212:215], v[116:119], a[172:175]
    s_waitcnt lgkmcnt(4)
    v_exp_f32 v178, v178
    v_mfma_f32_16x16x32_bf16 a[172:175], a[208:211], v[112:115], a[172:175]
    ds_read_b128 a[208:211], v201 offset:32768
    v_fma_f32 v178, v178, s28, s28
    v_mfma_f32_16x16x32_bf16 v[160:163], a[224:227], v[16:19], v[160:163]
    s_add_u32 s26, s26, 24576
    v_rcp_f32 v178, v178
    v_mfma_f32_16x16x32_bf16 v[160:163], a[228:231], v[20:23], v[160:163]
    buffer_load_dwordx4 v203, s[8:11], s25 offen offset:1024 lds
    v_mul_f32 v178, v178, v170
    v_mfma_f32_16x16x32_bf16 v[160:163], a[232:235], v[24:27], v[160:163]
    ds_read_b128 a[212:215], v201 offset:33792
    v_fma_f32 v179, v171, v171, s27
    v_mfma_f32_16x16x32_bf16 v[160:163], a[236:239], v[28:31], v[160:163]
    ds_read_b128 a[216:219], v201 offset:34816
    v_mul_f32 v179, v179, v171
    v_mfma_f32_16x16x32_bf16 v[164:167], a[236:239], v[76:79], v[164:167]
    v_exp_f32 v179, v179
    v_mfma_f32_16x16x32_bf16 v[164:167], a[232:235], v[72:75], v[164:167]
    ds_read_b128 a[220:223], v201 offset:35840
    v_fma_f32 v179, v179, s28, s28
    v_mfma_f32_16x16x32_bf16 v[164:167], a[228:231], v[68:71], v[164:167]
    s_waitcnt lgkmcnt(4)
    v_rcp_f32 v179, v179
    v_mfma_f32_16x16x32_bf16 v[164:167], a[224:227], v[64:67], v[164:167]
    buffer_load_dwordx4 v203, s[8:11], s25 offen offset:2048 lds
    v_mul_f32 v179, v179, v171
    v_cvt_pk_bf16_f32 v143, v178, v179
    v_mfma_f32_16x16x32_bf16 a[176:179], a[192:195], v[96:99], a[176:179]
    ds_read_b128 a[224:227], v201 offset:45056
    v_fma_f32 v180, v172, v172, s27
    v_mfma_f32_16x16x32_bf16 a[176:179], a[196:199], v[100:103], a[176:179]
    ds_read_b128 a[228:231], v201 offset:46080
    v_mul_f32 v180, v180, v172
    v_mfma_f32_16x16x32_bf16 a[176:179], a[200:203], v[104:107], a[176:179]
    s_add_u32 m0, s24, 61440
    v_exp_f32 v180, v180
    v_mfma_f32_16x16x32_bf16 a[176:179], a[204:207], v[108:111], a[176:179]
    ds_read_b128 a[232:235], v201 offset:47104
    v_fma_f32 v180, v180, s28, s28
    v_mfma_f32_16x16x32_bf16 a[180:183], a[204:207], v[124:127], a[180:183]
    s_waitcnt lgkmcnt(3)
    v_rcp_f32 v180, v180
    v_mfma_f32_16x16x32_bf16 a[180:183], a[200:203], v[120:123], a[180:183]
    buffer_load_dwordx4 v203, s[8:11], s26 offen offset:0 lds
    v_mul_f32 v180, v180, v172
    v_mfma_f32_16x16x32_bf16 a[180:183], a[196:199], v[116:119], a[180:183]
    ds_read_b128 a[236:239], v201 offset:48128
    v_fma_f32 v181, v173, v173, s27
    v_mfma_f32_16x16x32_bf16 a[180:183], a[192:195], v[112:115], a[180:183]
    ds_read_b128 a[192:195], v200 offset:0
    v_mul_f32 v181, v181, v173
    v_mfma_f32_16x16x32_bf16 v[160:163], a[208:211], v[32:35], v[160:163]
    v_exp_f32 v181, v181
    v_mfma_f32_16x16x32_bf16 v[160:163], a[212:215], v[36:39], v[160:163]
    ds_read_b128 a[196:199], v200 offset:1024
    v_fma_f32 v181, v181, s28, s28
    v_mfma_f32_16x16x32_bf16 v[160:163], a[216:219], v[40:43], v[160:163]
    v_rcp_f32 v181, v181
    v_mfma_f32_16x16x32_bf16 v[160:163], a[220:223], v[44:47], v[160:163]
    buffer_load_dwordx4 v203, s[8:11], s26 offen offset:1024 lds
    v_mul_f32 v181, v181, v173
    v_cvt_pk_bf16_f32 v158, v180, v181
    v_mfma_f32_16x16x32_bf16 v[164:167], a[220:223], v[92:95], v[164:167]
    ds_read_b128 a[200:203], v200 offset:2048
    v_fma_f32 v182, v174, v174, s27
    v_mfma_f32_16x16x32_bf16 v[164:167], a[216:219], v[88:91], v[164:167]
    ds_read_b128 a[204:207], v200 offset:3072
    v_mul_f32 v182, v182, v174
    v_mfma_f32_16x16x32_bf16 v[164:167], a[212:215], v[84:87], v[164:167]
    s_waitcnt lgkmcnt(4)
    v_exp_f32 v182, v182
    v_mfma_f32_16x16x32_bf16 v[164:167], a[208:211], v[80:83], v[164:167]
    ds_read_b128 a[208:211], v200 offset:12288
    v_fma_f32 v182, v182, s28, s28
    v_mfma_f32_16x16x32_bf16 a[184:187], a[224:227], v[96:99], a[184:187]
    v_rcp_f32 v182, v182
    v_mfma_f32_16x16x32_bf16 a[184:187], a[228:231], v[100:103], a[184:187]
    buffer_load_dwordx4 v203, s[8:11], s26 offen offset:2048 lds
    v_mul_f32 v182, v182, v174
    v_mfma_f32_16x16x32_bf16 a[184:187], a[232:235], v[104:107], a[184:187]
    ds_read_b128 a[212:215], v200 offset:13312
    v_fma_f32 v183, v175, v175, s27
    v_mfma_f32_16x16x32_bf16 a[184:187], a[236:239], v[108:111], a[184:187]
    ds_read_b128 a[216:219], v200 offset:14336
    v_mul_f32 v183, v183, v175
    v_mfma_f32_16x16x32_bf16 a[188:191], a[236:239], v[124:127], a[188:191]
    s_waitcnt vmcnt(6)
    v_exp_f32 v183, v183
    v_mfma_f32_16x16x32_bf16 a[188:191], a[232:235], v[120:123], a[188:191]
    ds_read_b128 a[220:223], v200 offset:15360
    v_fma_f32 v183, v183, s28, s28
    v_mfma_f32_16x16x32_bf16 a[188:191], a[228:231], v[116:119], a[188:191]
    s_waitcnt lgkmcnt(4)
    v_rcp_f32 v183, v183
    v_mfma_f32_16x16x32_bf16 a[188:191], a[224:227], v[112:115], a[188:191]
    s_nop 0
    v_mul_f32 v183, v183, v175
    v_cvt_pk_bf16_f32 v159, v182, v183
    v_mfma_f32_16x16x32_bf16 v[168:171], a[192:195], v[0:3], 0
    ds_read_b128 a[224:227], v200 offset:4096
    v_fma_f32 v176, v160, v160, s27
    v_mfma_f32_16x16x32_bf16 v[168:171], a[196:199], v[4:7], v[168:171]
    ds_read_b128 a[228:231], v200 offset:5120
    v_mul_f32 v176, v176, v160
    v_mfma_f32_16x16x32_bf16 v[168:171], a[200:203], v[8:11], v[168:171]
    s_barrier
    v_exp_f32 v176, v176
    v_mfma_f32_16x16x32_bf16 v[168:171], a[204:207], v[12:15], v[168:171]
    ds_read_b128 a[232:235], v200 offset:6144
    v_fma_f32 v176, v176, s28, s28
    v_mfma_f32_16x16x32_bf16 v[172:175], a[204:207], v[60:63], 0
    s_waitcnt lgkmcnt(3)
    v_rcp_f32 v176, v176
    v_mfma_f32_16x16x32_bf16 v[172:175], a[200:203], v[56:59], v[172:175]
    s_add_u32 m0, s24, 73728
    v_mul_f32 v176, v176, v160
    v_mfma_f32_16x16x32_bf16 v[172:175], a[196:199], v[52:55], v[172:175]
    ds_read_b128 a[236:239], v200 offset:7168
    v_fma_f32 v177, v161, v161, s27
    v_mfma_f32_16x16x32_bf16 v[172:175], a[192:195], v[48:51], v[172:175]
    ds_read_b128 a[192:195], v200 offset:16384
    v_mul_f32 v177, v177, v161
    v_mfma_f32_16x16x32_bf16 a[0:3], a[208:211], v[128:131], a[0:3]
    s_add_u32 s25, s25, 24576
    v_exp_f32 v177, v177
    v_mfma_f32_16x16x32_bf16 a[0:3], a[212:215], v[132:135], a[0:3]
    ds_read_b128 a[196:199], v200 offset:17408
    v_fma_f32 v177, v177, s28, s28
    v_mfma_f32_16x16x32_bf16 a[0:3], a[216:219], v[136:139], a[0:3]
    v_rcp_f32 v177, v177
    v_mfma_f32_16x16x32_bf16 a[0:3], a[220:223], v[140:143], a[0:3]
    buffer_load_dwordx4 v203, s[8:11], s25 offen offset:0 lds
    v_mul_f32 v177, v177, v161
    v_cvt_pk_bf16_f32 v96, v176, v177
    v_mfma_f32_16x16x32_bf16 a[4:7], a[220:223], v[156:159], a[4:7]
    ds_read_b128 a[200:203], v200 offset:18432
    v_fma_f32 v178, v162, v162, s27
    v_mfma_f32_16x16x32_bf16 a[4:7], a[216:219], v[152:155], a[4:7]
    ds_read_b128 a[204:207], v200 offset:19456
    v_mul_f32 v178, v178, v162
    v_mfma_f32_16x16x32_bf16 a[4:7], a[212:215], v[148:151], a[4:7]
    s_waitcnt lgkmcnt(4)
    v_exp_f32 v178, v178
    v_mfma_f32_16x16x32_bf16 a[4:7], a[208:211], v[144:147], a[4:7]
    ds_read_b128 a[208:211], v200 offset:8192
    v_fma_f32 v178, v178, s28, s28
    v_mfma_f32_16x16x32_bf16 v[168:171], a[224:227], v[16:19], v[168:171]
    s_add_u32 s26, s26, 24576
    v_rcp_f32 v178, v178
    v_mfma_f32_16x16x32_bf16 v[168:171], a[228:231], v[20:23], v[168:171]
    buffer_load_dwordx4 v203, s[8:11], s25 offen offset:1024 lds
    v_mul_f32 v178, v178, v162
    v_mfma_f32_16x16x32_bf16 v[168:171], a[232:235], v[24:27], v[168:171]
    ds_read_b128 a[212:215], v200 offset:9216
    v_fma_f32 v179, v163, v163, s27
    v_mfma_f32_16x16x32_bf16 v[168:171], a[236:239], v[28:31], v[168:171]
    ds_read_b128 a[216:219], v200 offset:10240
    v_mul_f32 v179, v179, v163
    v_mfma_f32_16x16x32_bf16 v[172:175], a[236:239], v[76:79], v[172:175]
    v_exp_f32 v179, v179
    v_mfma_f32_16x16x32_bf16 v[172:175], a[232:235], v[72:75], v[172:175]
    ds_read_b128 a[220:223], v200 offset:11264
    v_fma_f32 v179, v179, s28, s28
    v_mfma_f32_16x16x32_bf16 v[172:175], a[228:231], v[68:71], v[172:175]
    s_waitcnt lgkmcnt(4)
    v_rcp_f32 v179, v179
    v_mfma_f32_16x16x32_bf16 v[172:175], a[224:227], v[64:67], v[172:175]
    buffer_load_dwordx4 v203, s[8:11], s25 offen offset:2048 lds
    v_mul_f32 v179, v179, v163
    v_cvt_pk_bf16_f32 v97, v178, v179
    v_mfma_f32_16x16x32_bf16 a[8:11], a[192:195], v[128:131], a[8:11]
    ds_read_b128 a[224:227], v200 offset:20480
    v_fma_f32 v180, v164, v164, s27
    v_mfma_f32_16x16x32_bf16 a[8:11], a[196:199], v[132:135], a[8:11]
    ds_read_b128 a[228:231], v200 offset:21504
    v_mul_f32 v180, v180, v164
    v_mfma_f32_16x16x32_bf16 a[8:11], a[200:203], v[136:139], a[8:11]
    s_add_u32 m0, s24, 86016
    v_exp_f32 v180, v180
    v_mfma_f32_16x16x32_bf16 a[8:11], a[204:207], v[140:143], a[8:11]
    ds_read_b128 a[232:235], v200 offset:22528
    v_fma_f32 v180, v180, s28, s28
    v_mfma_f32_16x16x32_bf16 a[12:15], a[204:207], v[156:159], a[12:15]
    s_waitcnt lgkmcnt(3)
    v_rcp_f32 v180, v180
    v_mfma_f32_16x16x32_bf16 a[12:15], a[200:203], v[152:155], a[12:15]
    buffer_load_dwordx4 v203, s[8:11], s26 offen offset:0 lds
    v_mul_f32 v180, v180, v164
    v_mfma_f32_16x16x32_bf16 a[12:15], a[196:199], v[148:151], a[12:15]
    ds_read_b128 a[236:239], v200 offset:23552
    v_fma_f32 v181, v165, v165, s27
    v_mfma_f32_16x16x32_bf16 a[12:15], a[192:195], v[144:147], a[12:15]
    ds_read_b128 a[192:195], v200 offset:24576
    v_mul_f32 v181, v181, v165
    v_mfma_f32_16x16x32_bf16 v[168:171], a[208:211], v[32:35], v[168:171]
    v_exp_f32 v181, v181
    v_mfma_f32_16x16x32_bf16 v[168:171], a[212:215], v[36:39], v[168:171]
    ds_read_b128 a[196:199], v200 offset:25600
    v_fma_f32 v181, v181, s28, s28
    v_mfma_f32_16x16x32_bf16 v[168:171], a[216:219], v[40:43], v[168:171]
    v_rcp_f32 v181, v181
    v_mfma_f32_16x16x32_bf16 v[168:171], a[220:223], v[44:47], v[168:171]
    buffer_load_dwordx4 v203, s[8:11], s26 offen offset:1024 lds
    v_mul_f32 v181, v181, v165
    v_cvt_pk_bf16_f32 v112, v180, v181
    v_mfma_f32_16x16x32_bf16 v[172:175], a[220:223], v[92:95], v[172:175]
    ds_read_b128 a[200:203], v200 offset:26624
    v_fma_f32 v182, v166, v166, s27
    v_mfma_f32_16x16x32_bf16 v[172:175], a[216:219], v[88:91], v[172:175]
    ds_read_b128 a[204:207], v200 offset:27648
    v_mul_f32 v182, v182, v166
    v_mfma_f32_16x16x32_bf16 v[172:175], a[212:215], v[84:87], v[172:175]
    s_waitcnt lgkmcnt(4)
    v_exp_f32 v182, v182
    v_mfma_f32_16x16x32_bf16 v[172:175], a[208:211], v[80:83], v[172:175]
    ds_read_b128 a[208:211], v200 offset:36864
    v_fma_f32 v182, v182, s28, s28
    v_mfma_f32_16x16x32_bf16 a[16:19], a[224:227], v[128:131], a[16:19]
    s_waitcnt vmcnt(5)
    v_rcp_f32 v182, v182
    v_mfma_f32_16x16x32_bf16 a[16:19], a[228:231], v[132:135], a[16:19]
    buffer_load_dwordx4 v203, s[8:11], s26 offen offset:2048 lds
    v_mul_f32 v182, v182, v166
    v_mfma_f32_16x16x32_bf16 a[16:19], a[232:235], v[136:139], a[16:19]
    ds_read_b128 a[212:215], v200 offset:37888
    v_fma_f32 v183, v167, v167, s27
    v_mfma_f32_16x16x32_bf16 a[16:19], a[236:239], v[140:143], a[16:19]
    ds_read_b128 a[216:219], v200 offset:38912
    v_mul_f32 v183, v183, v167
    v_mfma_f32_16x16x32_bf16 a[20:23], a[236:239], v[156:159], a[20:23]
    s_mov_b32 m0, s33
    v_exp_f32 v183, v183
    v_mfma_f32_16x16x32_bf16 a[20:23], a[232:235], v[152:155], a[20:23]
    ds_read_b128 a[220:223], v200 offset:39936
    v_fma_f32 v183, v183, s28, s28
    v_mfma_f32_16x16x32_bf16 a[20:23], a[228:231], v[148:151], a[20:23]
    s_waitcnt lgkmcnt(4)
    v_rcp_f32 v183, v183
    v_mfma_f32_16x16x32_bf16 a[20:23], a[224:227], v[144:147], a[20:23]
    buffer_load_dwordx4 v212, s[4:7], s34 offen lds
    v_mul_f32 v183, v183, v167
    v_cvt_pk_bf16_f32 v113, v182, v183
    buffer_load_dword a253, v212, s[4:7], s3 offen
    s_add_u32 s33, s33, 1024
    v_mfma_f32_16x16x32_bf16 v[160:163], a[192:195], v[0:3], 0
    ds_read_b128 a[224:227], v200 offset:28672
    v_fma_f32 v176, v168, v168, s27
    v_mfma_f32_16x16x32_bf16 v[160:163], a[196:199], v[4:7], v[160:163]
    ds_read_b128 a[228:231], v200 offset:29696
    v_mul_f32 v176, v176, v168
    v_mfma_f32_16x16x32_bf16 v[160:163], a[200:203], v[8:11], v[160:163]
    s_barrier
    v_exp_f32 v176, v176
    v_mfma_f32_16x16x32_bf16 v[160:163], a[204:207], v[12:15], v[160:163]
    ds_read_b128 a[232:235], v200 offset:30720
    v_fma_f32 v176, v176, s28, s28
    v_mfma_f32_16x16x32_bf16 v[164:167], a[204:207], v[60:63], 0
    s_waitcnt lgkmcnt(3)
    v_rcp_f32 v176, v176
    v_mfma_f32_16x16x32_bf16 v[164:167], a[200:203], v[56:59], v[164:167]
    s_add_u32 m0, s24, 0
    v_mul_f32 v176, v176, v168
    v_mfma_f32_16x16x32_bf16 v[164:167], a[196:199], v[52:55], v[164:167]
    ds_read_b128 a[236:239], v200 offset:31744
    v_fma_f32 v177, v169, v169, s27
    v_mfma_f32_16x16x32_bf16 v[164:167], a[192:195], v[48:51], v[164:167]
    ds_read_b128 a[192:195], v200 offset:40960
    v_mul_f32 v177, v177, v169
    v_mfma_f32_16x16x32_bf16 a[24:27], a[208:211], v[128:131], a[24:27]
    s_add_u32 s25, s25, 24576
    v_exp_f32 v177, v177
    v_mfma_f32_16x16x32_bf16 a[24:27], a[212:215], v[132:135], a[24:27]
    ds_read_b128 a[196:199], v200 offset:41984
    v_fma_f32 v177, v177, s28, s28
    v_mfma_f32_16x16x32_bf16 a[24:27], a[216:219], v[136:139], a[24:27]
    v_rcp_f32 v177, v177
    v_mfma_f32_16x16x32_bf16 a[24:27], a[220:223], v[140:143], a[24:27]
    buffer_load_dwordx4 v203, s[8:11], s25 offen offset:0 lds
    v_mul_f32 v177, v177, v169
    v_cvt_pk_bf16_f32 v98, v176, v177
    v_mfma_f32_16x16x32_bf16 a[28:31], a[220:223], v[156:159], a[28:31]
    ds_read_b128 a[200:203], v200 offset:43008
    v_fma_f32 v178, v170, v170, s27
    v_mfma_f32_16x16x32_bf16 a[28:31], a[216:219], v[152:155], a[28:31]
    ds_read_b128 a[204:207], v200 offset:44032
    v_mul_f32 v178, v178, v170
    v_mfma_f32_16x16x32_bf16 a[28:31], a[212:215], v[148:151], a[28:31]
    s_waitcnt lgkmcnt(4)
    v_exp_f32 v178, v178
    v_mfma_f32_16x16x32_bf16 a[28:31], a[208:211], v[144:147], a[28:31]
    ds_read_b128 a[208:211], v200 offset:32768
    v_fma_f32 v178, v178, s28, s28
    v_mfma_f32_16x16x32_bf16 v[160:163], a[224:227], v[16:19], v[160:163]
    s_add_u32 s26, s26, 24576
    v_rcp_f32 v178, v178
    v_mfma_f32_16x16x32_bf16 v[160:163], a[228:231], v[20:23], v[160:163]
    buffer_load_dwordx4 v203, s[8:11], s25 offen offset:1024 lds
    v_mul_f32 v178, v178, v170
    v_mfma_f32_16x16x32_bf16 v[160:163], a[232:235], v[24:27], v[160:163]
    ds_read_b128 a[212:215], v200 offset:33792
    v_fma_f32 v179, v171, v171, s27
    v_mfma_f32_16x16x32_bf16 v[160:163], a[236:239], v[28:31], v[160:163]
    ds_read_b128 a[216:219], v200 offset:34816
    v_mul_f32 v179, v179, v171
    v_mfma_f32_16x16x32_bf16 v[164:167], a[236:239], v[76:79], v[164:167]
    v_exp_f32 v179, v179
    v_mfma_f32_16x16x32_bf16 v[164:167], a[232:235], v[72:75], v[164:167]
    ds_read_b128 a[220:223], v200 offset:35840
    v_fma_f32 v179, v179, s28, s28
    v_mfma_f32_16x16x32_bf16 v[164:167], a[228:231], v[68:71], v[164:167]
    s_waitcnt lgkmcnt(4)
    v_rcp_f32 v179, v179
    v_mfma_f32_16x16x32_bf16 v[164:167], a[224:227], v[64:67], v[164:167]
    buffer_load_dwordx4 v203, s[8:11], s25 offen offset:2048 lds
    v_mul_f32 v179, v179, v171
    v_cvt_pk_bf16_f32 v99, v178, v179
    v_mfma_f32_16x16x32_bf16 a[32:35], a[192:195], v[128:131], a[32:35]
    ds_read_b128 a[224:227], v200 offset:45056
    v_fma_f32 v180, v172, v172, s27
    v_mfma_f32_16x16x32_bf16 a[32:35], a[196:199], v[132:135], a[32:35]
    ds_read_b128 a[228:231], v200 offset:46080
    v_mul_f32 v180, v180, v172
    v_mfma_f32_16x16x32_bf16 a[32:35], a[200:203], v[136:139], a[32:35]
    s_add_u32 m0, s24, 12288
    v_exp_f32 v180, v180
    v_mfma_f32_16x16x32_bf16 a[32:35], a[204:207], v[140:143], a[32:35]
    ds_read_b128 a[232:235], v200 offset:47104
    v_fma_f32 v180, v180, s28, s28
    v_mfma_f32_16x16x32_bf16 a[36:39], a[204:207], v[156:159], a[36:39]
    s_waitcnt lgkmcnt(3)
    v_rcp_f32 v180, v180
    v_mfma_f32_16x16x32_bf16 a[36:39], a[200:203], v[152:155], a[36:39]
    buffer_load_dwordx4 v203, s[8:11], s26 offen offset:0 lds
    v_mul_f32 v180, v180, v172
    v_mfma_f32_16x16x32_bf16 a[36:39], a[196:199], v[148:151], a[36:39]
    ds_read_b128 a[236:239], v200 offset:48128
    v_fma_f32 v181, v173, v173, s27
    v_mfma_f32_16x16x32_bf16 a[36:39], a[192:195], v[144:147], a[36:39]
    ds_read_b128 a[192:195], v201 offset:0
    v_mul_f32 v181, v181, v173
    v_mfma_f32_16x16x32_bf16 v[160:163], a[208:211], v[32:35], v[160:163]
    v_exp_f32 v181, v181
    v_mfma_f32_16x16x32_bf16 v[160:163], a[212:215], v[36:39], v[160:163]
    ds_read_b128 a[196:199], v201 offset:1024
    v_fma_f32 v181, v181, s28, s28
    v_mfma_f32_16x16x32_bf16 v[160:163], a[216:219], v[40:43], v[160:163]
    v_rcp_f32 v181, v181
    v_mfma_f32_16x16x32_bf16 v[160:163], a[220:223], v[44:47], v[160:163]
    buffer_load_dwordx4 v203, s[8:11], s26 offen offset:1024 lds
    v_mul_f32 v181, v181, v173
    v_cvt_pk_bf16_f32 v114, v180, v181
    v_mfma_f32_16x16x32_bf16 v[164:167], a[220:223], v[92:95], v[164:167]
    ds_read_b128 a[200:203], v201 offset:2048
    v_fma_f32 v182, v174, v174, s27
    v_mfma_f32_16x16x32_bf16 v[164:167], a[216:219], v[88:91], v[164:167]
    ds_read_b128 a[204:207], v201 offset:3072
    v_mul_f32 v182, v182, v174
    v_mfma_f32_16x16x32_bf16 v[164:167], a[212:215], v[84:87], v[164:167]
    s_waitcnt lgkmcnt(4)
    v_exp_f32 v182, v182
    v_mfma_f32_16x16x32_bf16 v[164:167], a[208:211], v[80:83], v[164:167]
    ds_read_b128 a[208:211], v201 offset:12288
    v_fma_f32 v182, v182, s28, s28
    v_mfma_f32_16x16x32_bf16 a[40:43], a[224:227], v[128:131], a[40:43]
    v_rcp_f32 v182, v182
    v_mfma_f32_16x16x32_bf16 a[40:43], a[228:231], v[132:135], a[40:43]
    buffer_load_dwordx4 v203, s[8:11], s26 offen offset:2048 lds
    v_mul_f32 v182, v182, v174
    v_mfma_f32_16x16x32_bf16 a[40:43], a[232:235], v[136:139], a[40:43]
    ds_read_b128 a[212:215], v201 offset:13312
    v_fma_f32 v183, v175, v175, s27
    v_mfma_f32_16x16x32_bf16 a[40:43], a[236:239], v[140:143], a[40:43]
    ds_read_b128 a[216:219], v201 offset:14336
    v_mul_f32 v183, v183, v175
    v_mfma_f32_16x16x32_bf16 a[44:47], a[236:239], v[156:159], a[44:47]
    s_waitcnt vmcnt(8)
    v_exp_f32 v183, v183
    v_mfma_f32_16x16x32_bf16 a[44:47], a[232:235], v[152:155], a[44:47]
    ds_read_b128 a[220:223], v201 offset:15360
    v_fma_f32 v183, v183, s28, s28
    v_mfma_f32_16x16x32_bf16 a[44:47], a[228:231], v[148:151], a[44:47]
    s_waitcnt lgkmcnt(4)
    v_rcp_f32 v183, v183
    v_mfma_f32_16x16x32_bf16 a[44:47], a[224:227], v[144:147], a[44:47]
    s_nop 0
    v_mul_f32 v183, v183, v175
    v_cvt_pk_bf16_f32 v115, v182, v183
    v_mfma_f32_16x16x32_bf16 v[168:171], a[192:195], v[0:3], 0
    ds_read_b128 a[224:227], v201 offset:4096
    v_fma_f32 v176, v160, v160, s27
    v_mfma_f32_16x16x32_bf16 v[168:171], a[196:199], v[4:7], v[168:171]
    ds_read_b128 a[228:231], v201 offset:5120
    v_mul_f32 v176, v176, v160
    v_mfma_f32_16x16x32_bf16 v[168:171], a[200:203], v[8:11], v[168:171]
    s_barrier
    v_exp_f32 v176, v176
    v_mfma_f32_16x16x32_bf16 v[168:171], a[204:207], v[12:15], v[168:171]
    ds_read_b128 a[232:235], v201 offset:6144
    v_fma_f32 v176, v176, s28, s28
    v_mfma_f32_16x16x32_bf16 v[172:175], a[204:207], v[60:63], 0
    s_waitcnt lgkmcnt(3)
    v_rcp_f32 v176, v176
    v_mfma_f32_16x16x32_bf16 v[172:175], a[200:203], v[56:59], v[172:175]
    s_add_u32 m0, s24, 24576
    v_mul_f32 v176, v176, v160
    v_mfma_f32_16x16x32_bf16 v[172:175], a[196:199], v[52:55], v[172:175]
    ds_read_b128 a[236:239], v201 offset:7168
    v_fma_f32 v177, v161, v161, s27
    v_mfma_f32_16x16x32_bf16 v[172:175], a[192:195], v[48:51], v[172:175]
    ds_read_b128 a[192:195], v201 offset:16384
    v_mul_f32 v177, v177, v161
    v_mfma_f32_16x16x32_bf16 a[48:51], a[208:211], v[128:131], a[48:51]
    s_add_u32 s25, s25, 24576
    v_exp_f32 v177, v177
    v_mfma_f32_16x16x32_bf16 a[48:51], a[212:215], v[132:135], a[48:51]
    ds_read_b128 a[196:199], v201 offset:17408
    v_fma_f32 v177, v177, s28, s28
    v_mfma_f32_16x16x32_bf16 a[48:51], a[216:219], v[136:139], a[48:51]
    v_rcp_f32 v177, v177
    v_mfma_f32_16x16x32_bf16 a[48:51], a[220:223], v[140:143], a[48:51]
    buffer_load_dwordx4 v203, s[8:11], s25 offen offset:0 lds
    v_mul_f32 v177, v177, v161
    v_cvt_pk_bf16_f32 v100, v176, v177
    v_mfma_f32_16x16x32_bf16 a[52:55], a[220:223], v[156:159], a[52:55]
    ds_read_b128 a[200:203], v201 offset:18432
    v_fma_f32 v178, v162, v162, s27
    v_mfma_f32_16x16x32_bf16 a[52:55], a[216:219], v[152:155], a[52:55]
    ds_read_b128 a[204:207], v201 offset:19456
    v_mul_f32 v178, v178, v162
    v_mfma_f32_16x16x32_bf16 a[52:55], a[212:215], v[148:151], a[52:55]
    s_waitcnt lgkmcnt(4)
    v_exp_f32 v178, v178
    v_mfma_f32_16x16x32_bf16 a[52:55], a[208:211], v[144:147], a[52:55]
    ds_read_b128 a[208:211], v201 offset:8192
    v_fma_f32 v178, v178, s28, s28
    v_mfma_f32_16x16x32_bf16 v[168:171], a[224:227], v[16:19], v[168:171]
    s_add_u32 s26, s26, 24576
    v_rcp_f32 v178, v178
    v_mfma_f32_16x16x32_bf16 v[168:171], a[228:231], v[20:23], v[168:171]
    buffer_load_dwordx4 v203, s[8:11], s25 offen offset:1024 lds
    v_mul_f32 v178, v178, v162
    v_mfma_f32_16x16x32_bf16 v[168:171], a[232:235], v[24:27], v[168:171]
    ds_read_b128 a[212:215], v201 offset:9216
    v_fma_f32 v179, v163, v163, s27
    v_mfma_f32_16x16x32_bf16 v[168:171], a[236:239], v[28:31], v[168:171]
    ds_read_b128 a[216:219], v201 offset:10240
    v_mul_f32 v179, v179, v163
    v_mfma_f32_16x16x32_bf16 v[172:175], a[236:239], v[76:79], v[172:175]
    v_exp_f32 v179, v179
    v_mfma_f32_16x16x32_bf16 v[172:175], a[232:235], v[72:75], v[172:175]
    ds_read_b128 a[220:223], v201 offset:11264
    v_fma_f32 v179, v179, s28, s28
    v_mfma_f32_16x16x32_bf16 v[172:175], a[228:231], v[68:71], v[172:175]
    s_waitcnt lgkmcnt(4)
    v_rcp_f32 v179, v179
    v_mfma_f32_16x16x32_bf16 v[172:175], a[224:227], v[64:67], v[172:175]
    buffer_load_dwordx4 v203, s[8:11], s25 offen offset:2048 lds
    v_mul_f32 v179, v179, v163
    v_cvt_pk_bf16_f32 v101, v178, v179
    v_mfma_f32_16x16x32_bf16 a[56:59], a[192:195], v[128:131], a[56:59]
    ds_read_b128 a[224:227], v201 offset:20480
    v_fma_f32 v180, v164, v164, s27
    v_mfma_f32_16x16x32_bf16 a[56:59], a[196:199], v[132:135], a[56:59]
    ds_read_b128 a[228:231], v201 offset:21504
    v_mul_f32 v180, v180, v164
    v_mfma_f32_16x16x32_bf16 a[56:59], a[200:203], v[136:139], a[56:59]
    s_add_u32 m0, s24, 36864
    v_exp_f32 v180, v180
    v_mfma_f32_16x16x32_bf16 a[56:59], a[204:207], v[140:143], a[56:59]
    ds_read_b128 a[232:235], v201 offset:22528
    v_fma_f32 v180, v180, s28, s28
    v_mfma_f32_16x16x32_bf16 a[60:63], a[204:207], v[156:159], a[60:63]
    s_waitcnt lgkmcnt(3)
    v_rcp_f32 v180, v180
    v_mfma_f32_16x16x32_bf16 a[60:63], a[200:203], v[152:155], a[60:63]
    buffer_load_dwordx4 v203, s[8:11], s26 offen offset:0 lds
    v_mul_f32 v180, v180, v164
    v_mfma_f32_16x16x32_bf16 a[60:63], a[196:199], v[148:151], a[60:63]
    ds_read_b128 a[236:239], v201 offset:23552
    v_fma_f32 v181, v165, v165, s27
    v_mfma_f32_16x16x32_bf16 a[60:63], a[192:195], v[144:147], a[60:63]
    ds_read_b128 a[192:195], v201 offset:24576
    v_mul_f32 v181, v181, v165
    v_mfma_f32_16x16x32_bf16 v[168:171], a[208:211], v[32:35], v[168:171]
    v_exp_f32 v181, v181
    v_mfma_f32_16x16x32_bf16 v[168:171], a[212:215], v[36:39], v[168:171]
    ds_read_b128 a[196:199], v201 offset:25600
    v_fma_f32 v181, v181, s28, s28
    v_mfma_f32_16x16x32_bf16 v[168:171], a[216:219], v[40:43], v[168:171]
    v_rcp_f32 v181, v181
    v_mfma_f32_16x16x32_bf16 v[168:171], a[220:223], v[44:47], v[168:171]
    buffer_load_dwordx4 v203, s[8:11], s26 offen offset:1024 lds
    v_mul_f32 v181, v181, v165
    v_cvt_pk_bf16_f32 v116, v180, v181
    v_mfma_f32_16x16x32_bf16 v[172:175], a[220:223], v[92:95], v[172:175]
    ds_read_b128 a[200:203], v201 offset:26624
    v_fma_f32 v182, v166, v166, s27
    v_mfma_f32_16x16x32_bf16 v[172:175], a[216:219], v[88:91], v[172:175]
    ds_read_b128 a[204:207], v201 offset:27648
    v_mul_f32 v182, v182, v166
    v_mfma_f32_16x16x32_bf16 v[172:175], a[212:215], v[84:87], v[172:175]
    s_waitcnt lgkmcnt(4)
    v_exp_f32 v182, v182
    v_mfma_f32_16x16x32_bf16 v[172:175], a[208:211], v[80:83], v[172:175]
    ds_read_b128 a[208:211], v201 offset:36864
    v_fma_f32 v182, v182, s28, s28
    v_mfma_f32_16x16x32_bf16 a[64:67], a[224:227], v[128:131], a[64:67]
    v_rcp_f32 v182, v182
    v_mfma_f32_16x16x32_bf16 a[64:67], a[228:231], v[132:135], a[64:67]
    buffer_load_dwordx4 v203, s[8:11], s26 offen offset:2048 lds
    v_mul_f32 v182, v182, v166
    v_mfma_f32_16x16x32_bf16 a[64:67], a[232:235], v[136:139], a[64:67]
    ds_read_b128 a[212:215], v201 offset:37888
    v_fma_f32 v183, v167, v167, s27
    v_mfma_f32_16x16x32_bf16 a[64:67], a[236:239], v[140:143], a[64:67]
    ds_read_b128 a[216:219], v201 offset:38912
    v_mul_f32 v183, v183, v167
    v_mfma_f32_16x16x32_bf16 a[68:71], a[236:239], v[156:159], a[68:71]
    s_waitcnt vmcnt(6)
    v_exp_f32 v183, v183
    v_mfma_f32_16x16x32_bf16 a[68:71], a[232:235], v[152:155], a[68:71]
    ds_read_b128 a[220:223], v201 offset:39936
    v_fma_f32 v183, v183, s28, s28
    v_mfma_f32_16x16x32_bf16 a[68:71], a[228:231], v[148:151], a[68:71]
    s_waitcnt lgkmcnt(4)
    v_rcp_f32 v183, v183
    v_mfma_f32_16x16x32_bf16 a[68:71], a[224:227], v[144:147], a[68:71]
    s_nop 0
    v_mul_f32 v183, v183, v167
    v_cvt_pk_bf16_f32 v117, v182, v183
    v_mfma_f32_16x16x32_bf16 v[160:163], a[192:195], v[0:3], 0
    ds_read_b128 a[224:227], v201 offset:28672
    v_fma_f32 v176, v168, v168, s27
    v_mfma_f32_16x16x32_bf16 v[160:163], a[196:199], v[4:7], v[160:163]
    ds_read_b128 a[228:231], v201 offset:29696
    v_mul_f32 v176, v176, v168
    v_mfma_f32_16x16x32_bf16 v[160:163], a[200:203], v[8:11], v[160:163]
    s_barrier
    v_exp_f32 v176, v176
    v_mfma_f32_16x16x32_bf16 v[160:163], a[204:207], v[12:15], v[160:163]
    ds_read_b128 a[232:235], v201 offset:30720
    v_fma_f32 v176, v176, s28, s28
    v_mfma_f32_16x16x32_bf16 v[164:167], a[204:207], v[60:63], 0
    s_waitcnt lgkmcnt(3)
    v_rcp_f32 v176, v176
    v_mfma_f32_16x16x32_bf16 v[164:167], a[200:203], v[56:59], v[164:167]
    s_add_u32 m0, s24, 49152
    v_mul_f32 v176, v176, v168
    v_mfma_f32_16x16x32_bf16 v[164:167], a[196:199], v[52:55], v[164:167]
    ds_read_b128 a[236:239], v201 offset:31744
    v_fma_f32 v177, v169, v169, s27
    v_mfma_f32_16x16x32_bf16 v[164:167], a[192:195], v[48:51], v[164:167]
    ds_read_b128 a[192:195], v201 offset:40960
    v_mul_f32 v177, v177, v169
    v_mfma_f32_16x16x32_bf16 a[72:75], a[208:211], v[128:131], a[72:75]
    s_add_u32 s25, s25, 24576
    v_exp_f32 v177, v177
    v_mfma_f32_16x16x32_bf16 a[72:75], a[212:215], v[132:135], a[72:75]
    ds_read_b128 a[196:199], v201 offset:41984
    v_fma_f32 v177, v177, s28, s28
    v_mfma_f32_16x16x32_bf16 a[72:75], a[216:219], v[136:139], a[72:75]
    v_rcp_f32 v177, v177
    v_mfma_f32_16x16x32_bf16 a[72:75], a[220:223], v[140:143], a[72:75]
    buffer_load_dwordx4 v203, s[8:11], s25 offen offset:0 lds
    v_mul_f32 v177, v177, v169
    v_cvt_pk_bf16_f32 v102, v176, v177
    v_mfma_f32_16x16x32_bf16 a[76:79], a[220:223], v[156:159], a[76:79]
    ds_read_b128 a[200:203], v201 offset:43008
    v_fma_f32 v178, v170, v170, s27
    v_mfma_f32_16x16x32_bf16 a[76:79], a[216:219], v[152:155], a[76:79]
    ds_read_b128 a[204:207], v201 offset:44032
    v_mul_f32 v178, v178, v170
    v_mfma_f32_16x16x32_bf16 a[76:79], a[212:215], v[148:151], a[76:79]
    s_waitcnt lgkmcnt(4)
    v_exp_f32 v178, v178
    v_mfma_f32_16x16x32_bf16 a[76:79], a[208:211], v[144:147], a[76:79]
    ds_read_b128 a[208:211], v201 offset:32768
    v_fma_f32 v178, v178, s28, s28
    v_mfma_f32_16x16x32_bf16 v[160:163], a[224:227], v[16:19], v[160:163]
    s_add_u32 s26, s26, 24576
    v_rcp_f32 v178, v178
    v_mfma_f32_16x16x32_bf16 v[160:163], a[228:231], v[20:23], v[160:163]
    buffer_load_dwordx4 v203, s[8:11], s25 offen offset:1024 lds
    v_mul_f32 v178, v178, v170
    v_mfma_f32_16x16x32_bf16 v[160:163], a[232:235], v[24:27], v[160:163]
    ds_read_b128 a[212:215], v201 offset:33792
    v_fma_f32 v179, v171, v171, s27
    v_mfma_f32_16x16x32_bf16 v[160:163], a[236:239], v[28:31], v[160:163]
    ds_read_b128 a[216:219], v201 offset:34816
    v_mul_f32 v179, v179, v171
    v_mfma_f32_16x16x32_bf16 v[164:167], a[236:239], v[76:79], v[164:167]
    v_exp_f32 v179, v179
    v_mfma_f32_16x16x32_bf16 v[164:167], a[232:235], v[72:75], v[164:167]
    ds_read_b128 a[220:223], v201 offset:35840
    v_fma_f32 v179, v179, s28, s28
    v_mfma_f32_16x16x32_bf16 v[164:167], a[228:231], v[68:71], v[164:167]
    s_waitcnt lgkmcnt(4)
    v_rcp_f32 v179, v179
    v_mfma_f32_16x16x32_bf16 v[164:167], a[224:227], v[64:67], v[164:167]
    buffer_load_dwordx4 v203, s[8:11], s25 offen offset:2048 lds
    v_mul_f32 v179, v179, v171
    v_cvt_pk_bf16_f32 v103, v178, v179
    v_mfma_f32_16x16x32_bf16 a[80:83], a[192:195], v[128:131], a[80:83]
    ds_read_b128 a[224:227], v201 offset:45056
    v_fma_f32 v180, v172, v172, s27
    v_mfma_f32_16x16x32_bf16 a[80:83], a[196:199], v[132:135], a[80:83]
    ds_read_b128 a[228:231], v201 offset:46080
    v_mul_f32 v180, v180, v172
    v_mfma_f32_16x16x32_bf16 a[80:83], a[200:203], v[136:139], a[80:83]
    s_add_u32 m0, s24, 61440
    v_exp_f32 v180, v180
    v_mfma_f32_16x16x32_bf16 a[80:83], a[204:207], v[140:143], a[80:83]
    ds_read_b128 a[232:235], v201 offset:47104
    v_fma_f32 v180, v180, s28, s28
    v_mfma_f32_16x16x32_bf16 a[84:87], a[204:207], v[156:159], a[84:87]
    s_waitcnt lgkmcnt(3)
    v_rcp_f32 v180, v180
    v_mfma_f32_16x16x32_bf16 a[84:87], a[200:203], v[152:155], a[84:87]
    buffer_load_dwordx4 v203, s[8:11], s26 offen offset:0 lds
    v_mul_f32 v180, v180, v172
    v_mfma_f32_16x16x32_bf16 a[84:87], a[196:199], v[148:151], a[84:87]
    ds_read_b128 a[236:239], v201 offset:48128
    v_fma_f32 v181, v173, v173, s27
    v_mfma_f32_16x16x32_bf16 a[84:87], a[192:195], v[144:147], a[84:87]
    ds_read_b128 a[192:195], v200 offset:0
    v_mul_f32 v181, v181, v173
    v_mfma_f32_16x16x32_bf16 v[160:163], a[208:211], v[32:35], v[160:163]
    v_exp_f32 v181, v181
    v_mfma_f32_16x16x32_bf16 v[160:163], a[212:215], v[36:39], v[160:163]
    ds_read_b128 a[196:199], v200 offset:1024
    v_fma_f32 v181, v181, s28, s28
    v_mfma_f32_16x16x32_bf16 v[160:163], a[216:219], v[40:43], v[160:163]
    v_rcp_f32 v181, v181
    v_mfma_f32_16x16x32_bf16 v[160:163], a[220:223], v[44:47], v[160:163]
    buffer_load_dwordx4 v203, s[8:11], s26 offen offset:1024 lds
    v_mul_f32 v181, v181, v173
    v_cvt_pk_bf16_f32 v118, v180, v181
    v_mfma_f32_16x16x32_bf16 v[164:167], a[220:223], v[92:95], v[164:167]
    ds_read_b128 a[200:203], v200 offset:2048
    v_fma_f32 v182, v174, v174, s27
    v_mfma_f32_16x16x32_bf16 v[164:167], a[216:219], v[88:91], v[164:167]
    ds_read_b128 a[204:207], v200 offset:3072
    v_mul_f32 v182, v182, v174
    v_mfma_f32_16x16x32_bf16 v[164:167], a[212:215], v[84:87], v[164:167]
    s_waitcnt lgkmcnt(4)
    v_exp_f32 v182, v182
    v_mfma_f32_16x16x32_bf16 v[164:167], a[208:211], v[80:83], v[164:167]
    ds_read_b128 a[208:211], v200 offset:12288
    v_fma_f32 v182, v182, s28, s28
    v_mfma_f32_16x16x32_bf16 a[88:91], a[224:227], v[128:131], a[88:91]
    v_rcp_f32 v182, v182
    v_mfma_f32_16x16x32_bf16 a[88:91], a[228:231], v[132:135], a[88:91]
    buffer_load_dwordx4 v203, s[8:11], s26 offen offset:2048 lds
    v_mul_f32 v182, v182, v174
    v_mfma_f32_16x16x32_bf16 a[88:91], a[232:235], v[136:139], a[88:91]
    ds_read_b128 a[212:215], v200 offset:13312
    v_fma_f32 v183, v175, v175, s27
    v_mfma_f32_16x16x32_bf16 a[88:91], a[236:239], v[140:143], a[88:91]
    ds_read_b128 a[216:219], v200 offset:14336
    v_mul_f32 v183, v183, v175
    v_mfma_f32_16x16x32_bf16 a[92:95], a[236:239], v[156:159], a[92:95]
    s_waitcnt vmcnt(6)
    v_exp_f32 v183, v183
    v_mfma_f32_16x16x32_bf16 a[92:95], a[232:235], v[152:155], a[92:95]
    ds_read_b128 a[220:223], v200 offset:15360
    v_fma_f32 v183, v183, s28, s28
    v_mfma_f32_16x16x32_bf16 a[92:95], a[228:231], v[148:151], a[92:95]
    s_waitcnt lgkmcnt(4)
    v_rcp_f32 v183, v183
    v_mfma_f32_16x16x32_bf16 a[92:95], a[224:227], v[144:147], a[92:95]
    s_nop 0
    v_mul_f32 v183, v183, v175
    v_cvt_pk_bf16_f32 v119, v182, v183
    v_mfma_f32_16x16x32_bf16 v[168:171], a[192:195], v[0:3], 0
    ds_read_b128 a[224:227], v200 offset:4096
    v_fma_f32 v176, v160, v160, s27
    v_mfma_f32_16x16x32_bf16 v[168:171], a[196:199], v[4:7], v[168:171]
    ds_read_b128 a[228:231], v200 offset:5120
    v_mul_f32 v176, v176, v160
    v_mfma_f32_16x16x32_bf16 v[168:171], a[200:203], v[8:11], v[168:171]
    s_barrier
    v_exp_f32 v176, v176
    v_mfma_f32_16x16x32_bf16 v[168:171], a[204:207], v[12:15], v[168:171]
    ds_read_b128 a[232:235], v200 offset:6144
    v_fma_f32 v176, v176, s28, s28
    v_mfma_f32_16x16x32_bf16 v[172:175], a[204:207], v[60:63], 0
    s_waitcnt lgkmcnt(3)
    v_rcp_f32 v176, v176
    v_mfma_f32_16x16x32_bf16 v[172:175], a[200:203], v[56:59], v[172:175]
    s_add_u32 m0, s24, 73728
    v_mul_f32 v176, v176, v160
    v_mfma_f32_16x16x32_bf16 v[172:175], a[196:199], v[52:55], v[172:175]
    ds_read_b128 a[236:239], v200 offset:7168
    v_fma_f32 v177, v161, v161, s27
    v_mfma_f32_16x16x32_bf16 v[172:175], a[192:195], v[48:51], v[172:175]
    ds_read_b128 a[192:195], v200 offset:16384
    v_mul_f32 v177, v177, v161
    v_mfma_f32_16x16x32_bf16 a[96:99], a[208:211], v[128:131], a[96:99]
    s_add_u32 s25, s25, 24576
    v_exp_f32 v177, v177
    v_mfma_f32_16x16x32_bf16 a[96:99], a[212:215], v[132:135], a[96:99]
    ds_read_b128 a[196:199], v200 offset:17408
    v_fma_f32 v177, v177, s28, s28
    v_mfma_f32_16x16x32_bf16 a[96:99], a[216:219], v[136:139], a[96:99]
    v_rcp_f32 v177, v177
    v_mfma_f32_16x16x32_bf16 a[96:99], a[220:223], v[140:143], a[96:99]
    buffer_load_dwordx4 v203, s[8:11], s25 offen offset:0 lds
    v_mul_f32 v177, v177, v161
    v_cvt_pk_bf16_f32 v104, v176, v177
    v_mfma_f32_16x16x32_bf16 a[100:103], a[220:223], v[156:159], a[100:103]
    ds_read_b128 a[200:203], v200 offset:18432
    v_fma_f32 v178, v162, v162, s27
    v_mfma_f32_16x16x32_bf16 a[100:103], a[216:219], v[152:155], a[100:103]
    ds_read_b128 a[204:207], v200 offset:19456
    v_mul_f32 v178, v178, v162
    v_mfma_f32_16x16x32_bf16 a[100:103], a[212:215], v[148:151], a[100:103]
    s_waitcnt lgkmcnt(4)
    v_exp_f32 v178, v178
    v_mfma_f32_16x16x32_bf16 a[100:103], a[208:211], v[144:147], a[100:103]
    ds_read_b128 a[208:211], v200 offset:8192
    v_fma_f32 v178, v178, s28, s28
    v_mfma_f32_16x16x32_bf16 v[168:171], a[224:227], v[16:19], v[168:171]
    s_add_u32 s26, s26, 24576
    v_rcp_f32 v178, v178
    v_mfma_f32_16x16x32_bf16 v[168:171], a[228:231], v[20:23], v[168:171]
    buffer_load_dwordx4 v203, s[8:11], s25 offen offset:1024 lds
    v_mul_f32 v178, v178, v162
    v_mfma_f32_16x16x32_bf16 v[168:171], a[232:235], v[24:27], v[168:171]
    ds_read_b128 a[212:215], v200 offset:9216
    v_fma_f32 v179, v163, v163, s27
    v_mfma_f32_16x16x32_bf16 v[168:171], a[236:239], v[28:31], v[168:171]
    ds_read_b128 a[216:219], v200 offset:10240
    v_mul_f32 v179, v179, v163
    v_mfma_f32_16x16x32_bf16 v[172:175], a[236:239], v[76:79], v[172:175]
    v_exp_f32 v179, v179
    v_mfma_f32_16x16x32_bf16 v[172:175], a[232:235], v[72:75], v[172:175]
    ds_read_b128 a[220:223], v200 offset:11264
    v_fma_f32 v179, v179, s28, s28
    v_mfma_f32_16x16x32_bf16 v[172:175], a[228:231], v[68:71], v[172:175]
    s_waitcnt lgkmcnt(4)
    v_rcp_f32 v179, v179
    v_mfma_f32_16x16x32_bf16 v[172:175], a[224:227], v[64:67], v[172:175]
    buffer_load_dwordx4 v203, s[8:11], s25 offen offset:2048 lds
    v_mul_f32 v179, v179, v163
    v_cvt_pk_bf16_f32 v105, v178, v179
    v_mfma_f32_16x16x32_bf16 a[104:107], a[192:195], v[128:131], a[104:107]
    ds_read_b128 a[224:227], v200 offset:20480
    v_fma_f32 v180, v164, v164, s27
    v_mfma_f32_16x16x32_bf16 a[104:107], a[196:199], v[132:135], a[104:107]
    ds_read_b128 a[228:231], v200 offset:21504
    v_mul_f32 v180, v180, v164
    v_mfma_f32_16x16x32_bf16 a[104:107], a[200:203], v[136:139], a[104:107]
    s_add_u32 m0, s24, 86016
    v_exp_f32 v180, v180
    v_mfma_f32_16x16x32_bf16 a[104:107], a[204:207], v[140:143], a[104:107]
    ds_read_b128 a[232:235], v200 offset:22528
    v_fma_f32 v180, v180, s28, s28
    v_mfma_f32_16x16x32_bf16 a[108:111], a[204:207], v[156:159], a[108:111]
    s_waitcnt lgkmcnt(3)
    v_rcp_f32 v180, v180
    v_mfma_f32_16x16x32_bf16 a[108:111], a[200:203], v[152:155], a[108:111]
    buffer_load_dwordx4 v203, s[8:11], s26 offen offset:0 lds
    v_mul_f32 v180, v180, v164
    v_mfma_f32_16x16x32_bf16 a[108:111], a[196:199], v[148:151], a[108:111]
    ds_read_b128 a[236:239], v200 offset:23552
    v_fma_f32 v181, v165, v165, s27
    v_mfma_f32_16x16x32_bf16 a[108:111], a[192:195], v[144:147], a[108:111]
    ds_read_b128 a[192:195], v200 offset:24576
    v_mul_f32 v181, v181, v165
    v_mfma_f32_16x16x32_bf16 v[168:171], a[208:211], v[32:35], v[168:171]
    v_exp_f32 v181, v181
    v_mfma_f32_16x16x32_bf16 v[168:171], a[212:215], v[36:39], v[168:171]
    ds_read_b128 a[196:199], v200 offset:25600
    v_fma_f32 v181, v181, s28, s28
    v_mfma_f32_16x16x32_bf16 v[168:171], a[216:219], v[40:43], v[168:171]
    v_rcp_f32 v181, v181
    v_mfma_f32_16x16x32_bf16 v[168:171], a[220:223], v[44:47], v[168:171]
    buffer_load_dwordx4 v203, s[8:11], s26 offen offset:1024 lds
    v_mul_f32 v181, v181, v165
    v_cvt_pk_bf16_f32 v120, v180, v181
    v_mfma_f32_16x16x32_bf16 v[172:175], a[220:223], v[92:95], v[172:175]
    ds_read_b128 a[200:203], v200 offset:26624
    v_fma_f32 v182, v166, v166, s27
    v_mfma_f32_16x16x32_bf16 v[172:175], a[216:219], v[88:91], v[172:175]
    ds_read_b128 a[204:207], v200 offset:27648
    v_mul_f32 v182, v182, v166
    v_mfma_f32_16x16x32_bf16 v[172:175], a[212:215], v[84:87], v[172:175]
    s_waitcnt lgkmcnt(4)
    v_exp_f32 v182, v182
    v_mfma_f32_16x16x32_bf16 v[172:175], a[208:211], v[80:83], v[172:175]
    ds_read_b128 a[208:211], v200 offset:36864
    v_fma_f32 v182, v182, s28, s28
    v_mfma_f32_16x16x32_bf16 a[112:115], a[224:227], v[128:131], a[112:115]
    v_rcp_f32 v182, v182
    v_mfma_f32_16x16x32_bf16 a[112:115], a[228:231], v[132:135], a[112:115]
    buffer_load_dwordx4 v203, s[8:11], s26 offen offset:2048 lds
    v_mul_f32 v182, v182, v166
    v_mfma_f32_16x16x32_bf16 a[112:115], a[232:235], v[136:139], a[112:115]
    ds_read_b128 a[212:215], v200 offset:37888
    v_fma_f32 v183, v167, v167, s27
    v_mfma_f32_16x16x32_bf16 a[112:115], a[236:239], v[140:143], a[112:115]
    ds_read_b128 a[216:219], v200 offset:38912
    v_mul_f32 v183, v183, v167
    v_mfma_f32_16x16x32_bf16 a[116:119], a[236:239], v[156:159], a[116:119]
    s_waitcnt vmcnt(6)
    v_exp_f32 v183, v183
    v_mfma_f32_16x16x32_bf16 a[116:119], a[232:235], v[152:155], a[116:119]
    ds_read_b128 a[220:223], v200 offset:39936
    v_fma_f32 v183, v183, s28, s28
    v_mfma_f32_16x16x32_bf16 a[116:119], a[228:231], v[148:151], a[116:119]
    s_waitcnt lgkmcnt(4)
    v_rcp_f32 v183, v183
    v_mfma_f32_16x16x32_bf16 a[116:119], a[224:227], v[144:147], a[116:119]
    s_nop 0
    v_mul_f32 v183, v183, v167
    v_cvt_pk_bf16_f32 v121, v182, v183
    v_mfma_f32_16x16x32_bf16 v[160:163], a[192:195], v[0:3], 0
    ds_read_b128 a[224:227], v200 offset:28672
    v_fma_f32 v176, v168, v168, s27
    v_mfma_f32_16x16x32_bf16 v[160:163], a[196:199], v[4:7], v[160:163]
    ds_read_b128 a[228:231], v200 offset:29696
    v_mul_f32 v176, v176, v168
    v_mfma_f32_16x16x32_bf16 v[160:163], a[200:203], v[8:11], v[160:163]
    s_barrier
    v_exp_f32 v176, v176
    v_mfma_f32_16x16x32_bf16 v[160:163], a[204:207], v[12:15], v[160:163]
    ds_read_b128 a[232:235], v200 offset:30720
    v_fma_f32 v176, v176, s28, s28
    v_mfma_f32_16x16x32_bf16 v[164:167], a[204:207], v[60:63], 0
    s_waitcnt lgkmcnt(3)
    v_rcp_f32 v176, v176
    v_mfma_f32_16x16x32_bf16 v[164:167], a[200:203], v[56:59], v[164:167]
    s_add_u32 m0, s24, 0
    v_mul_f32 v176, v176, v168
    v_mfma_f32_16x16x32_bf16 v[164:167], a[196:199], v[52:55], v[164:167]
    ds_read_b128 a[236:239], v200 offset:31744
    v_fma_f32 v177, v169, v169, s27
    v_mfma_f32_16x16x32_bf16 v[164:167], a[192:195], v[48:51], v[164:167]
    ds_read_b128 a[192:195], v200 offset:40960
    v_mul_f32 v177, v177, v169
    v_mfma_f32_16x16x32_bf16 a[120:123], a[208:211], v[128:131], a[120:123]
    s_add_u32 s25, s25, 24576
    v_exp_f32 v177, v177
    v_mfma_f32_16x16x32_bf16 a[120:123], a[212:215], v[132:135], a[120:123]
    ds_read_b128 a[196:199], v200 offset:41984
    v_fma_f32 v177, v177, s28, s28
    v_mfma_f32_16x16x32_bf16 a[120:123], a[216:219], v[136:139], a[120:123]
    v_rcp_f32 v177, v177
    v_mfma_f32_16x16x32_bf16 a[120:123], a[220:223], v[140:143], a[120:123]
    buffer_load_dwordx4 v203, s[8:11], s25 offen offset:0 lds
    v_mul_f32 v177, v177, v169
    v_cvt_pk_bf16_f32 v106, v176, v177
    v_mfma_f32_16x16x32_bf16 a[124:127], a[220:223], v[156:159], a[124:127]
    ds_read_b128 a[200:203], v200 offset:43008
    v_fma_f32 v178, v170, v170, s27
    v_mfma_f32_16x16x32_bf16 a[124:127], a[216:219], v[152:155], a[124:127]
    ds_read_b128 a[204:207], v200 offset:44032
    v_mul_f32 v178, v178, v170
    v_mfma_f32_16x16x32_bf16 a[124:127], a[212:215], v[148:151], a[124:127]
    s_waitcnt lgkmcnt(4)
    v_exp_f32 v178, v178
    v_mfma_f32_16x16x32_bf16 a[124:127], a[208:211], v[144:147], a[124:127]
    ds_read_b128 a[208:211], v200 offset:32768
    v_fma_f32 v178, v178, s28, s28
    v_mfma_f32_16x16x32_bf16 v[160:163], a[224:227], v[16:19], v[160:163]
    s_add_u32 s26, s26, 24576
    v_rcp_f32 v178, v178
    v_mfma_f32_16x16x32_bf16 v[160:163], a[228:231], v[20:23], v[160:163]
    buffer_load_dwordx4 v203, s[8:11], s25 offen offset:1024 lds
    v_mul_f32 v178, v178, v170
    v_mfma_f32_16x16x32_bf16 v[160:163], a[232:235], v[24:27], v[160:163]
    ds_read_b128 a[212:215], v200 offset:33792
    v_fma_f32 v179, v171, v171, s27
    v_mfma_f32_16x16x32_bf16 v[160:163], a[236:239], v[28:31], v[160:163]
    ds_read_b128 a[216:219], v200 offset:34816
    v_mul_f32 v179, v179, v171
    v_mfma_f32_16x16x32_bf16 v[164:167], a[236:239], v[76:79], v[164:167]
    v_exp_f32 v179, v179
    v_mfma_f32_16x16x32_bf16 v[164:167], a[232:235], v[72:75], v[164:167]
    ds_read_b128 a[220:223], v200 offset:35840
    v_fma_f32 v179, v179, s28, s28
    v_mfma_f32_16x16x32_bf16 v[164:167], a[228:231], v[68:71], v[164:167]
    s_waitcnt lgkmcnt(4)
    v_rcp_f32 v179, v179
    v_mfma_f32_16x16x32_bf16 v[164:167], a[224:227], v[64:67], v[164:167]
    buffer_load_dwordx4 v203, s[8:11], s25 offen offset:2048 lds
    v_mul_f32 v179, v179, v171
    v_cvt_pk_bf16_f32 v107, v178, v179
    v_mfma_f32_16x16x32_bf16 a[128:131], a[192:195], v[128:131], a[128:131]
    ds_read_b128 a[224:227], v200 offset:45056
    v_fma_f32 v180, v172, v172, s27
    v_mfma_f32_16x16x32_bf16 a[128:131], a[196:199], v[132:135], a[128:131]
    ds_read_b128 a[228:231], v200 offset:46080
    v_mul_f32 v180, v180, v172
    v_mfma_f32_16x16x32_bf16 a[128:131], a[200:203], v[136:139], a[128:131]
    s_add_u32 m0, s24, 12288
    v_exp_f32 v180, v180
    v_mfma_f32_16x16x32_bf16 a[128:131], a[204:207], v[140:143], a[128:131]
    ds_read_b128 a[232:235], v200 offset:47104
    v_fma_f32 v180, v180, s28, s28
    v_mfma_f32_16x16x32_bf16 a[132:135], a[204:207], v[156:159], a[132:135]
    s_waitcnt lgkmcnt(3)
    v_rcp_f32 v180, v180
    v_mfma_f32_16x16x32_bf16 a[132:135], a[200:203], v[152:155], a[132:135]
    buffer_load_dwordx4 v203, s[8:11], s26 offen offset:0 lds
    v_mul_f32 v180, v180, v172
    v_mfma_f32_16x16x32_bf16 a[132:135], a[196:199], v[148:151], a[132:135]
    ds_read_b128 a[236:239], v200 offset:48128
    v_fma_f32 v181, v173, v173, s27
    v_mfma_f32_16x16x32_bf16 a[132:135], a[192:195], v[144:147], a[132:135]
    ds_read_b128 a[192:195], v201 offset:0
    v_mul_f32 v181, v181, v173
    v_mfma_f32_16x16x32_bf16 v[160:163], a[208:211], v[32:35], v[160:163]
    v_exp_f32 v181, v181
    v_mfma_f32_16x16x32_bf16 v[160:163], a[212:215], v[36:39], v[160:163]
    ds_read_b128 a[196:199], v201 offset:1024
    v_fma_f32 v181, v181, s28, s28
    v_mfma_f32_16x16x32_bf16 v[160:163], a[216:219], v[40:43], v[160:163]
    v_rcp_f32 v181, v181
    v_mfma_f32_16x16x32_bf16 v[160:163], a[220:223], v[44:47], v[160:163]
    buffer_load_dwordx4 v203, s[8:11], s26 offen offset:1024 lds
    v_mul_f32 v181, v181, v173
    v_cvt_pk_bf16_f32 v122, v180, v181
    v_mfma_f32_16x16x32_bf16 v[164:167], a[220:223], v[92:95], v[164:167]
    ds_read_b128 a[200:203], v201 offset:2048
    v_fma_f32 v182, v174, v174, s27
    v_mfma_f32_16x16x32_bf16 v[164:167], a[216:219], v[88:91], v[164:167]
    ds_read_b128 a[204:207], v201 offset:3072
    v_mul_f32 v182, v182, v174
    v_mfma_f32_16x16x32_bf16 v[164:167], a[212:215], v[84:87], v[164:167]
    s_waitcnt lgkmcnt(4)
    v_exp_f32 v182, v182
    v_mfma_f32_16x16x32_bf16 v[164:167], a[208:211], v[80:83], v[164:167]
    ds_read_b128 a[208:211], v201 offset:12288
    v_fma_f32 v182, v182, s28, s28
    v_mfma_f32_16x16x32_bf16 a[136:139], a[224:227], v[128:131], a[136:139]
    s_waitcnt vmcnt(5)
    v_rcp_f32 v182, v182
    v_mfma_f32_16x16x32_bf16 a[136:139], a[228:231], v[132:135], a[136:139]
    buffer_load_dwordx4 v203, s[8:11], s26 offen offset:2048 lds
    v_mul_f32 v182, v182, v174
    v_mfma_f32_16x16x32_bf16 a[136:139], a[232:235], v[136:139], a[136:139]
    ds_read_b128 a[212:215], v201 offset:13312
    v_fma_f32 v183, v175, v175, s27
    v_mfma_f32_16x16x32_bf16 a[136:139], a[236:239], v[140:143], a[136:139]
    ds_read_b128 a[216:219], v201 offset:14336
    v_mul_f32 v183, v183, v175
    v_mfma_f32_16x16x32_bf16 a[140:143], a[236:239], v[156:159], a[140:143]
    s_mov_b32 m0, s33
    v_exp_f32 v183, v183
    v_mfma_f32_16x16x32_bf16 a[140:143], a[232:235], v[152:155], a[140:143]
    ds_read_b128 a[220:223], v201 offset:15360
    v_fma_f32 v183, v183, s28, s28
    v_mfma_f32_16x16x32_bf16 a[140:143], a[228:231], v[148:151], a[140:143]
    s_waitcnt lgkmcnt(4)
    v_rcp_f32 v183, v183
    v_mfma_f32_16x16x32_bf16 a[140:143], a[224:227], v[144:147], a[140:143]
    buffer_load_dwordx4 v213, s[4:7], s34 offen lds
    v_mul_f32 v183, v183, v175
    v_cvt_pk_bf16_f32 v123, v182, v183
    buffer_load_dword a253, v213, s[4:7], s3 offen
    s_add_u32 s33, s33, 1024
    v_mfma_f32_16x16x32_bf16 v[168:171], a[192:195], v[0:3], 0
    ds_read_b128 a[224:227], v201 offset:4096
    v_fma_f32 v176, v160, v160, s27
    v_mfma_f32_16x16x32_bf16 v[168:171], a[196:199], v[4:7], v[168:171]
    ds_read_b128 a[228:231], v201 offset:5120
    v_mul_f32 v176, v176, v160
    v_mfma_f32_16x16x32_bf16 v[168:171], a[200:203], v[8:11], v[168:171]
    s_barrier
    v_exp_f32 v176, v176
    v_mfma_f32_16x16x32_bf16 v[168:171], a[204:207], v[12:15], v[168:171]
    ds_read_b128 a[232:235], v201 offset:6144
    v_fma_f32 v176, v176, s28, s28
    v_mfma_f32_16x16x32_bf16 v[172:175], a[204:207], v[60:63], 0
    s_waitcnt lgkmcnt(3)
    v_rcp_f32 v176, v176
    v_mfma_f32_16x16x32_bf16 v[172:175], a[200:203], v[56:59], v[172:175]
    s_add_u32 m0, s24, 24576
    v_mul_f32 v176, v176, v160
    v_mfma_f32_16x16x32_bf16 v[172:175], a[196:199], v[52:55], v[172:175]
    ds_read_b128 a[236:239], v201 offset:7168
    v_fma_f32 v177, v161, v161, s27
    v_mfma_f32_16x16x32_bf16 v[172:175], a[192:195], v[48:51], v[172:175]
    ds_read_b128 a[192:195], v201 offset:16384
    v_mul_f32 v177, v177, v161
    v_mfma_f32_16x16x32_bf16 a[144:147], a[208:211], v[128:131], a[144:147]
    s_add_u32 s25, s25, 24576
    v_exp_f32 v177, v177
    v_mfma_f32_16x16x32_bf16 a[144:147], a[212:215], v[132:135], a[144:147]
    ds_read_b128 a[196:199], v201 offset:17408
    v_fma_f32 v177, v177, s28, s28
    v_mfma_f32_16x16x32_bf16 a[144:147], a[216:219], v[136:139], a[144:147]
    v_rcp_f32 v177, v177
    v_mfma_f32_16x16x32_bf16 a[144:147], a[220:223], v[140:143], a[144:147]
    buffer_load_dwordx4 v203, s[8:11], s25 offen offset:0 lds
    v_mul_f32 v177, v177, v161
    v_cvt_pk_bf16_f32 v108, v176, v177
    v_mfma_f32_16x16x32_bf16 a[148:151], a[220:223], v[156:159], a[148:151]
    ds_read_b128 a[200:203], v201 offset:18432
    v_fma_f32 v178, v162, v162, s27
    v_mfma_f32_16x16x32_bf16 a[148:151], a[216:219], v[152:155], a[148:151]
    ds_read_b128 a[204:207], v201 offset:19456
    v_mul_f32 v178, v178, v162
    v_mfma_f32_16x16x32_bf16 a[148:151], a[212:215], v[148:151], a[148:151]
    s_waitcnt lgkmcnt(4)
    v_exp_f32 v178, v178
    v_mfma_f32_16x16x32_bf16 a[148:151], a[208:211], v[144:147], a[148:151]
    ds_read_b128 a[208:211], v201 offset:8192
    v_fma_f32 v178, v178, s28, s28
    v_mfma_f32_16x16x32_bf16 v[168:171], a[224:227], v[16:19], v[168:171]
    s_add_u32 s26, s26, 24576
    v_rcp_f32 v178, v178
    v_mfma_f32_16x16x32_bf16 v[168:171], a[228:231], v[20:23], v[168:171]
    buffer_load_dwordx4 v203, s[8:11], s25 offen offset:1024 lds
    v_mul_f32 v178, v178, v162
    v_mfma_f32_16x16x32_bf16 v[168:171], a[232:235], v[24:27], v[168:171]
    ds_read_b128 a[212:215], v201 offset:9216
    v_fma_f32 v179, v163, v163, s27
    v_mfma_f32_16x16x32_bf16 v[168:171], a[236:239], v[28:31], v[168:171]
    ds_read_b128 a[216:219], v201 offset:10240
    v_mul_f32 v179, v179, v163
    v_mfma_f32_16x16x32_bf16 v[172:175], a[236:239], v[76:79], v[172:175]
    v_exp_f32 v179, v179
    v_mfma_f32_16x16x32_bf16 v[172:175], a[232:235], v[72:75], v[172:175]
    ds_read_b128 a[220:223], v201 offset:11264
    v_fma_f32 v179, v179, s28, s28
    v_mfma_f32_16x16x32_bf16 v[172:175], a[228:231], v[68:71], v[172:175]
    s_waitcnt lgkmcnt(4)
    v_rcp_f32 v179, v179
    v_mfma_f32_16x16x32_bf16 v[172:175], a[224:227], v[64:67], v[172:175]
    buffer_load_dwordx4 v203, s[8:11], s25 offen offset:2048 lds
    v_mul_f32 v179, v179, v163
    v_cvt_pk_bf16_f32 v109, v178, v179
    v_mfma_f32_16x16x32_bf16 a[152:155], a[192:195], v[128:131], a[152:155]
    ds_read_b128 a[224:227], v201 offset:20480
    v_fma_f32 v180, v164, v164, s27
    v_mfma_f32_16x16x32_bf16 a[152:155], a[196:199], v[132:135], a[152:155]
    ds_read_b128 a[228:231], v201 offset:21504
    v_mul_f32 v180, v180, v164
    v_mfma_f32_16x16x32_bf16 a[152:155], a[200:203], v[136:139], a[152:155]
    s_add_u32 m0, s24, 36864
    v_exp_f32 v180, v180
    v_mfma_f32_16x16x32_bf16 a[152:155], a[204:207], v[140:143], a[152:155]
    ds_read_b128 a[232:235], v201 offset:22528
    v_fma_f32 v180, v180, s28, s28
    v_mfma_f32_16x16x32_bf16 a[156:159], a[204:207], v[156:159], a[156:159]
    s_waitcnt lgkmcnt(3)
    v_rcp_f32 v180, v180
    v_mfma_f32_16x16x32_bf16 a[156:159], a[200:203], v[152:155], a[156:159]
    buffer_load_dwordx4 v203, s[8:11], s26 offen offset:0 lds
    v_mul_f32 v180, v180, v164
    v_mfma_f32_16x16x32_bf16 a[156:159], a[196:199], v[148:151], a[156:159]
    ds_read_b128 a[236:239], v201 offset:23552
    v_fma_f32 v181, v165, v165, s27
    v_mfma_f32_16x16x32_bf16 a[156:159], a[192:195], v[144:147], a[156:159]
    ds_read_b128 a[192:195], v201 offset:24576
    v_mul_f32 v181, v181, v165
    v_mfma_f32_16x16x32_bf16 v[168:171], a[208:211], v[32:35], v[168:171]
    v_exp_f32 v181, v181
    v_mfma_f32_16x16x32_bf16 v[168:171], a[212:215], v[36:39], v[168:171]
    ds_read_b128 a[196:199], v201 offset:25600
    v_fma_f32 v181, v181, s28, s28
    v_mfma_f32_16x16x32_bf16 v[168:171], a[216:219], v[40:43], v[168:171]
    v_rcp_f32 v181, v181
    v_mfma_f32_16x16x32_bf16 v[168:171], a[220:223], v[44:47], v[168:171]
    buffer_load_dwordx4 v203, s[8:11], s26 offen offset:1024 lds
    v_mul_f32 v181, v181, v165
    v_cvt_pk_bf16_f32 v124, v180, v181
    v_mfma_f32_16x16x32_bf16 v[172:175], a[220:223], v[92:95], v[172:175]
    ds_read_b128 a[200:203], v201 offset:26624
    v_fma_f32 v182, v166, v166, s27
    v_mfma_f32_16x16x32_bf16 v[172:175], a[216:219], v[88:91], v[172:175]
    ds_read_b128 a[204:207], v201 offset:27648
    v_mul_f32 v182, v182, v166
    v_mfma_f32_16x16x32_bf16 v[172:175], a[212:215], v[84:87], v[172:175]
    s_waitcnt lgkmcnt(4)
    v_exp_f32 v182, v182
    v_mfma_f32_16x16x32_bf16 v[172:175], a[208:211], v[80:83], v[172:175]
    ds_read_b128 a[208:211], v201 offset:36864
    v_fma_f32 v182, v182, s28, s28
    v_mfma_f32_16x16x32_bf16 a[160:163], a[224:227], v[128:131], a[160:163]
    v_rcp_f32 v182, v182
    v_mfma_f32_16x16x32_bf16 a[160:163], a[228:231], v[132:135], a[160:163]
    buffer_load_dwordx4 v203, s[8:11], s26 offen offset:2048 lds
    v_mul_f32 v182, v182, v166
    v_mfma_f32_16x16x32_bf16 a[160:163], a[232:235], v[136:139], a[160:163]
    ds_read_b128 a[212:215], v201 offset:37888
    v_fma_f32 v183, v167, v167, s27
    v_mfma_f32_16x16x32_bf16 a[160:163], a[236:239], v[140:143], a[160:163]
    ds_read_b128 a[216:219], v201 offset:38912
    v_mul_f32 v183, v183, v167
    v_mfma_f32_16x16x32_bf16 a[164:167], a[236:239], v[156:159], a[164:167]
    s_waitcnt vmcnt(8)
    v_exp_f32 v183, v183
    v_mfma_f32_16x16x32_bf16 a[164:167], a[232:235], v[152:155], a[164:167]
    ds_read_b128 a[220:223], v201 offset:39936
    v_fma_f32 v183, v183, s28, s28
    v_mfma_f32_16x16x32_bf16 a[164:167], a[228:231], v[148:151], a[164:167]
    s_waitcnt lgkmcnt(4)
    v_rcp_f32 v183, v183
    v_mfma_f32_16x16x32_bf16 a[164:167], a[224:227], v[144:147], a[164:167]
    s_nop 0
    v_mul_f32 v183, v183, v167
    v_cvt_pk_bf16_f32 v125, v182, v183
    v_mfma_f32_16x16x32_bf16 v[160:163], a[192:195], v[0:3], 0
    ds_read_b128 a[224:227], v201 offset:28672
    v_fma_f32 v176, v168, v168, s27
    v_mfma_f32_16x16x32_bf16 v[160:163], a[196:199], v[4:7], v[160:163]
    ds_read_b128 a[228:231], v201 offset:29696
    v_mul_f32 v176, v176, v168
    v_mfma_f32_16x16x32_bf16 v[160:163], a[200:203], v[8:11], v[160:163]
    s_barrier
    v_exp_f32 v176, v176
    v_mfma_f32_16x16x32_bf16 v[160:163], a[204:207], v[12:15], v[160:163]
    ds_read_b128 a[232:235], v201 offset:30720
    v_fma_f32 v176, v176, s28, s28
    v_mfma_f32_16x16x32_bf16 v[164:167], a[204:207], v[60:63], 0
    s_waitcnt lgkmcnt(3)
    v_rcp_f32 v176, v176
    v_mfma_f32_16x16x32_bf16 v[164:167], a[200:203], v[56:59], v[164:167]
    s_add_u32 m0, s24, 49152
    v_mul_f32 v176, v176, v168
    v_mfma_f32_16x16x32_bf16 v[164:167], a[196:199], v[52:55], v[164:167]
    ds_read_b128 a[236:239], v201 offset:31744
    v_fma_f32 v177, v169, v169, s27
    v_mfma_f32_16x16x32_bf16 v[164:167], a[192:195], v[48:51], v[164:167]
    ds_read_b128 a[192:195], v201 offset:40960
    v_mul_f32 v177, v177, v169
    v_mfma_f32_16x16x32_bf16 a[168:171], a[208:211], v[128:131], a[168:171]
    s_add_u32 s25, s25, 24576
    v_exp_f32 v177, v177
    v_mfma_f32_16x16x32_bf16 a[168:171], a[212:215], v[132:135], a[168:171]
    ds_read_b128 a[196:199], v201 offset:41984
    v_fma_f32 v177, v177, s28, s28
    v_mfma_f32_16x16x32_bf16 a[168:171], a[216:219], v[136:139], a[168:171]
    v_rcp_f32 v177, v177
    v_mfma_f32_16x16x32_bf16 a[168:171], a[220:223], v[140:143], a[168:171]
    buffer_load_dwordx4 v203, s[8:11], s25 offen offset:0 lds
    v_mul_f32 v177, v177, v169
    v_cvt_pk_bf16_f32 v110, v176, v177
    v_mfma_f32_16x16x32_bf16 a[172:175], a[220:223], v[156:159], a[172:175]
    ds_read_b128 a[200:203], v201 offset:43008
    v_fma_f32 v178, v170, v170, s27
    v_mfma_f32_16x16x32_bf16 a[172:175], a[216:219], v[152:155], a[172:175]
    ds_read_b128 a[204:207], v201 offset:44032
    v_mul_f32 v178, v178, v170
    v_mfma_f32_16x16x32_bf16 a[172:175], a[212:215], v[148:151], a[172:175]
    s_waitcnt lgkmcnt(4)
    v_exp_f32 v178, v178
    v_mfma_f32_16x16x32_bf16 a[172:175], a[208:211], v[144:147], a[172:175]
    ds_read_b128 a[208:211], v201 offset:32768
    v_fma_f32 v178, v178, s28, s28
    v_mfma_f32_16x16x32_bf16 v[160:163], a[224:227], v[16:19], v[160:163]
    s_add_u32 s26, s26, 24576
    v_rcp_f32 v178, v178
    v_mfma_f32_16x16x32_bf16 v[160:163], a[228:231], v[20:23], v[160:163]
    buffer_load_dwordx4 v203, s[8:11], s25 offen offset:1024 lds
    v_mul_f32 v178, v178, v170
    v_mfma_f32_16x16x32_bf16 v[160:163], a[232:235], v[24:27], v[160:163]
    ds_read_b128 a[212:215], v201 offset:33792
    v_fma_f32 v179, v171, v171, s27
    v_mfma_f32_16x16x32_bf16 v[160:163], a[236:239], v[28:31], v[160:163]
    ds_read_b128 a[216:219], v201 offset:34816
    v_mul_f32 v179, v179, v171
    v_mfma_f32_16x16x32_bf16 v[164:167], a[236:239], v[76:79], v[164:167]
    v_exp_f32 v179, v179
    v_mfma_f32_16x16x32_bf16 v[164:167], a[232:235], v[72:75], v[164:167]
    ds_read_b128 a[220:223], v201 offset:35840
    v_fma_f32 v179, v179, s28, s28
    v_mfma_f32_16x16x32_bf16 v[164:167], a[228:231], v[68:71], v[164:167]
    s_waitcnt lgkmcnt(4)
    v_rcp_f32 v179, v179
    v_mfma_f32_16x16x32_bf16 v[164:167], a[224:227], v[64:67], v[164:167]
    buffer_load_dwordx4 v203, s[8:11], s25 offen offset:2048 lds
    v_mul_f32 v179, v179, v171
    v_cvt_pk_bf16_f32 v111, v178, v179
    v_mfma_f32_16x16x32_bf16 a[176:179], a[192:195], v[128:131], a[176:179]
    ds_read_b128 a[224:227], v201 offset:45056
    v_fma_f32 v180, v172, v172, s27
    v_mfma_f32_16x16x32_bf16 a[176:179], a[196:199], v[132:135], a[176:179]
    ds_read_b128 a[228:231], v201 offset:46080
    v_mul_f32 v180, v180, v172
    v_mfma_f32_16x16x32_bf16 a[176:179], a[200:203], v[136:139], a[176:179]
    s_add_u32 m0, s24, 61440
    v_exp_f32 v180, v180
    v_mfma_f32_16x16x32_bf16 a[176:179], a[204:207], v[140:143], a[176:179]
    ds_read_b128 a[232:235], v201 offset:47104
    v_fma_f32 v180, v180, s28, s28
    v_mfma_f32_16x16x32_bf16 a[180:183], a[204:207], v[156:159], a[180:183]
    s_waitcnt lgkmcnt(3)
    v_rcp_f32 v180, v180
    v_mfma_f32_16x16x32_bf16 a[180:183], a[200:203], v[152:155], a[180:183]
    buffer_load_dwordx4 v203, s[8:11], s26 offen offset:0 lds
    v_mul_f32 v180, v180, v172
    v_mfma_f32_16x16x32_bf16 a[180:183], a[196:199], v[148:151], a[180:183]
    ds_read_b128 a[236:239], v201 offset:48128
    v_fma_f32 v181, v173, v173, s27
    v_mfma_f32_16x16x32_bf16 a[180:183], a[192:195], v[144:147], a[180:183]
    ds_read_b128 a[192:195], v200 offset:0
    v_mul_f32 v181, v181, v173
    v_mfma_f32_16x16x32_bf16 v[160:163], a[208:211], v[32:35], v[160:163]
    v_exp_f32 v181, v181
    v_mfma_f32_16x16x32_bf16 v[160:163], a[212:215], v[36:39], v[160:163]
    ds_read_b128 a[196:199], v200 offset:1024
    v_fma_f32 v181, v181, s28, s28
    v_mfma_f32_16x16x32_bf16 v[160:163], a[216:219], v[40:43], v[160:163]
    v_rcp_f32 v181, v181
    v_mfma_f32_16x16x32_bf16 v[160:163], a[220:223], v[44:47], v[160:163]
    buffer_load_dwordx4 v203, s[8:11], s26 offen offset:1024 lds
    v_mul_f32 v181, v181, v173
    v_cvt_pk_bf16_f32 v126, v180, v181
    v_mfma_f32_16x16x32_bf16 v[164:167], a[220:223], v[92:95], v[164:167]
    ds_read_b128 a[200:203], v200 offset:2048
    v_fma_f32 v182, v174, v174, s27
    v_mfma_f32_16x16x32_bf16 v[164:167], a[216:219], v[88:91], v[164:167]
    ds_read_b128 a[204:207], v200 offset:3072
    v_mul_f32 v182, v182, v174
    v_mfma_f32_16x16x32_bf16 v[164:167], a[212:215], v[84:87], v[164:167]
    s_waitcnt lgkmcnt(4)
    v_exp_f32 v182, v182
    v_mfma_f32_16x16x32_bf16 v[164:167], a[208:211], v[80:83], v[164:167]
    ds_read_b128 a[208:211], v200 offset:12288
    v_fma_f32 v182, v182, s28, s28
    v_mfma_f32_16x16x32_bf16 a[184:187], a[224:227], v[128:131], a[184:187]
    v_rcp_f32 v182, v182
    v_mfma_f32_16x16x32_bf16 a[184:187], a[228:231], v[132:135], a[184:187]
    buffer_load_dwordx4 v203, s[8:11], s26 offen offset:2048 lds
    v_mul_f32 v182, v182, v174
    v_mfma_f32_16x16x32_bf16 a[184:187], a[232:235], v[136:139], a[184:187]
    ds_read_b128 a[212:215], v200 offset:13312
    v_fma_f32 v183, v175, v175, s27
    v_mfma_f32_16x16x32_bf16 a[184:187], a[236:239], v[140:143], a[184:187]
    ds_read_b128 a[216:219], v200 offset:14336
    v_mul_f32 v183, v183, v175
    v_mfma_f32_16x16x32_bf16 a[188:191], a[236:239], v[156:159], a[188:191]
    s_waitcnt vmcnt(6)
    v_exp_f32 v183, v183
    v_mfma_f32_16x16x32_bf16 a[188:191], a[232:235], v[152:155], a[188:191]
    ds_read_b128 a[220:223], v200 offset:15360
    v_fma_f32 v183, v183, s28, s28
    v_mfma_f32_16x16x32_bf16 a[188:191], a[228:231], v[148:151], a[188:191]
    s_waitcnt lgkmcnt(4)
    v_rcp_f32 v183, v183
    v_mfma_f32_16x16x32_bf16 a[188:191], a[224:227], v[144:147], a[188:191]
    s_nop 0
    v_mul_f32 v183, v183, v175
    v_cvt_pk_bf16_f32 v127, v182, v183
    v_mfma_f32_16x16x32_bf16 v[168:171], a[192:195], v[0:3], 0
    ds_read_b128 a[224:227], v200 offset:4096
    v_fma_f32 v176, v160, v160, s27
    v_mfma_f32_16x16x32_bf16 v[168:171], a[196:199], v[4:7], v[168:171]
    ds_read_b128 a[228:231], v200 offset:5120
    v_mul_f32 v176, v176, v160
    v_mfma_f32_16x16x32_bf16 v[168:171], a[200:203], v[8:11], v[168:171]
    s_barrier
    v_exp_f32 v176, v176
    v_mfma_f32_16x16x32_bf16 v[168:171], a[204:207], v[12:15], v[168:171]
    ds_read_b128 a[232:235], v200 offset:6144
    v_fma_f32 v176, v176, s28, s28
    v_mfma_f32_16x16x32_bf16 v[172:175], a[204:207], v[60:63], 0
    s_waitcnt lgkmcnt(3)
    v_rcp_f32 v176, v176
    v_mfma_f32_16x16x32_bf16 v[172:175], a[200:203], v[56:59], v[172:175]
    s_add_u32 m0, s24, 73728
    v_mul_f32 v176, v176, v160
    v_mfma_f32_16x16x32_bf16 v[172:175], a[196:199], v[52:55], v[172:175]
    ds_read_b128 a[236:239], v200 offset:7168
    v_fma_f32 v177, v161, v161, s27
    v_mfma_f32_16x16x32_bf16 v[172:175], a[192:195], v[48:51], v[172:175]
    ds_read_b128 a[192:195], v200 offset:16384
    v_mul_f32 v177, v177, v161
    v_mfma_f32_16x16x32_bf16 a[0:3], a[208:211], v[96:99], a[0:3]
    s_add_u32 s25, s25, 24576
    v_exp_f32 v177, v177
    v_mfma_f32_16x16x32_bf16 a[0:3], a[212:215], v[100:103], a[0:3]
    ds_read_b128 a[196:199], v200 offset:17408
    v_fma_f32 v177, v177, s28, s28
    v_mfma_f32_16x16x32_bf16 a[0:3], a[216:219], v[104:107], a[0:3]
    v_rcp_f32 v177, v177
    v_mfma_f32_16x16x32_bf16 a[0:3], a[220:223], v[108:111], a[0:3]
    buffer_load_dwordx4 v203, s[8:11], s25 offen offset:0 lds
    v_mul_f32 v177, v177, v161
    v_cvt_pk_bf16_f32 v128, v176, v177
    v_mfma_f32_16x16x32_bf16 a[4:7], a[220:223], v[124:127], a[4:7]
    ds_read_b128 a[200:203], v200 offset:18432
    v_fma_f32 v178, v162, v162, s27
    v_mfma_f32_16x16x32_bf16 a[4:7], a[216:219], v[120:123], a[4:7]
    ds_read_b128 a[204:207], v200 offset:19456
    v_mul_f32 v178, v178, v162
    v_mfma_f32_16x16x32_bf16 a[4:7], a[212:215], v[116:119], a[4:7]
    s_waitcnt lgkmcnt(4)
    v_exp_f32 v178, v178
    v_mfma_f32_16x16x32_bf16 a[4:7], a[208:211], v[112:115], a[4:7]
    ds_read_b128 a[208:211], v200 offset:8192
    v_fma_f32 v178, v178, s28, s28
    v_mfma_f32_16x16x32_bf16 v[168:171], a[224:227], v[16:19], v[168:171]
    s_add_u32 s26, s26, 24576
    v_rcp_f32 v178, v178
    v_mfma_f32_16x16x32_bf16 v[168:171], a[228:231], v[20:23], v[168:171]
    buffer_load_dwordx4 v203, s[8:11], s25 offen offset:1024 lds
    v_mul_f32 v178, v178, v162
    v_mfma_f32_16x16x32_bf16 v[168:171], a[232:235], v[24:27], v[168:171]
    ds_read_b128 a[212:215], v200 offset:9216
    v_fma_f32 v179, v163, v163, s27
    v_mfma_f32_16x16x32_bf16 v[168:171], a[236:239], v[28:31], v[168:171]
    ds_read_b128 a[216:219], v200 offset:10240
    v_mul_f32 v179, v179, v163
    v_mfma_f32_16x16x32_bf16 v[172:175], a[236:239], v[76:79], v[172:175]
    v_exp_f32 v179, v179
    v_mfma_f32_16x16x32_bf16 v[172:175], a[232:235], v[72:75], v[172:175]
    ds_read_b128 a[220:223], v200 offset:11264
    v_fma_f32 v179, v179, s28, s28
    v_mfma_f32_16x16x32_bf16 v[172:175], a[228:231], v[68:71], v[172:175]
    s_waitcnt lgkmcnt(4)
    v_rcp_f32 v179, v179
    v_mfma_f32_16x16x32_bf16 v[172:175], a[224:227], v[64:67], v[172:175]
    buffer_load_dwordx4 v203, s[8:11], s25 offen offset:2048 lds
    v_mul_f32 v179, v179, v163
    v_cvt_pk_bf16_f32 v129, v178, v179
    v_mfma_f32_16x16x32_bf16 a[8:11], a[192:195], v[96:99], a[8:11]
    ds_read_b128 a[224:227], v200 offset:20480
    v_fma_f32 v180, v164, v164, s27
    v_mfma_f32_16x16x32_bf16 a[8:11], a[196:199], v[100:103], a[8:11]
    ds_read_b128 a[228:231], v200 offset:21504
    v_mul_f32 v180, v180, v164
    v_mfma_f32_16x16x32_bf16 a[8:11], a[200:203], v[104:107], a[8:11]
    s_add_u32 m0, s24, 86016
    v_exp_f32 v180, v180
    v_mfma_f32_16x16x32_bf16 a[8:11], a[204:207], v[108:111], a[8:11]
    ds_read_b128 a[232:235], v200 offset:22528
    v_fma_f32 v180, v180, s28, s28
    v_mfma_f32_16x16x32_bf16 a[12:15], a[204:207], v[124:127], a[12:15]
    s_waitcnt lgkmcnt(3)
    v_rcp_f32 v180, v180
    v_mfma_f32_16x16x32_bf16 a[12:15], a[200:203], v[120:123], a[12:15]
    buffer_load_dwordx4 v203, s[8:11], s26 offen offset:0 lds
    v_mul_f32 v180, v180, v164
    v_mfma_f32_16x16x32_bf16 a[12:15], a[196:199], v[116:119], a[12:15]
    ds_read_b128 a[236:239], v200 offset:23552
    v_fma_f32 v181, v165, v165, s27
    v_mfma_f32_16x16x32_bf16 a[12:15], a[192:195], v[112:115], a[12:15]
    ds_read_b128 a[192:195], v200 offset:24576
    v_mul_f32 v181, v181, v165
    v_mfma_f32_16x16x32_bf16 v[168:171], a[208:211], v[32:35], v[168:171]
    v_exp_f32 v181, v181
    v_mfma_f32_16x16x32_bf16 v[168:171], a[212:215], v[36:39], v[168:171]
    ds_read_b128 a[196:199], v200 offset:25600
    v_fma_f32 v181, v181, s28, s28
    v_mfma_f32_16x16x32_bf16 v[168:171], a[216:219], v[40:43], v[168:171]
    v_rcp_f32 v181, v181
    v_mfma_f32_16x16x32_bf16 v[168:171], a[220:223], v[44:47], v[168:171]
    buffer_load_dwordx4 v203, s[8:11], s26 offen offset:1024 lds
    v_mul_f32 v181, v181, v165
    v_cvt_pk_bf16_f32 v144, v180, v181
    v_mfma_f32_16x16x32_bf16 v[172:175], a[220:223], v[92:95], v[172:175]
    ds_read_b128 a[200:203], v200 offset:26624
    v_fma_f32 v182, v166, v166, s27
    v_mfma_f32_16x16x32_bf16 v[172:175], a[216:219], v[88:91], v[172:175]
    ds_read_b128 a[204:207], v200 offset:27648
    v_mul_f32 v182, v182, v166
    v_mfma_f32_16x16x32_bf16 v[172:175], a[212:215], v[84:87], v[172:175]
    s_waitcnt lgkmcnt(4)
    v_exp_f32 v182, v182
    v_mfma_f32_16x16x32_bf16 v[172:175], a[208:211], v[80:83], v[172:175]
    ds_read_b128 a[208:211], v200 offset:36864
    v_fma_f32 v182, v182, s28, s28
    v_mfma_f32_16x16x32_bf16 a[16:19], a[224:227], v[96:99], a[16:19]
    v_rcp_f32 v182, v182
    v_mfma_f32_16x16x32_bf16 a[16:19], a[228:231], v[100:103], a[16:19]
    buffer_load_dwordx4 v203, s[8:11], s26 offen offset:2048 lds
    v_mul_f32 v182, v182, v166
    v_mfma_f32_16x16x32_bf16 a[16:19], a[232:235], v[104:107], a[16:19]
    ds_read_b128 a[212:215], v200 offset:37888
    v_fma_f32 v183, v167, v167, s27
    v_mfma_f32_16x16x32_bf16 a[16:19], a[236:239], v[108:111], a[16:19]
    ds_read_b128 a[216:219], v200 offset:38912
    v_mul_f32 v183, v183, v167
    v_mfma_f32_16x16x32_bf16 a[20:23], a[236:239], v[124:127], a[20:23]
    s_waitcnt vmcnt(6)
    v_exp_f32 v183, v183
    v_mfma_f32_16x16x32_bf16 a[20:23], a[232:235], v[120:123], a[20:23]
    ds_read_b128 a[220:223], v200 offset:39936
    v_fma_f32 v183, v183, s28, s28
    v_mfma_f32_16x16x32_bf16 a[20:23], a[228:231], v[116:119], a[20:23]
    s_waitcnt lgkmcnt(4)
    v_rcp_f32 v183, v183
    v_mfma_f32_16x16x32_bf16 a[20:23], a[224:227], v[112:115], a[20:23]
    s_nop 0
    v_mul_f32 v183, v183, v167
    v_cvt_pk_bf16_f32 v145, v182, v183
    v_mfma_f32_16x16x32_bf16 v[160:163], a[192:195], v[0:3], 0
    ds_read_b128 a[224:227], v200 offset:28672
    v_fma_f32 v176, v168, v168, s27
    v_mfma_f32_16x16x32_bf16 v[160:163], a[196:199], v[4:7], v[160:163]
    ds_read_b128 a[228:231], v200 offset:29696
    v_mul_f32 v176, v176, v168
    v_mfma_f32_16x16x32_bf16 v[160:163], a[200:203], v[8:11], v[160:163]
    s_barrier
    v_exp_f32 v176, v176
    v_mfma_f32_16x16x32_bf16 v[160:163], a[204:207], v[12:15], v[160:163]
    ds_read_b128 a[232:235], v200 offset:30720
    v_fma_f32 v176, v176, s28, s28
    v_mfma_f32_16x16x32_bf16 v[164:167], a[204:207], v[60:63], 0
    s_waitcnt lgkmcnt(3)
    v_rcp_f32 v176, v176
    v_mfma_f32_16x16x32_bf16 v[164:167], a[200:203], v[56:59], v[164:167]
    s_add_u32 m0, s24, 0
    v_mul_f32 v176, v176, v168
    v_mfma_f32_16x16x32_bf16 v[164:167], a[196:199], v[52:55], v[164:167]
    ds_read_b128 a[236:239], v200 offset:31744
    v_fma_f32 v177, v169, v169, s27
    v_mfma_f32_16x16x32_bf16 v[164:167], a[192:195], v[48:51], v[164:167]
    ds_read_b128 a[192:195], v200 offset:40960
    v_mul_f32 v177, v177, v169
    v_mfma_f32_16x16x32_bf16 a[24:27], a[208:211], v[96:99], a[24:27]
    s_add_u32 s25, s25, 24576
    v_exp_f32 v177, v177
    v_mfma_f32_16x16x32_bf16 a[24:27], a[212:215], v[100:103], a[24:27]
    ds_read_b128 a[196:199], v200 offset:41984
    v_fma_f32 v177, v177, s28, s28
    v_mfma_f32_16x16x32_bf16 a[24:27], a[216:219], v[104:107], a[24:27]
    v_rcp_f32 v177, v177
    v_mfma_f32_16x16x32_bf16 a[24:27], a[220:223], v[108:111], a[24:27]
    buffer_load_dwordx4 v203, s[8:11], s25 offen offset:0 lds
    v_mul_f32 v177, v177, v169
    v_cvt_pk_bf16_f32 v130, v176, v177
    v_mfma_f32_16x16x32_bf16 a[28:31], a[220:223], v[124:127], a[28:31]
    ds_read_b128 a[200:203], v200 offset:43008
    v_fma_f32 v178, v170, v170, s27
    v_mfma_f32_16x16x32_bf16 a[28:31], a[216:219], v[120:123], a[28:31]
    ds_read_b128 a[204:207], v200 offset:44032
    v_mul_f32 v178, v178, v170
    v_mfma_f32_16x16x32_bf16 a[28:31], a[212:215], v[116:119], a[28:31]
    s_waitcnt lgkmcnt(4)
    v_exp_f32 v178, v178
    v_mfma_f32_16x16x32_bf16 a[28:31], a[208:211], v[112:115], a[28:31]
    ds_read_b128 a[208:211], v200 offset:32768
    v_fma_f32 v178, v178, s28, s28
    v_mfma_f32_16x16x32_bf16 v[160:163], a[224:227], v[16:19], v[160:163]
    s_add_u32 s26, s26, 24576
    v_rcp_f32 v178, v178
    v_mfma_f32_16x16x32_bf16 v[160:163], a[228:231], v[20:23], v[160:163]
    buffer_load_dwordx4 v203, s[8:11], s25 offen offset:1024 lds
    v_mul_f32 v178, v178, v170
    v_mfma_f32_16x16x32_bf16 v[160:163], a[232:235], v[24:27], v[160:163]
    ds_read_b128 a[212:215], v200 offset:33792
    v_fma_f32 v179, v171, v171, s27
    v_mfma_f32_16x16x32_bf16 v[160:163], a[236:239], v[28:31], v[160:163]
    ds_read_b128 a[216:219], v200 offset:34816
    v_mul_f32 v179, v179, v171
    v_mfma_f32_16x16x32_bf16 v[164:167], a[236:239], v[76:79], v[164:167]
    v_exp_f32 v179, v179
    v_mfma_f32_16x16x32_bf16 v[164:167], a[232:235], v[72:75], v[164:167]
    ds_read_b128 a[220:223], v200 offset:35840
    v_fma_f32 v179, v179, s28, s28
    v_mfma_f32_16x16x32_bf16 v[164:167], a[228:231], v[68:71], v[164:167]
    s_waitcnt lgkmcnt(4)
    v_rcp_f32 v179, v179
    v_mfma_f32_16x16x32_bf16 v[164:167], a[224:227], v[64:67], v[164:167]
    buffer_load_dwordx4 v203, s[8:11], s25 offen offset:2048 lds
    v_mul_f32 v179, v179, v171
    v_cvt_pk_bf16_f32 v131, v178, v179
    v_mfma_f32_16x16x32_bf16 a[32:35], a[192:195], v[96:99], a[32:35]
    ds_read_b128 a[224:227], v200 offset:45056
    v_fma_f32 v180, v172, v172, s27
    v_mfma_f32_16x16x32_bf16 a[32:35], a[196:199], v[100:103], a[32:35]
    ds_read_b128 a[228:231], v200 offset:46080
    v_mul_f32 v180, v180, v172
    v_mfma_f32_16x16x32_bf16 a[32:35], a[200:203], v[104:107], a[32:35]
    s_add_u32 m0, s24, 12288
    v_exp_f32 v180, v180
    v_mfma_f32_16x16x32_bf16 a[32:35], a[204:207], v[108:111], a[32:35]
    ds_read_b128 a[232:235], v200 offset:47104
    v_fma_f32 v180, v180, s28, s28
    v_mfma_f32_16x16x32_bf16 a[36:39], a[204:207], v[124:127], a[36:39]
    s_waitcnt lgkmcnt(3)
    v_rcp_f32 v180, v180
    v_mfma_f32_16x16x32_bf16 a[36:39], a[200:203], v[120:123], a[36:39]
    buffer_load_dwordx4 v203, s[8:11], s26 offen offset:0 lds
    v_mul_f32 v180, v180, v172
    v_mfma_f32_16x16x32_bf16 a[36:39], a[196:199], v[116:119], a[36:39]
    ds_read_b128 a[236:239], v200 offset:48128
    v_fma_f32 v181, v173, v173, s27
    v_mfma_f32_16x16x32_bf16 a[36:39], a[192:195], v[112:115], a[36:39]
    ds_read_b128 a[192:195], v201 offset:0
    v_mul_f32 v181, v181, v173
    v_mfma_f32_16x16x32_bf16 v[160:163], a[208:211], v[32:35], v[160:163]
    v_exp_f32 v181, v181
    v_mfma_f32_16x16x32_bf16 v[160:163], a[212:215], v[36:39], v[160:163]
    ds_read_b128 a[196:199], v201 offset:1024
    v_fma_f32 v181, v181, s28, s28
    v_mfma_f32_16x16x32_bf16 v[160:163], a[216:219], v[40:43], v[160:163]
    v_rcp_f32 v181, v181
    v_mfma_f32_16x16x32_bf16 v[160:163], a[220:223], v[44:47], v[160:163]
    buffer_load_dwordx4 v203, s[8:11], s26 offen offset:1024 lds
    v_mul_f32 v181, v181, v173
    v_cvt_pk_bf16_f32 v146, v180, v181
    v_mfma_f32_16x16x32_bf16 v[164:167], a[220:223], v[92:95], v[164:167]
    ds_read_b128 a[200:203], v201 offset:2048
    v_fma_f32 v182, v174, v174, s27
    v_mfma_f32_16x16x32_bf16 v[164:167], a[216:219], v[88:91], v[164:167]
    ds_read_b128 a[204:207], v201 offset:3072
    v_mul_f32 v182, v182, v174
    v_mfma_f32_16x16x32_bf16 v[164:167], a[212:215], v[84:87], v[164:167]
    s_waitcnt lgkmcnt(4)
    v_exp_f32 v182, v182
    v_mfma_f32_16x16x32_bf16 v[164:167], a[208:211], v[80:83], v[164:167]
    ds_read_b128 a[208:211], v201 offset:12288
    v_fma_f32 v182, v182, s28, s28
    v_mfma_f32_16x16x32_bf16 a[40:43], a[224:227], v[96:99], a[40:43]
    v_rcp_f32 v182, v182
    v_mfma_f32_16x16x32_bf16 a[40:43], a[228:231], v[100:103], a[40:43]
    buffer_load_dwordx4 v203, s[8:11], s26 offen offset:2048 lds
    v_mul_f32 v182, v182, v174
    v_mfma_f32_16x16x32_bf16 a[40:43], a[232:235], v[104:107], a[40:43]
    ds_read_b128 a[212:215], v201 offset:13312
    v_fma_f32 v183, v175, v175, s27
    v_mfma_f32_16x16x32_bf16 a[40:43], a[236:239], v[108:111], a[40:43]
    ds_read_b128 a[216:219], v201 offset:14336
    v_mul_f32 v183, v183, v175
    v_mfma_f32_16x16x32_bf16 a[44:47], a[236:239], v[124:127], a[44:47]
    s_waitcnt vmcnt(6)
    v_exp_f32 v183, v183
    v_mfma_f32_16x16x32_bf16 a[44:47], a[232:235], v[120:123], a[44:47]
    ds_read_b128 a[220:223], v201 offset:15360
    v_fma_f32 v183, v183, s28, s28
    v_mfma_f32_16x16x32_bf16 a[44:47], a[228:231], v[116:119], a[44:47]
    s_waitcnt lgkmcnt(4)
    v_rcp_f32 v183, v183
    v_mfma_f32_16x16x32_bf16 a[44:47], a[224:227], v[112:115], a[44:47]
    s_nop 0
    v_mul_f32 v183, v183, v175
    v_cvt_pk_bf16_f32 v147, v182, v183
    v_mfma_f32_16x16x32_bf16 v[168:171], a[192:195], v[0:3], 0
    ds_read_b128 a[224:227], v201 offset:4096
    v_fma_f32 v176, v160, v160, s27
    v_mfma_f32_16x16x32_bf16 v[168:171], a[196:199], v[4:7], v[168:171]
    ds_read_b128 a[228:231], v201 offset:5120
    v_mul_f32 v176, v176, v160
    v_mfma_f32_16x16x32_bf16 v[168:171], a[200:203], v[8:11], v[168:171]
    s_barrier
    v_exp_f32 v176, v176
    v_mfma_f32_16x16x32_bf16 v[168:171], a[204:207], v[12:15], v[168:171]
    ds_read_b128 a[232:235], v201 offset:6144
    v_fma_f32 v176, v176, s28, s28
    v_mfma_f32_16x16x32_bf16 v[172:175], a[204:207], v[60:63], 0
    s_waitcnt lgkmcnt(3)
    v_rcp_f32 v176, v176
    v_mfma_f32_16x16x32_bf16 v[172:175], a[200:203], v[56:59], v[172:175]
    s_add_u32 m0, s24, 24576
    v_mul_f32 v176, v176, v160
    v_mfma_f32_16x16x32_bf16 v[172:175], a[196:199], v[52:55], v[172:175]
    ds_read_b128 a[236:239], v201 offset:7168
    v_fma_f32 v177, v161, v161, s27
    v_mfma_f32_16x16x32_bf16 v[172:175], a[192:195], v[48:51], v[172:175]
    ds_read_b128 a[192:195], v201 offset:16384
    v_mul_f32 v177, v177, v161
    v_mfma_f32_16x16x32_bf16 a[48:51], a[208:211], v[96:99], a[48:51]
    s_add_u32 s25, s25, 24576
    v_exp_f32 v177, v177
    v_mfma_f32_16x16x32_bf16 a[48:51], a[212:215], v[100:103], a[48:51]
    ds_read_b128 a[196:199], v201 offset:17408
    v_fma_f32 v177, v177, s28, s28
    v_mfma_f32_16x16x32_bf16 a[48:51], a[216:219], v[104:107], a[48:51]
    v_rcp_f32 v177, v177
    v_mfma_f32_16x16x32_bf16 a[48:51], a[220:223], v[108:111], a[48:51]
    buffer_load_dwordx4 v203, s[8:11], s25 offen offset:0 lds
    v_mul_f32 v177, v177, v161
    v_cvt_pk_bf16_f32 v132, v176, v177
    v_mfma_f32_16x16x32_bf16 a[52:55], a[220:223], v[124:127], a[52:55]
    ds_read_b128 a[200:203], v201 offset:18432
    v_fma_f32 v178, v162, v162, s27
    v_mfma_f32_16x16x32_bf16 a[52:55], a[216:219], v[120:123], a[52:55]
    ds_read_b128 a[204:207], v201 offset:19456
    v_mul_f32 v178, v178, v162
    v_mfma_f32_16x16x32_bf16 a[52:55], a[212:215], v[116:119], a[52:55]
    s_waitcnt lgkmcnt(4)
    v_exp_f32 v178, v178
    v_mfma_f32_16x16x32_bf16 a[52:55], a[208:211], v[112:115], a[52:55]
    ds_read_b128 a[208:211], v201 offset:8192
    v_fma_f32 v178, v178, s28, s28
    v_mfma_f32_16x16x32_bf16 v[168:171], a[224:227], v[16:19], v[168:171]
    s_add_u32 s26, s26, 24576
    v_rcp_f32 v178, v178
    v_mfma_f32_16x16x32_bf16 v[168:171], a[228:231], v[20:23], v[168:171]
    buffer_load_dwordx4 v203, s[8:11], s25 offen offset:1024 lds
    v_mul_f32 v178, v178, v162
    v_mfma_f32_16x16x32_bf16 v[168:171], a[232:235], v[24:27], v[168:171]
    ds_read_b128 a[212:215], v201 offset:9216
    v_fma_f32 v179, v163, v163, s27
    v_mfma_f32_16x16x32_bf16 v[168:171], a[236:239], v[28:31], v[168:171]
    ds_read_b128 a[216:219], v201 offset:10240
    v_mul_f32 v179, v179, v163
    v_mfma_f32_16x16x32_bf16 v[172:175], a[236:239], v[76:79], v[172:175]
    v_exp_f32 v179, v179
    v_mfma_f32_16x16x32_bf16 v[172:175], a[232:235], v[72:75], v[172:175]
    ds_read_b128 a[220:223], v201 offset:11264
    v_fma_f32 v179, v179, s28, s28
    v_mfma_f32_16x16x32_bf16 v[172:175], a[228:231], v[68:71], v[172:175]
    s_waitcnt lgkmcnt(4)
    v_rcp_f32 v179, v179
    v_mfma_f32_16x16x32_bf16 v[172:175], a[224:227], v[64:67], v[172:175]
    buffer_load_dwordx4 v203, s[8:11], s25 offen offset:2048 lds
    v_mul_f32 v179, v179, v163
    v_cvt_pk_bf16_f32 v133, v178, v179
    v_mfma_f32_16x16x32_bf16 a[56:59], a[192:195], v[96:99], a[56:59]
    ds_read_b128 a[224:227], v201 offset:20480
    v_fma_f32 v180, v164, v164, s27
    v_mfma_f32_16x16x32_bf16 a[56:59], a[196:199], v[100:103], a[56:59]
    ds_read_b128 a[228:231], v201 offset:21504
    v_mul_f32 v180, v180, v164
    v_mfma_f32_16x16x32_bf16 a[56:59], a[200:203], v[104:107], a[56:59]
    s_add_u32 m0, s24, 36864
    v_exp_f32 v180, v180
    v_mfma_f32_16x16x32_bf16 a[56:59], a[204:207], v[108:111], a[56:59]
    ds_read_b128 a[232:235], v201 offset:22528
    v_fma_f32 v180, v180, s28, s28
    v_mfma_f32_16x16x32_bf16 a[60:63], a[204:207], v[124:127], a[60:63]
    s_waitcnt lgkmcnt(3)
    v_rcp_f32 v180, v180
    v_mfma_f32_16x16x32_bf16 a[60:63], a[200:203], v[120:123], a[60:63]
    buffer_load_dwordx4 v203, s[8:11], s26 offen offset:0 lds
    v_mul_f32 v180, v180, v164
    v_mfma_f32_16x16x32_bf16 a[60:63], a[196:199], v[116:119], a[60:63]
    ds_read_b128 a[236:239], v201 offset:23552
    v_fma_f32 v181, v165, v165, s27
    v_mfma_f32_16x16x32_bf16 a[60:63], a[192:195], v[112:115], a[60:63]
    ds_read_b128 a[192:195], v201 offset:24576
    v_mul_f32 v181, v181, v165
    v_mfma_f32_16x16x32_bf16 v[168:171], a[208:211], v[32:35], v[168:171]
    v_exp_f32 v181, v181
    v_mfma_f32_16x16x32_bf16 v[168:171], a[212:215], v[36:39], v[168:171]
    ds_read_b128 a[196:199], v201 offset:25600
    v_fma_f32 v181, v181, s28, s28
    v_mfma_f32_16x16x32_bf16 v[168:171], a[216:219], v[40:43], v[168:171]
    v_rcp_f32 v181, v181
    v_mfma_f32_16x16x32_bf16 v[168:171], a[220:223], v[44:47], v[168:171]
    buffer_load_dwordx4 v203, s[8:11], s26 offen offset:1024 lds
    v_mul_f32 v181, v181, v165
    v_cvt_pk_bf16_f32 v148, v180, v181
    v_mfma_f32_16x16x32_bf16 v[172:175], a[220:223], v[92:95], v[172:175]
    ds_read_b128 a[200:203], v201 offset:26624
    v_fma_f32 v182, v166, v166, s27
    v_mfma_f32_16x16x32_bf16 v[172:175], a[216:219], v[88:91], v[172:175]
    ds_read_b128 a[204:207], v201 offset:27648
    v_mul_f32 v182, v182, v166
    v_mfma_f32_16x16x32_bf16 v[172:175], a[212:215], v[84:87], v[172:175]
    s_waitcnt lgkmcnt(4)
    v_exp_f32 v182, v182
    v_mfma_f32_16x16x32_bf16 v[172:175], a[208:211], v[80:83], v[172:175]
    ds_read_b128 a[208:211], v201 offset:36864
    v_fma_f32 v182, v182, s28, s28
    v_mfma_f32_16x16x32_bf16 a[64:67], a[224:227], v[96:99], a[64:67]
    s_waitcnt vmcnt(5)
    v_rcp_f32 v182, v182
    v_mfma_f32_16x16x32_bf16 a[64:67], a[228:231], v[100:103], a[64:67]
    buffer_load_dwordx4 v203, s[8:11], s26 offen offset:2048 lds
    v_mul_f32 v182, v182, v166
    v_mfma_f32_16x16x32_bf16 a[64:67], a[232:235], v[104:107], a[64:67]
    ds_read_b128 a[212:215], v201 offset:37888
    v_fma_f32 v183, v167, v167, s27
    v_mfma_f32_16x16x32_bf16 a[64:67], a[236:239], v[108:111], a[64:67]
    ds_read_b128 a[216:219], v201 offset:38912
    v_mul_f32 v183, v183, v167
    v_mfma_f32_16x16x32_bf16 a[68:71], a[236:239], v[124:127], a[68:71]
    s_mov_b32 m0, s33
    v_exp_f32 v183, v183
    v_mfma_f32_16x16x32_bf16 a[68:71], a[232:235], v[120:123], a[68:71]
    ds_read_b128 a[220:223], v201 offset:39936
    v_fma_f32 v183, v183, s28, s28
    v_mfma_f32_16x16x32_bf16 a[68:71], a[228:231], v[116:119], a[68:71]
    s_waitcnt lgkmcnt(4)
    v_rcp_f32 v183, v183
    v_mfma_f32_16x16x32_bf16 a[68:71], a[224:227], v[112:115], a[68:71]
    buffer_load_dwordx4 v214, s[4:7], s34 offen lds
    v_mul_f32 v183, v183, v167
    v_cvt_pk_bf16_f32 v149, v182, v183
    buffer_load_dword a253, v214, s[4:7], s3 offen
    s_add_u32 s33, s33, 1024
    v_mov_b32 v184, v212
    v_mov_b32 v185, v213
    v_mov_b32 v186, v214
    v_mov_b32 v212, v215
    v_mov_b32 v213, v216
    v_mov_b32 v214, v217
    v_mov_b32 v215, v218
    v_mov_b32 v216, v219
    v_mov_b32 v217, v220
    v_mov_b32 v218, v221
    v_mov_b32 v219, v222
    v_mov_b32 v220, v223
    v_mov_b32 v221, v224
    v_mov_b32 v222, v225
    v_mov_b32 v223, v226
    v_mov_b32 v224, v184
    v_mov_b32 v225, v185
    v_mov_b32 v226, v186
    v_mfma_f32_16x16x32_bf16 v[160:163], a[192:195], v[0:3], 0
    ds_read_b128 a[224:227], v201 offset:28672
    v_fma_f32 v176, v168, v168, s27
    v_mfma_f32_16x16x32_bf16 v[160:163], a[196:199], v[4:7], v[160:163]
    ds_read_b128 a[228:231], v201 offset:29696
    v_mul_f32 v176, v176, v168
    v_mfma_f32_16x16x32_bf16 v[160:163], a[200:203], v[8:11], v[160:163]
    s_barrier
    v_exp_f32 v176, v176
    v_mfma_f32_16x16x32_bf16 v[160:163], a[204:207], v[12:15], v[160:163]
    ds_read_b128 a[232:235], v201 offset:30720
    v_fma_f32 v176, v176, s28, s28
    v_mfma_f32_16x16x32_bf16 v[164:167], a[204:207], v[60:63], 0
    s_waitcnt lgkmcnt(3)
    v_rcp_f32 v176, v176
    v_mfma_f32_16x16x32_bf16 v[164:167], a[200:203], v[56:59], v[164:167]
    s_add_u32 m0, s24, 49152
    v_mul_f32 v176, v176, v168
    v_mfma_f32_16x16x32_bf16 v[164:167], a[196:199], v[52:55], v[164:167]
    ds_read_b128 a[236:239], v201 offset:31744
    v_fma_f32 v177, v169, v169, s27
    v_mfma_f32_16x16x32_bf16 v[164:167], a[192:195], v[48:51], v[164:167]
    ds_read_b128 a[192:195], v201 offset:40960
    v_mul_f32 v177, v177, v169
    v_mfma_f32_16x16x32_bf16 a[72:75], a[208:211], v[96:99], a[72:75]
    s_add_u32 s25, s25, 24576
    v_exp_f32 v177, v177
    v_mfma_f32_16x16x32_bf16 a[72:75], a[212:215], v[100:103], a[72:75]
    ds_read_b128 a[196:199], v201 offset:41984
    v_fma_f32 v177, v177, s28, s28
    v_mfma_f32_16x16x32_bf16 a[72:75], a[216:219], v[104:107], a[72:75]
    v_rcp_f32 v177, v177
    v_mfma_f32_16x16x32_bf16 a[72:75], a[220:223], v[108:111], a[72:75]
    buffer_load_dwordx4 v203, s[8:11], s25 offen offset:0 lds
    v_mul_f32 v177, v177, v169
    v_cvt_pk_bf16_f32 v134, v176, v177
    v_mfma_f32_16x16x32_bf16 a[76:79], a[220:223], v[124:127], a[76:79]
    ds_read_b128 a[200:203], v201 offset:43008
    v_fma_f32 v178, v170, v170, s27
    v_mfma_f32_16x16x32_bf16 a[76:79], a[216:219], v[120:123], a[76:79]
    ds_read_b128 a[204:207], v201 offset:44032
    v_mul_f32 v178, v178, v170
    v_mfma_f32_16x16x32_bf16 a[76:79], a[212:215], v[116:119], a[76:79]
    s_waitcnt lgkmcnt(4)
    v_exp_f32 v178, v178
    v_mfma_f32_16x16x32_bf16 a[76:79], a[208:211], v[112:115], a[76:79]
    ds_read_b128 a[208:211], v201 offset:32768
    v_fma_f32 v178, v178, s28, s28
    v_mfma_f32_16x16x32_bf16 v[160:163], a[224:227], v[16:19], v[160:163]
    s_add_u32 s26, s26, 24576
    v_rcp_f32 v178, v178
    v_mfma_f32_16x16x32_bf16 v[160:163], a[228:231], v[20:23], v[160:163]
    buffer_load_dwordx4 v203, s[8:11], s25 offen offset:1024 lds
    v_mul_f32 v178, v178, v170
    v_mfma_f32_16x16x32_bf16 v[160:163], a[232:235], v[24:27], v[160:163]
    ds_read_b128 a[212:215], v201 offset:33792
    v_fma_f32 v179, v171, v171, s27
    v_mfma_f32_16x16x32_bf16 v[160:163], a[236:239], v[28:31], v[160:163]
    ds_read_b128 a[216:219], v201 offset:34816
    v_mul_f32 v179, v179, v171
    v_mfma_f32_16x16x32_bf16 v[164:167], a[236:239], v[76:79], v[164:167]
    v_exp_f32 v179, v179
    v_mfma_f32_16x16x32_bf16 v[164:167], a[232:235], v[72:75], v[164:167]
    ds_read_b128 a[220:223], v201 offset:35840
    v_fma_f32 v179, v179, s28, s28
    v_mfma_f32_16x16x32_bf16 v[164:167], a[228:231], v[68:71], v[164:167]
    s_waitcnt lgkmcnt(4)
    v_rcp_f32 v179, v179
    v_mfma_f32_16x16x32_bf16 v[164:167], a[224:227], v[64:67], v[164:167]
    buffer_load_dwordx4 v203, s[8:11], s25 offen offset:2048 lds
    v_mul_f32 v179, v179, v171
    v_cvt_pk_bf16_f32 v135, v178, v179
    v_mfma_f32_16x16x32_bf16 a[80:83], a[192:195], v[96:99], a[80:83]
    ds_read_b128 a[224:227], v201 offset:45056
    v_fma_f32 v180, v172, v172, s27
    v_mfma_f32_16x16x32_bf16 a[80:83], a[196:199], v[100:103], a[80:83]
    ds_read_b128 a[228:231], v201 offset:46080
    v_mul_f32 v180, v180, v172
    v_mfma_f32_16x16x32_bf16 a[80:83], a[200:203], v[104:107], a[80:83]
    s_add_u32 m0, s24, 61440
    v_exp_f32 v180, v180
    v_mfma_f32_16x16x32_bf16 a[80:83], a[204:207], v[108:111], a[80:83]
    ds_read_b128 a[232:235], v201 offset:47104
    v_fma_f32 v180, v180, s28, s28
    v_mfma_f32_16x16x32_bf16 a[84:87], a[204:207], v[124:127], a[84:87]
    s_waitcnt lgkmcnt(3)
    v_rcp_f32 v180, v180
    v_mfma_f32_16x16x32_bf16 a[84:87], a[200:203], v[120:123], a[84:87]
    buffer_load_dwordx4 v203, s[8:11], s26 offen offset:0 lds
    v_mul_f32 v180, v180, v172
    v_mfma_f32_16x16x32_bf16 a[84:87], a[196:199], v[116:119], a[84:87]
    ds_read_b128 a[236:239], v201 offset:48128
    v_fma_f32 v181, v173, v173, s27
    v_mfma_f32_16x16x32_bf16 a[84:87], a[192:195], v[112:115], a[84:87]
    ds_read_b128 a[192:195], v200 offset:0
    v_mul_f32 v181, v181, v173
    v_mfma_f32_16x16x32_bf16 v[160:163], a[208:211], v[32:35], v[160:163]
    v_exp_f32 v181, v181
    v_mfma_f32_16x16x32_bf16 v[160:163], a[212:215], v[36:39], v[160:163]
    ds_read_b128 a[196:199], v200 offset:1024
    v_fma_f32 v181, v181, s28, s28
    v_mfma_f32_16x16x32_bf16 v[160:163], a[216:219], v[40:43], v[160:163]
    v_rcp_f32 v181, v181
    v_mfma_f32_16x16x32_bf16 v[160:163], a[220:223], v[44:47], v[160:163]
    buffer_load_dwordx4 v203, s[8:11], s26 offen offset:1024 lds
    v_mul_f32 v181, v181, v173
    v_cvt_pk_bf16_f32 v150, v180, v181
    v_mfma_f32_16x16x32_bf16 v[164:167], a[220:223], v[92:95], v[164:167]
    ds_read_b128 a[200:203], v200 offset:2048
    v_fma_f32 v182, v174, v174, s27
    v_mfma_f32_16x16x32_bf16 v[164:167], a[216:219], v[88:91], v[164:167]
    ds_read_b128 a[204:207], v200 offset:3072
    v_mul_f32 v182, v182, v174
    v_mfma_f32_16x16x32_bf16 v[164:167], a[212:215], v[84:87], v[164:167]
    s_waitcnt lgkmcnt(4)
    v_exp_f32 v182, v182
    v_mfma_f32_16x16x32_bf16 v[164:167], a[208:211], v[80:83], v[164:167]
    ds_read_b128 a[208:211], v200 offset:12288
    v_fma_f32 v182, v182, s28, s28
    v_mfma_f32_16x16x32_bf16 a[88:91], a[224:227], v[96:99], a[88:91]
    v_rcp_f32 v182, v182
    v_mfma_f32_16x16x32_bf16 a[88:91], a[228:231], v[100:103], a[88:91]
    buffer_load_dwordx4 v203, s[8:11], s26 offen offset:2048 lds
    v_mul_f32 v182, v182, v174
    v_mfma_f32_16x16x32_bf16 a[88:91], a[232:235], v[104:107], a[88:91]
    ds_read_b128 a[212:215], v200 offset:13312
    v_fma_f32 v183, v175, v175, s27
    v_mfma_f32_16x16x32_bf16 a[88:91], a[236:239], v[108:111], a[88:91]
    ds_read_b128 a[216:219], v200 offset:14336
    v_mul_f32 v183, v183, v175
    v_mfma_f32_16x16x32_bf16 a[92:95], a[236:239], v[124:127], a[92:95]
    s_waitcnt vmcnt(8)
    v_exp_f32 v183, v183
    v_mfma_f32_16x16x32_bf16 a[92:95], a[232:235], v[120:123], a[92:95]
    ds_read_b128 a[220:223], v200 offset:15360
    v_fma_f32 v183, v183, s28, s28
    v_mfma_f32_16x16x32_bf16 a[92:95], a[228:231], v[116:119], a[92:95]
    s_waitcnt lgkmcnt(4)
    v_rcp_f32 v183, v183
    v_mfma_f32_16x16x32_bf16 a[92:95], a[224:227], v[112:115], a[92:95]
    s_nop 0
    v_mul_f32 v183, v183, v175
    v_cvt_pk_bf16_f32 v151, v182, v183
    v_mfma_f32_16x16x32_bf16 v[168:171], a[192:195], v[0:3], 0
    ds_read_b128 a[224:227], v200 offset:4096
    v_fma_f32 v176, v160, v160, s27
    v_mfma_f32_16x16x32_bf16 v[168:171], a[196:199], v[4:7], v[168:171]
    ds_read_b128 a[228:231], v200 offset:5120
    v_mul_f32 v176, v176, v160
    v_mfma_f32_16x16x32_bf16 v[168:171], a[200:203], v[8:11], v[168:171]
    s_barrier
    v_exp_f32 v176, v176
    v_mfma_f32_16x16x32_bf16 v[168:171], a[204:207], v[12:15], v[168:171]
    ds_read_b128 a[232:235], v200 offset:6144
    v_fma_f32 v176, v176, s28, s28
    v_mfma_f32_16x16x32_bf16 v[172:175], a[204:207], v[60:63], 0
    s_waitcnt lgkmcnt(3)
    v_rcp_f32 v176, v176
    v_mfma_f32_16x16x32_bf16 v[172:175], a[200:203], v[56:59], v[172:175]
    s_add_u32 m0, s24, 73728
    v_mul_f32 v176, v176, v160
    v_mfma_f32_16x16x32_bf16 v[172:175], a[196:199], v[52:55], v[172:175]
    ds_read_b128 a[236:239], v200 offset:7168
    v_fma_f32 v177, v161, v161, s27
    v_mfma_f32_16x16x32_bf16 v[172:175], a[192:195], v[48:51], v[172:175]
    ds_read_b128 a[192:195], v200 offset:16384
    v_mul_f32 v177, v177, v161
    v_mfma_f32_16x16x32_bf16 a[96:99], a[208:211], v[96:99], a[96:99]
    s_add_u32 s25, s25, 24576
    v_exp_f32 v177, v177
    v_mfma_f32_16x16x32_bf16 a[96:99], a[212:215], v[100:103], a[96:99]
    ds_read_b128 a[196:199], v200 offset:17408
    v_fma_f32 v177, v177, s28, s28
    v_mfma_f32_16x16x32_bf16 a[96:99], a[216:219], v[104:107], a[96:99]
    v_rcp_f32 v177, v177
    v_mfma_f32_16x16x32_bf16 a[96:99], a[220:223], v[108:111], a[96:99]
    buffer_load_dwordx4 v203, s[8:11], s25 offen offset:0 lds
    v_mul_f32 v177, v177, v161
    v_cvt_pk_bf16_f32 v136, v176, v177
    v_mfma_f32_16x16x32_bf16 a[100:103], a[220:223], v[124:127], a[100:103]
    ds_read_b128 a[200:203], v200 offset:18432
    v_fma_f32 v178, v162, v162, s27
    v_mfma_f32_16x16x32_bf16 a[100:103], a[216:219], v[120:123], a[100:103]
    ds_read_b128 a[204:207], v200 offset:19456
    v_mul_f32 v178, v178, v162
    v_mfma_f32_16x16x32_bf16 a[100:103], a[212:215], v[116:119], a[100:103]
    s_waitcnt lgkmcnt(4)
    v_exp_f32 v178, v178
    v_mfma_f32_16x16x32_bf16 a[100:103], a[208:211], v[112:115], a[100:103]
    ds_read_b128 a[208:211], v200 offset:8192
    v_fma_f32 v178, v178, s28, s28
    v_mfma_f32_16x16x32_bf16 v[168:171], a[224:227], v[16:19], v[168:171]
    s_add_u32 s26, s26, 24576
    v_rcp_f32 v178, v178
    v_mfma_f32_16x16x32_bf16 v[168:171], a[228:231], v[20:23], v[168:171]
    buffer_load_dwordx4 v203, s[8:11], s25 offen offset:1024 lds
    v_mul_f32 v178, v178, v162
    v_mfma_f32_16x16x32_bf16 v[168:171], a[232:235], v[24:27], v[168:171]
    ds_read_b128 a[212:215], v200 offset:9216
    v_fma_f32 v179, v163, v163, s27
    v_mfma_f32_16x16x32_bf16 v[168:171], a[236:239], v[28:31], v[168:171]
    ds_read_b128 a[216:219], v200 offset:10240
    v_mul_f32 v179, v179, v163
    v_mfma_f32_16x16x32_bf16 v[172:175], a[236:239], v[76:79], v[172:175]
    v_exp_f32 v179, v179
    v_mfma_f32_16x16x32_bf16 v[172:175], a[232:235], v[72:75], v[172:175]
    ds_read_b128 a[220:223], v200 offset:11264
    v_fma_f32 v179, v179, s28, s28
    v_mfma_f32_16x16x32_bf16 v[172:175], a[228:231], v[68:71], v[172:175]
    s_waitcnt lgkmcnt(4)
    v_rcp_f32 v179, v179
    v_mfma_f32_16x16x32_bf16 v[172:175], a[224:227], v[64:67], v[172:175]
    buffer_load_dwordx4 v203, s[8:11], s25 offen offset:2048 lds
    v_mul_f32 v179, v179, v163
    v_cvt_pk_bf16_f32 v137, v178, v179
    v_mfma_f32_16x16x32_bf16 a[104:107], a[192:195], v[96:99], a[104:107]
    ds_read_b128 a[224:227], v200 offset:20480
    v_fma_f32 v180, v164, v164, s27
    v_mfma_f32_16x16x32_bf16 a[104:107], a[196:199], v[100:103], a[104:107]
    ds_read_b128 a[228:231], v200 offset:21504
    v_mul_f32 v180, v180, v164
    v_mfma_f32_16x16x32_bf16 a[104:107], a[200:203], v[104:107], a[104:107]
    s_add_u32 m0, s24, 86016
    v_exp_f32 v180, v180
    v_mfma_f32_16x16x32_bf16 a[104:107], a[204:207], v[108:111], a[104:107]
    ds_read_b128 a[232:235], v200 offset:22528
    v_fma_f32 v180, v180, s28, s28
    v_mfma_f32_16x16x32_bf16 a[108:111], a[204:207], v[124:127], a[108:111]
    s_waitcnt lgkmcnt(3)
    v_rcp_f32 v180, v180
    v_mfma_f32_16x16x32_bf16 a[108:111], a[200:203], v[120:123], a[108:111]
    buffer_load_dwordx4 v203, s[8:11], s26 offen offset:0 lds
    v_mul_f32 v180, v180, v164
    v_mfma_f32_16x16x32_bf16 a[108:111], a[196:199], v[116:119], a[108:111]
    ds_read_b128 a[236:239], v200 offset:23552
    v_fma_f32 v181, v165, v165, s27
    v_mfma_f32_16x16x32_bf16 a[108:111], a[192:195], v[112:115], a[108:111]
    ds_read_b128 a[192:195], v200 offset:24576
    v_mul_f32 v181, v181, v165
    v_mfma_f32_16x16x32_bf16 v[168:171], a[208:211], v[32:35], v[168:171]
    v_exp_f32 v181, v181
    v_mfma_f32_16x16x32_bf16 v[168:171], a[212:215], v[36:39], v[168:171]
    ds_read_b128 a[196:199], v200 offset:25600
    v_fma_f32 v181, v181, s28, s28
    v_mfma_f32_16x16x32_bf16 v[168:171], a[216:219], v[40:43], v[168:171]
    v_rcp_f32 v181, v181
    v_mfma_f32_16x16x32_bf16 v[168:171], a[220:223], v[44:47], v[168:171]
    buffer_load_dwordx4 v203, s[8:11], s26 offen offset:1024 lds
    v_mul_f32 v181, v181, v165
    v_cvt_pk_bf16_f32 v152, v180, v181
    v_mfma_f32_16x16x32_bf16 v[172:175], a[220:223], v[92:95], v[172:175]
    ds_read_b128 a[200:203], v200 offset:26624
    v_fma_f32 v182, v166, v166, s27
    v_mfma_f32_16x16x32_bf16 v[172:175], a[216:219], v[88:91], v[172:175]
    ds_read_b128 a[204:207], v200 offset:27648
    v_mul_f32 v182, v182, v166
    v_mfma_f32_16x16x32_bf16 v[172:175], a[212:215], v[84:87], v[172:175]
    s_waitcnt lgkmcnt(4)
    v_exp_f32 v182, v182
    v_mfma_f32_16x16x32_bf16 v[172:175], a[208:211], v[80:83], v[172:175]
    ds_read_b128 a[208:211], v200 offset:36864
    v_fma_f32 v182, v182, s28, s28
    v_mfma_f32_16x16x32_bf16 a[112:115], a[224:227], v[96:99], a[112:115]
    v_rcp_f32 v182, v182
    v_mfma_f32_16x16x32_bf16 a[112:115], a[228:231], v[100:103], a[112:115]
    buffer_load_dwordx4 v203, s[8:11], s26 offen offset:2048 lds
    v_mul_f32 v182, v182, v166
    v_mfma_f32_16x16x32_bf16 a[112:115], a[232:235], v[104:107], a[112:115]
    ds_read_b128 a[212:215], v200 offset:37888
    v_fma_f32 v183, v167, v167, s27
    v_mfma_f32_16x16x32_bf16 a[112:115], a[236:239], v[108:111], a[112:115]
    ds_read_b128 a[216:219], v200 offset:38912
    v_mul_f32 v183, v183, v167
    v_mfma_f32_16x16x32_bf16 a[116:119], a[236:239], v[124:127], a[116:119]
    s_waitcnt vmcnt(6)
    v_exp_f32 v183, v183
    v_mfma_f32_16x16x32_bf16 a[116:119], a[232:235], v[120:123], a[116:119]
    ds_read_b128 a[220:223], v200 offset:39936
    v_fma_f32 v183, v183, s28, s28
    v_mfma_f32_16x16x32_bf16 a[116:119], a[228:231], v[116:119], a[116:119]
    s_waitcnt lgkmcnt(4)
    v_rcp_f32 v183, v183
    v_mfma_f32_16x16x32_bf16 a[116:119], a[224:227], v[112:115], a[116:119]
    s_nop 0
    v_mul_f32 v183, v183, v167
    v_cvt_pk_bf16_f32 v153, v182, v183
    v_mfma_f32_16x16x32_bf16 v[160:163], a[192:195], v[0:3], 0
    ds_read_b128 a[224:227], v200 offset:28672
    v_fma_f32 v176, v168, v168, s27
    v_mfma_f32_16x16x32_bf16 v[160:163], a[196:199], v[4:7], v[160:163]
    ds_read_b128 a[228:231], v200 offset:29696
    v_mul_f32 v176, v176, v168
    v_mfma_f32_16x16x32_bf16 v[160:163], a[200:203], v[8:11], v[160:163]
    s_barrier
    v_exp_f32 v176, v176
    v_mfma_f32_16x16x32_bf16 v[160:163], a[204:207], v[12:15], v[160:163]
    ds_read_b128 a[232:235], v200 offset:30720
    v_fma_f32 v176, v176, s28, s28
    v_mfma_f32_16x16x32_bf16 v[164:167], a[204:207], v[60:63], 0
    s_waitcnt lgkmcnt(3)
    v_rcp_f32 v176, v176
    v_mfma_f32_16x16x32_bf16 v[164:167], a[200:203], v[56:59], v[164:167]
    s_add_u32 m0, s24, 0
    v_mul_f32 v176, v176, v168
    v_mfma_f32_16x16x32_bf16 v[164:167], a[196:199], v[52:55], v[164:167]
    ds_read_b128 a[236:239], v200 offset:31744
    v_fma_f32 v177, v169, v169, s27
    v_mfma_f32_16x16x32_bf16 v[164:167], a[192:195], v[48:51], v[164:167]
    ds_read_b128 a[192:195], v200 offset:40960
    v_mul_f32 v177, v177, v169
    v_mfma_f32_16x16x32_bf16 a[120:123], a[208:211], v[96:99], a[120:123]
    s_add_u32 s25, s25, 24576
    v_exp_f32 v177, v177
    v_mfma_f32_16x16x32_bf16 a[120:123], a[212:215], v[100:103], a[120:123]
    ds_read_b128 a[196:199], v200 offset:41984
    v_fma_f32 v177, v177, s28, s28
    v_mfma_f32_16x16x32_bf16 a[120:123], a[216:219], v[104:107], a[120:123]
    v_rcp_f32 v177, v177
    v_mfma_f32_16x16x32_bf16 a[120:123], a[220:223], v[108:111], a[120:123]
    buffer_load_dwordx4 v203, s[8:11], s25 offen offset:0 lds
    v_mul_f32 v177, v177, v169
    v_cvt_pk_bf16_f32 v138, v176, v177
    v_mfma_f32_16x16x32_bf16 a[124:127], a[220:223], v[124:127], a[124:127]
    ds_read_b128 a[200:203], v200 offset:43008
    v_fma_f32 v178, v170, v170, s27
    v_mfma_f32_16x16x32_bf16 a[124:127], a[216:219], v[120:123], a[124:127]
    ds_read_b128 a[204:207], v200 offset:44032
    v_mul_f32 v178, v178, v170
    v_mfma_f32_16x16x32_bf16 a[124:127], a[212:215], v[116:119], a[124:127]
    s_waitcnt lgkmcnt(4)
    v_exp_f32 v178, v178
    v_mfma_f32_16x16x32_bf16 a[124:127], a[208:211], v[112:115], a[124:127]
    ds_read_b128 a[208:211], v200 offset:32768
    v_fma_f32 v178, v178, s28, s28
    v_mfma_f32_16x16x32_bf16 v[160:163], a[224:227], v[16:19], v[160:163]
    s_add_u32 s26, s26, 24576
    v_rcp_f32 v178, v178
    v_mfma_f32_16x16x32_bf16 v[160:163], a[228:231], v[20:23], v[160:163]
    buffer_load_dwordx4 v203, s[8:11], s25 offen offset:1024 lds
    v_mul_f32 v178, v178, v170
    v_mfma_f32_16x16x32_bf16 v[160:163], a[232:235], v[24:27], v[160:163]
    ds_read_b128 a[212:215], v200 offset:33792
    v_fma_f32 v179, v171, v171, s27
    v_mfma_f32_16x16x32_bf16 v[160:163], a[236:239], v[28:31], v[160:163]
    ds_read_b128 a[216:219], v200 offset:34816
    v_mul_f32 v179, v179, v171
    v_mfma_f32_16x16x32_bf16 v[164:167], a[236:239], v[76:79], v[164:167]
    v_exp_f32 v179, v179
    v_mfma_f32_16x16x32_bf16 v[164:167], a[232:235], v[72:75], v[164:167]
    ds_read_b128 a[220:223], v200 offset:35840
    v_fma_f32 v179, v179, s28, s28
    v_mfma_f32_16x16x32_bf16 v[164:167], a[228:231], v[68:71], v[164:167]
    s_waitcnt lgkmcnt(4)
    v_rcp_f32 v179, v179
    v_mfma_f32_16x16x32_bf16 v[164:167], a[224:227], v[64:67], v[164:167]
    buffer_load_dwordx4 v203, s[8:11], s25 offen offset:2048 lds
    v_mul_f32 v179, v179, v171
    v_cvt_pk_bf16_f32 v139, v178, v179
    v_mfma_f32_16x16x32_bf16 a[128:131], a[192:195], v[96:99], a[128:131]
    ds_read_b128 a[224:227], v200 offset:45056
    v_fma_f32 v180, v172, v172, s27
    v_mfma_f32_16x16x32_bf16 a[128:131], a[196:199], v[100:103], a[128:131]
    ds_read_b128 a[228:231], v200 offset:46080
    v_mul_f32 v180, v180, v172
    v_mfma_f32_16x16x32_bf16 a[128:131], a[200:203], v[104:107], a[128:131]
    s_add_u32 m0, s24, 12288
    v_exp_f32 v180, v180
    v_mfma_f32_16x16x32_bf16 a[128:131], a[204:207], v[108:111], a[128:131]
    ds_read_b128 a[232:235], v200 offset:47104
    v_fma_f32 v180, v180, s28, s28
    v_mfma_f32_16x16x32_bf16 a[132:135], a[204:207], v[124:127], a[132:135]
    s_waitcnt lgkmcnt(3)
    v_rcp_f32 v180, v180
    v_mfma_f32_16x16x32_bf16 a[132:135], a[200:203], v[120:123], a[132:135]
    buffer_load_dwordx4 v203, s[8:11], s26 offen offset:0 lds
    v_mul_f32 v180, v180, v172
    v_mfma_f32_16x16x32_bf16 a[132:135], a[196:199], v[116:119], a[132:135]
    ds_read_b128 a[236:239], v200 offset:48128
    v_fma_f32 v181, v173, v173, s27
    v_mfma_f32_16x16x32_bf16 a[132:135], a[192:195], v[112:115], a[132:135]
    ds_read_b128 a[192:195], v201 offset:0
    v_mul_f32 v181, v181, v173
    v_mfma_f32_16x16x32_bf16 v[160:163], a[208:211], v[32:35], v[160:163]
    s_sub_u32 s29, s29, 1
    v_exp_f32 v181, v181
    v_mfma_f32_16x16x32_bf16 v[160:163], a[212:215], v[36:39], v[160:163]
    ds_read_b128 a[196:199], v201 offset:1024
    v_fma_f32 v181, v181, s28, s28
    v_mfma_f32_16x16x32_bf16 v[160:163], a[216:219], v[40:43], v[160:163]
    v_rcp_f32 v181, v181
    v_mfma_f32_16x16x32_bf16 v[160:163], a[220:223], v[44:47], v[160:163]
    buffer_load_dwordx4 v203, s[8:11], s26 offen offset:1024 lds
    v_mul_f32 v181, v181, v173
    v_cvt_pk_bf16_f32 v154, v180, v181
    v_mfma_f32_16x16x32_bf16 v[164:167], a[220:223], v[92:95], v[164:167]
    ds_read_b128 a[200:203], v201 offset:2048
    v_fma_f32 v182, v174, v174, s27
    v_mfma_f32_16x16x32_bf16 v[164:167], a[216:219], v[88:91], v[164:167]
    ds_read_b128 a[204:207], v201 offset:3072
    v_mul_f32 v182, v182, v174
    v_mfma_f32_16x16x32_bf16 v[164:167], a[212:215], v[84:87], v[164:167]
    s_waitcnt lgkmcnt(4)
    v_exp_f32 v182, v182
    v_mfma_f32_16x16x32_bf16 v[164:167], a[208:211], v[80:83], v[164:167]
    ds_read_b128 a[208:211], v201 offset:12288
    v_fma_f32 v182, v182, s28, s28
    v_mfma_f32_16x16x32_bf16 a[136:139], a[224:227], v[96:99], a[136:139]
    v_rcp_f32 v182, v182
    v_mfma_f32_16x16x32_bf16 a[136:139], a[228:231], v[100:103], a[136:139]
    buffer_load_dwordx4 v203, s[8:11], s26 offen offset:2048 lds
    v_mul_f32 v182, v182, v174
    v_mfma_f32_16x16x32_bf16 a[136:139], a[232:235], v[104:107], a[136:139]
    ds_read_b128 a[212:215], v201 offset:13312
    v_fma_f32 v183, v175, v175, s27
    v_mfma_f32_16x16x32_bf16 a[136:139], a[236:239], v[108:111], a[136:139]
    ds_read_b128 a[216:219], v201 offset:14336
    v_mul_f32 v183, v183, v175
    v_mfma_f32_16x16x32_bf16 a[140:143], a[236:239], v[124:127], a[140:143]
    s_waitcnt vmcnt(6)
    v_exp_f32 v183, v183
    v_mfma_f32_16x16x32_bf16 a[140:143], a[232:235], v[120:123], a[140:143]
    ds_read_b128 a[220:223], v201 offset:15360
    v_fma_f32 v183, v183, s28, s28
    v_mfma_f32_16x16x32_bf16 a[140:143], a[228:231], v[116:119], a[140:143]
    s_waitcnt lgkmcnt(4)
    v_rcp_f32 v183, v183
    v_mfma_f32_16x16x32_bf16 a[140:143], a[224:227], v[112:115], a[140:143]
    s_cmp_lg_u32 s29, 0
    v_mul_f32 v183, v183, v175
    v_cvt_pk_bf16_f32 v155, v182, v183
    s_cbranch_scc1 L_loop
    v_mfma_f32_16x16x32_bf16 v[168:171], a[192:195], v[0:3], 0
    ds_read_b128 a[224:227], v201 offset:4096
    v_fma_f32 v176, v160, v160, s27
    v_mfma_f32_16x16x32_bf16 v[168:171], a[196:199], v[4:7], v[168:171]
    ds_read_b128 a[228:231], v201 offset:5120
    v_mul_f32 v176, v176, v160
    v_mfma_f32_16x16x32_bf16 v[168:171], a[200:203], v[8:11], v[168:171]
    s_barrier
    v_exp_f32 v176, v176
    v_mfma_f32_16x16x32_bf16 v[168:171], a[204:207], v[12:15], v[168:171]
    ds_read_b128 a[232:235], v201 offset:6144
    v_fma_f32 v176, v176, s28, s28
    v_mfma_f32_16x16x32_bf16 v[172:175], a[204:207], v[60:63], 0
    s_waitcnt lgkmcnt(3)
    v_rcp_f32 v176, v176
    v_mfma_f32_16x16x32_bf16 v[172:175], a[200:203], v[56:59], v[172:175]
    s_add_u32 m0, s24, 36864
    v_mul_f32 v176, v176, v160
    v_mfma_f32_16x16x32_bf16 v[172:175], a[196:199], v[52:55], v[172:175]
    ds_read_b128 a[236:239], v201 offset:7168
    v_fma_f32 v177, v161, v161, s27
    v_mfma_f32_16x16x32_bf16 v[172:175], a[192:195], v[48:51], v[172:175]
    ds_read_b128 a[192:195], v201 offset:16384
    v_mul_f32 v177, v177, v161
    v_mfma_f32_16x16x32_bf16 a[144:147], a[208:211], v[96:99], a[144:147]
    s_mov_b32 s26, 2420736
    v_exp_f32 v177, v177
    v_mfma_f32_16x16x32_bf16 a[144:147], a[212:215], v[100:103], a[144:147]
    ds_read_b128 a[196:199], v201 offset:17408
    v_fma_f32 v177, v177, s28, s28
    v_mfma_f32_16x16x32_bf16 a[144:147], a[216:219], v[104:107], a[144:147]
    v_rcp_f32 v177, v177
    v_mfma_f32_16x16x32_bf16 a[144:147], a[220:223], v[108:111], a[144:147]
    s_nop 0
    v_mul_f32 v177, v177, v161
    v_cvt_pk_bf16_f32 v140, v176, v177
    v_mfma_f32_16x16x32_bf16 a[148:151], a[220:223], v[124:127], a[148:151]
    ds_read_b128 a[200:203], v201 offset:18432
    v_fma_f32 v178, v162, v162, s27
    v_mfma_f32_16x16x32_bf16 a[148:151], a[216:219], v[120:123], a[148:151]
    ds_read_b128 a[204:207], v201 offset:19456
    v_mul_f32 v178, v178, v162
    v_mfma_f32_16x16x32_bf16 a[148:151], a[212:215], v[116:119], a[148:151]
    s_waitcnt lgkmcnt(4)
    v_exp_f32 v178, v178
    v_mfma_f32_16x16x32_bf16 a[148:151], a[208:211], v[112:115], a[148:151]
    ds_read_b128 a[208:211], v201 offset:8192
    v_fma_f32 v178, v178, s28, s28
    v_mfma_f32_16x16x32_bf16 v[168:171], a[224:227], v[16:19], v[168:171]
    v_rcp_f32 v178, v178
    v_mfma_f32_16x16x32_bf16 v[168:171], a[228:231], v[20:23], v[168:171]
    buffer_load_dwordx4 v203, s[8:11], s26 offen offset:0 lds
    v_mul_f32 v178, v178, v162
    v_mfma_f32_16x16x32_bf16 v[168:171], a[232:235], v[24:27], v[168:171]
    ds_read_b128 a[212:215], v201 offset:9216
    v_fma_f32 v179, v163, v163, s27
    v_mfma_f32_16x16x32_bf16 v[168:171], a[236:239], v[28:31], v[168:171]
    ds_read_b128 a[216:219], v201 offset:10240
    v_mul_f32 v179, v179, v163
    v_mfma_f32_16x16x32_bf16 v[172:175], a[236:239], v[76:79], v[172:175]
    v_exp_f32 v179, v179
    v_mfma_f32_16x16x32_bf16 v[172:175], a[232:235], v[72:75], v[172:175]
    ds_read_b128 a[220:223], v201 offset:11264
    v_fma_f32 v179, v179, s28, s28
    v_mfma_f32_16x16x32_bf16 v[172:175], a[228:231], v[68:71], v[172:175]
    s_waitcnt lgkmcnt(4)
    v_rcp_f32 v179, v179
    v_mfma_f32_16x16x32_bf16 v[172:175], a[224:227], v[64:67], v[172:175]
    s_nop 0
    v_mul_f32 v179, v179, v163
    v_cvt_pk_bf16_f32 v141, v178, v179
    v_mfma_f32_16x16x32_bf16 a[152:155], a[192:195], v[96:99], a[152:155]
    ds_read_b128 a[224:227], v201 offset:20480
    v_fma_f32 v180, v164, v164, s27
    v_mfma_f32_16x16x32_bf16 a[152:155], a[196:199], v[100:103], a[152:155]
    ds_read_b128 a[228:231], v201 offset:21504
    v_mul_f32 v180, v180, v164
    v_mfma_f32_16x16x32_bf16 a[152:155], a[200:203], v[104:107], a[152:155]
    v_exp_f32 v180, v180
    v_mfma_f32_16x16x32_bf16 a[152:155], a[204:207], v[108:111], a[152:155]
    ds_read_b128 a[232:235], v201 offset:22528
    v_fma_f32 v180, v180, s28, s28
    v_mfma_f32_16x16x32_bf16 a[156:159], a[204:207], v[124:127], a[156:159]
    s_waitcnt lgkmcnt(3)
    v_rcp_f32 v180, v180
    v_mfma_f32_16x16x32_bf16 a[156:159], a[200:203], v[120:123], a[156:159]
    buffer_load_dwordx4 v203, s[8:11], s26 offen offset:1024 lds
    v_mul_f32 v180, v180, v164
    v_mfma_f32_16x16x32_bf16 a[156:159], a[196:199], v[116:119], a[156:159]
    ds_read_b128 a[236:239], v201 offset:23552
    v_fma_f32 v181, v165, v165, s27
    v_mfma_f32_16x16x32_bf16 a[156:159], a[192:195], v[112:115], a[156:159]
    ds_read_b128 a[192:195], v201 offset:36864
    v_mul_f32 v181, v181, v165
    v_mfma_f32_16x16x32_bf16 v[168:171], a[208:211], v[32:35], v[168:171]
    v_exp_f32 v181, v181
    v_mfma_f32_16x16x32_bf16 v[168:171], a[212:215], v[36:39], v[168:171]
    ds_read_b128 a[196:199], v201 offset:37888
    v_fma_f32 v181, v181, s28, s28
    v_mfma_f32_16x16x32_bf16 v[168:171], a[216:219], v[40:43], v[168:171]
    v_rcp_f32 v181, v181
    v_mfma_f32_16x16x32_bf16 v[168:171], a[220:223], v[44:47], v[168:171]
    s_nop 0
    v_mul_f32 v181, v181, v165
    v_cvt_pk_bf16_f32 v156, v180, v181
    v_mfma_f32_16x16x32_bf16 v[172:175], a[220:223], v[92:95], v[172:175]
    ds_read_b128 a[200:203], v201 offset:38912
    v_fma_f32 v182, v166, v166, s27
    v_mfma_f32_16x16x32_bf16 v[172:175], a[216:219], v[88:91], v[172:175]
    ds_read_b128 a[204:207], v201 offset:39936
    v_mul_f32 v182, v182, v166
    v_mfma_f32_16x16x32_bf16 v[172:175], a[212:215], v[84:87], v[172:175]
    s_waitcnt lgkmcnt(4)
    v_exp_f32 v182, v182
    v_mfma_f32_16x16x32_bf16 v[172:175], a[208:211], v[80:83], v[172:175]
    ds_read_b128 a[208:211], v201 offset:40960
    v_fma_f32 v182, v182, s28, s28
    v_mfma_f32_16x16x32_bf16 a[160:163], a[224:227], v[96:99], a[160:163]
    v_rcp_f32 v182, v182
    v_mfma_f32_16x16x32_bf16 a[160:163], a[228:231], v[100:103], a[160:163]
    buffer_load_dwordx4 v203, s[8:11], s26 offen offset:2048 lds
    v_mul_f32 v182, v182, v166
    v_mfma_f32_16x16x32_bf16 a[160:163], a[232:235], v[104:107], a[160:163]
    ds_read_b128 a[212:215], v201 offset:41984
    v_fma_f32 v183, v167, v167, s27
    v_mfma_f32_16x16x32_bf16 a[160:163], a[236:239], v[108:111], a[160:163]
    ds_read_b128 a[216:219], v201 offset:43008
    v_mul_f32 v183, v183, v167
    v_mfma_f32_16x16x32_bf16 a[164:167], a[236:239], v[124:127], a[164:167]
    s_waitcnt vmcnt(3)
    v_exp_f32 v183, v183
    v_mfma_f32_16x16x32_bf16 a[164:167], a[232:235], v[120:123], a[164:167]
    ds_read_b128 a[220:223], v201 offset:44032
    v_fma_f32 v183, v183, s28, s28
    v_mfma_f32_16x16x32_bf16 a[164:167], a[228:231], v[116:119], a[164:167]
    s_waitcnt lgkmcnt(4)
    v_rcp_f32 v183, v183
    v_mfma_f32_16x16x32_bf16 a[164:167], a[224:227], v[112:115], a[164:167]
    s_nop 0
    v_mul_f32 v183, v183, v167
    v_cvt_pk_bf16_f32 v157, v182, v183
    s_cmp_eq_u32 s21, 1
    s_cbranch_scc1 L_final
    s_barrier
    v_mfma_f32_16x16x32_bf16 a[168:171], a[192:195], v[96:99], a[168:171]
    ds_read_b128 a[224:227], v201 offset:45056
    s_add_u32 m0, s24, 61440
    v_fma_f32 v176, v168, v168, s27
    v_fma_f32 v177, v169, v169, s27
    v_fma_f32 v178, v170, v170, s27
    v_mfma_f32_16x16x32_bf16 a[168:171], a[196:199], v[100:103], a[168:171]
    s_mov_b32 s26, 2445312
    v_fma_f32 v179, v171, v171, s27
    v_fma_f32 v180, v172, v172, s27
    v_fma_f32 v181, v173, v173, s27
    v_mfma_f32_16x16x32_bf16 a[168:171], a[200:203], v[104:107], a[168:171]
    ds_read_b128 a[228:231], v201 offset:46080
    v_fma_f32 v182, v174, v174, s27
    v_fma_f32 v183, v175, v175, s27
    v_mul_f32 v176, v176, v168
    v_mfma_f32_16x16x32_bf16 a[168:171], a[204:207], v[108:111], a[168:171]
    buffer_load_dwordx4 v203, s[8:11], s26 offen offset:0 lds
    v_mul_f32 v177, v177, v169
    v_mul_f32 v178, v178, v170
    v_mul_f32 v179, v179, v171
    v_mfma_f32_16x16x32_bf16 a[172:175], a[204:207], v[124:127], a[172:175]
    ds_read_b128 a[232:235], v201 offset:47104
    v_mul_f32 v180, v180, v172
    v_mul_f32 v181, v181, v173
    v_mul_f32 v182, v182, v174
    v_mfma_f32_16x16x32_bf16 a[172:175], a[200:203], v[120:123], a[172:175]
    buffer_load_dwordx4 v203, s[8:11], s26 offen offset:1024 lds
    v_mul_f32 v183, v183, v175
    v_exp_f32 v176, v176
    v_mfma_f32_16x16x32_bf16 a[172:175], a[196:199], v[116:119], a[172:175]
    ds_read_b128 a[236:239], v201 offset:48128
    v_exp_f32 v177, v177
    v_mfma_f32_16x16x32_bf16 a[172:175], a[192:195], v[112:115], a[172:175]
    buffer_load_dwordx4 v203, s[8:11], s26 offen offset:2048 lds
    v_exp_f32 v178, v178
    s_waitcnt lgkmcnt(4)
    v_mfma_f32_16x16x32_bf16 a[176:179], a[208:211], v[96:99], a[176:179]
    ds_read_b128 a[192:195], v200 offset:12288
    v_exp_f32 v179, v179
    v_mfma_f32_16x16x32_bf16 a[176:179], a[212:215], v[100:103], a[176:179]
    buffer_load_dwordx4 v[4:7], v212, s[4:7], s45 offen
    v_exp_f32 v180, v180
    v_mfma_f32_16x16x32_bf16 a[176:179], a[216:219], v[104:107], a[176:179]
    ds_read_b128 a[196:199], v200 offset:13312
    v_exp_f32 v181, v181
    v_mfma_f32_16x16x32_bf16 a[176:179], a[220:223], v[108:111], a[176:179]
    buffer_load_dwordx4 v[8:11], v213, s[4:7], s45 offen
    v_exp_f32 v182, v182
    v_exp_f32 v183, v183
    v_mfma_f32_16x16x32_bf16 a[180:183], a[220:223], v[124:127], a[180:183]
    ds_read_b128 a[200:203], v200 offset:14336
    v_fma_f32 v176, v176, s28, s28
    v_fma_f32 v177, v177, s28, s28
    v_fma_f32 v178, v178, s28, s28
    v_mfma_f32_16x16x32_bf16 a[180:183], a[216:219], v[120:123], a[180:183]
    buffer_load_dwordx4 v[12:15], v214, s[4:7], s45 offen
    v_fma_f32 v179, v179, s28, s28
    v_fma_f32 v180, v180, s28, s28
    v_fma_f32 v181, v181, s28, s28
    v_mfma_f32_16x16x32_bf16 a[180:183], a[212:215], v[116:119], a[180:183]
    ds_read_b128 a[204:207], v200 offset:15360
    v_fma_f32 v182, v182, s28, s28
    v_fma_f32 v183, v183, s28, s28
    v_mfma_f32_16x16x32_bf16 a[180:183], a[208:211], v[112:115], a[180:183]
    buffer_load_dwordx4 v[16:19], v215, s[4:7], s45 offen
    v_rcp_f32 v176, v176
    v_rcp_f32 v177, v177
    s_waitcnt lgkmcnt(4)
    v_mfma_f32_16x16x32_bf16 a[184:187], a[224:227], v[96:99], a[184:187]
    ds_read_b128 a[208:211], v200 offset:16384
    v_rcp_f32 v178, v178
    v_mfma_f32_16x16x32_bf16 a[184:187], a[228:231], v[100:103], a[184:187]
    buffer_load_dwordx4 v[20:23], v216, s[4:7], s45 offen
    v_rcp_f32 v179, v179
    v_rcp_f32 v180, v180
    v_mfma_f32_16x16x32_bf16 a[184:187], a[232:235], v[104:107], a[184:187]
    ds_read_b128 a[212:215], v200 offset:17408
    v_rcp_f32 v181, v181
    v_mfma_f32_16x16x32_bf16 a[184:187], a[236:239], v[108:111], a[184:187]
    buffer_load_dwordx4 v[24:27], v217, s[4:7], s45 offen
    v_rcp_f32 v182, v182
    v_rcp_f32 v183, v183
    v_mfma_f32_16x16x32_bf16 a[188:191], a[236:239], v[124:127], a[188:191]
    ds_read_b128 a[216:219], v200 offset:18432
    v_mul_f32 v176, v176, v168
    v_mul_f32 v177, v177, v169
    v_mul_f32 v178, v178, v170
    v_mfma_f32_16x16x32_bf16 a[188:191], a[232:235], v[120:123], a[188:191]
    buffer_load_dwordx4 v[28:31], v218, s[4:7], s45 offen
    v_mul_f32 v179, v179, v171
    v_mul_f32 v180, v180, v172
    v_mul_f32 v181, v181, v173
    v_mfma_f32_16x16x32_bf16 a[188:191], a[228:231], v[116:119], a[188:191]
    ds_read_b128 a[220:223], v200 offset:19456
    v_mul_f32 v182, v182, v174
    v_mul_f32 v183, v183, v175
    v_cvt_pk_bf16_f32 v142, v176, v177
    v_mfma_f32_16x16x32_bf16 a[188:191], a[224:227], v[112:115], a[188:191]
    buffer_load_dwordx4 v[32:35], v219, s[4:7], s45 offen
    v_cvt_pk_bf16_f32 v143, v178, v179
    v_cvt_pk_bf16_f32 v158, v180, v181
    v_cvt_pk_bf16_f32 v159, v182, v183
    s_waitcnt vmcnt(11)
    s_barrier
    s_waitcnt lgkmcnt(4)
    v_mfma_f32_16x16x32_bf16 a[0:3], a[192:195], v[128:131], a[0:3]
    ds_read_b128 a[224:227], v200 offset:20480
    s_add_u32 m0, s24, 86016
    v_and_b32 v179, 15, v252
    v_mfma_f32_16x16x32_bf16 a[0:3], a[196:199], v[132:135], a[0:3]
    s_mov_b32 s26, 2469888
    v_lshrrev_b32 v180, 4, v252
    v_mfma_f32_16x16x32_bf16 a[0:3], a[200:203], v[136:139], a[0:3]
    ds_read_b128 a[228:231], v200 offset:21504
    buffer_load_dwordx4 v203, s[8:11], s26 offen offset:0 lds
    v_lshrrev_b32 v181, 1, v179
    v_mfma_f32_16x16x32_bf16 a[0:3], a[204:207], v[140:143], a[0:3]
    buffer_load_dwordx4 v203, s[8:11], s26 offen offset:1024 lds
    v_add_u32 v180, v180, v181
    v_mfma_f32_16x16x32_bf16 a[4:7], a[204:207], v[156:159], a[4:7]
    ds_read_b128 a[232:235], v200 offset:22528
    buffer_load_dwordx4 v203, s[8:11], s26 offen offset:2048 lds
    v_and_b32 v180, 3, v180
    v_mfma_f32_16x16x32_bf16 a[4:7], a[200:203], v[152:155], a[4:7]
    s_add_u32 m0, s24, 49152
    v_lshlrev_b32 v180, 4, v180
    v_mfma_f32_16x16x32_bf16 a[4:7], a[196:199], v[148:151], a[4:7]
    ds_read_b128 a[236:239], v200 offset:23552
    v_lshl_add_u32 v180, v179, 6, v180
    v_mfma_f32_16x16x32_bf16 a[4:7], a[192:195], v[144:147], a[4:7]
    s_mov_b32 s26, 2543616
    s_lshl_b32 s49, s20, 10
    s_waitcnt lgkmcnt(4)
    v_mfma_f32_16x16x32_bf16 a[8:11], a[208:211], v[128:131], a[8:11]
    ds_read_b128 a[192:195], v200 offset:36864
    buffer_load_dwordx4 v203, s[8:11], s26 offen offset:0 lds
    s_add_u32 s49, s49, 159744
    v_mfma_f32_16x16x32_bf16 a[8:11], a[212:215], v[132:135], a[8:11]
    buffer_load_dwordx4 v203, s[8:11], s26 offen offset:1024 lds
    v_add_u32 v124, s49, v180
    v_mfma_f32_16x16x32_bf16 a[8:11], a[216:219], v[136:139], a[8:11]
    ds_read_b128 a[196:199], v200 offset:37888
    buffer_load_dwordx4 v203, s[8:11], s26 offen offset:2048 lds
    v_lshrrev_b32 v179, 2, v252
    v_mfma_f32_16x16x32_bf16 a[8:11], a[220:223], v[140:143], a[8:11]
    buffer_load_dwordx4 v[36:39], v220, s[4:7], s45 offen
    v_and_b32 v180, 3, v252
    v_mfma_f32_16x16x32_bf16 a[12:15], a[220:223], v[156:159], a[12:15]
    ds_read_b128 a[200:203], v200 offset:38912
    buffer_load_dwordx4 v[40:43], v221, s[4:7], s45 offen
    v_lshrrev_b32 v181, 3, v179
    v_mfma_f32_16x16x32_bf16 a[12:15], a[216:219], v[152:155], a[12:15]
    buffer_load_dwordx4 v[44:47], v222, s[4:7], s45 offen
    v_lshlrev_b32 v181, 1, v181
    v_mfma_f32_16x16x32_bf16 a[12:15], a[212:215], v[148:151], a[12:15]
    ds_read_b128 a[204:207], v200 offset:39936
    v_xor_b32 v180, v180, v181
    v_mfma_f32_16x16x32_bf16 a[12:15], a[208:211], v[144:147], a[12:15]
    buffer_load_dwordx4 v[48:51], v223, s[4:7], s45 offen
    v_lshrrev_b32 v181, 1, v179
    s_waitcnt lgkmcnt(4)
    v_mfma_f32_16x16x32_bf16 a[16:19], a[224:227], v[128:131], a[16:19]
    ds_read_b128 a[208:211], v200 offset:40960
    buffer_load_dwordx4 v[52:55], v224, s[4:7], s45 offen
    v_add_u32 v180, v180, v181
    v_mfma_f32_16x16x32_bf16 a[16:19], a[228:231], v[132:135], a[16:19]
    buffer_load_dwordx4 v[56:59], v225, s[4:7], s45 offen
    v_and_b32 v180, 3, v180
    v_mfma_f32_16x16x32_bf16 a[16:19], a[232:235], v[136:139], a[16:19]
    ds_read_b128 a[212:215], v200 offset:41984
    buffer_load_dwordx4 v[60:63], v226, s[4:7], s45 offen
    v_lshlrev_b32 v180, 4, v180
    v_mfma_f32_16x16x32_bf16 a[16:19], a[236:239], v[140:143], a[16:19]
    buffer_load_dwordx4 v[64:67], v212, s[4:7], s44 offen
    v_lshl_add_u32 v180, v179, 6, v180
    v_mfma_f32_16x16x32_bf16 a[20:23], a[236:239], v[156:159], a[20:23]
    ds_read_b128 a[216:219], v200 offset:43008
    v_add_u32 v125, s49, v180
    v_mfma_f32_16x16x32_bf16 a[20:23], a[232:235], v[152:155], a[20:23]
    buffer_load_dwordx4 v[68:71], v213, s[4:7], s44 offen
    v_mfma_f32_16x16x32_bf16 a[20:23], a[228:231], v[148:151], a[20:23]
    ds_read_b128 a[220:223], v200 offset:44032
    v_mfma_f32_16x16x32_bf16 a[20:23], a[224:227], v[144:147], a[20:23]
    buffer_load_dwordx4 v[72:75], v214, s[4:7], s44 offen
    s_waitcnt vmcnt(24)
    s_barrier
    s_waitcnt lgkmcnt(4)
    v_mfma_f32_16x16x32_bf16 a[24:27], a[192:195], v[128:131], a[24:27]
    ds_read_b128 a[224:227], v200 offset:45056
    s_add_u32 m0, s24, 12288
    v_add_u32 v176, 0, v252
    v_mul_u32_u24 v177, 171, v176
    v_lshrrev_b32 v177, 11, v177
    v_mul_u32_u24 v178, 12, v177
    v_mfma_f32_16x16x32_bf16 a[24:27], a[196:199], v[132:135], a[24:27]
    s_mov_b32 s26, 2494464
    v_sub_u32 v178, v176, v178
    v_mul_u32_u24 v177, 0x300, v177
    v_lshrrev_b32 v176, 2, v178
    v_lshlrev_b32 v176, 8, v176
    v_mfma_f32_16x16x32_bf16 a[24:27], a[200:203], v[136:139], a[24:27]
    ds_read_b128 a[228:231], v200 offset:46080
    buffer_load_dwordx4 v203, s[8:11], s26 offen offset:0 lds
    v_and_b32 v178, 3, v178
    v_lshl_add_u32 v176, v178, 4, v176
    v_add3_u32 v0, v176, v177, s34
    v_add_u32 v176, 64, v252
    v_mfma_f32_16x16x32_bf16 a[24:27], a[204:207], v[140:143], a[24:27]
    buffer_load_dwordx4 v203, s[8:11], s26 offen offset:1024 lds
    v_mul_u32_u24 v177, 171, v176
    v_lshrrev_b32 v177, 11, v177
    v_mul_u32_u24 v178, 12, v177
    v_sub_u32 v178, v176, v178
    v_mfma_f32_16x16x32_bf16 a[28:31], a[204:207], v[156:159], a[28:31]
    ds_read_b128 a[232:235], v200 offset:47104
    v_mul_u32_u24 v177, 0x300, v177
    v_lshrrev_b32 v176, 2, v178
    v_lshlrev_b32 v176, 8, v176
    v_and_b32 v178, 3, v178
    v_mfma_f32_16x16x32_bf16 a[28:31], a[200:203], v[152:155], a[28:31]
    buffer_load_dwordx4 v203, s[8:11], s26 offen offset:2048 lds
    v_lshl_add_u32 v176, v178, 4, v176
    v_add3_u32 v1, v176, v177, s34
    v_add_u32 v176, 128, v252
    v_mul_u32_u24 v177, 171, v176
    v_mfma_f32_16x16x32_bf16 a[28:31], a[196:199], v[148:151], a[28:31]
    ds_read_b128 a[236:239], v200 offset:48128
    v_lshrrev_b32 v177, 11, v177
    v_mul_u32_u24 v178, 12, v177
    v_sub_u32 v178, v176, v178
    v_mul_u32_u24 v177, 0x300, v177
    v_mfma_f32_16x16x32_bf16 a[28:31], a[192:195], v[144:147], a[28:31]
    s_add_u32 m0, s24, 73728
    v_lshrrev_b32 v176, 2, v178
    v_lshlrev_b32 v176, 8, v176
    v_and_b32 v178, 3, v178
    v_lshl_add_u32 v176, v178, 4, v176
    s_waitcnt lgkmcnt(4)
    v_mfma_f32_16x16x32_bf16 a[32:35], a[208:211], v[128:131], a[32:35]
    ds_read_b128 a[192:195], v201 offset:12288
    s_mov_b32 s26, 2568192
    v_add3_u32 v2, v176, v177, s34
    v_add_u32 v176, 192, v252
    v_mul_u32_u24 v177, 171, v176
    v_lshrrev_b32 v177, 11, v177
    v_mfma_f32_16x16x32_bf16 a[32:35], a[212:215], v[132:135], a[32:35]
    buffer_load_dwordx4 v203, s[8:11], s26 offen offset:0 lds
    v_mul_u32_u24 v178, 12, v177
    v_sub_u32 v178, v176, v178
    v_mul_u32_u24 v177, 0x300, v177
    v_lshrrev_b32 v176, 2, v178
    v_mfma_f32_16x16x32_bf16 a[32:35], a[216:219], v[136:139], a[32:35]
    ds_read_b128 a[196:199], v201 offset:13312
    buffer_load_dwordx4 v203, s[8:11], s26 offen offset:1024 lds
    v_lshlrev_b32 v176, 8, v176
    v_and_b32 v178, 3, v178
    v_lshl_add_u32 v176, v178, 4, v176
    v_add3_u32 v3, v176, v177, s34
    v_mfma_f32_16x16x32_bf16 a[32:35], a[220:223], v[140:143], a[32:35]
    buffer_load_dwordx4 v203, s[8:11], s26 offen offset:2048 lds
    v_add_u32 v176, 256, v252
    v_mul_u32_u24 v177, 171, v176
    v_lshrrev_b32 v177, 11, v177
    v_mul_u32_u24 v178, 12, v177
    v_mfma_f32_16x16x32_bf16 a[36:39], a[220:223], v[156:159], a[36:39]
    ds_read_b128 a[200:203], v201 offset:14336
    v_sub_u32 v178, v176, v178
    v_mul_u32_u24 v177, 0x300, v177
    v_lshrrev_b32 v176, 2, v178
    v_lshlrev_b32 v176, 8, v176
    v_mfma_f32_16x16x32_bf16 a[36:39], a[216:219], v[152:155], a[36:39]
    buffer_load_dwordx4 v[76:79], v215, s[4:7], s44 offen
    v_and_b32 v178, 3, v178
    v_lshl_add_u32 v176, v178, 4, v176
    v_add3_u32 v126, v176, v177, s34
    v_mov_b32 v178, v252
    v_mfma_f32_16x16x32_bf16 a[36:39], a[212:215], v[148:151], a[36:39]
    ds_read_b128 a[204:207], v201 offset:15360
    v_lshrrev_b32 v177, 2, v178
    v_lshlrev_b32 v177, 8, v177
    v_and_b32 v178, 3, v178
    v_lshl_add_u32 v177, v178, 4, v177
    v_mfma_f32_16x16x32_bf16 a[36:39], a[208:211], v[144:147], a[36:39]
    buffer_load_dwordx4 v[80:83], v216, s[4:7], s44 offen
    v_add_u32 v127, s34, v177
    v_cmp_gt_u32 vcc, 12, v252
    v_mov_b32 v176, s38
    s_nop 0
    s_waitcnt lgkmcnt(4)
    v_mfma_f32_16x16x32_bf16 a[40:43], a[224:227], v[128:131], a[40:43]
    ds_read_b128 a[208:211], v201 offset:16384
    buffer_load_dwordx4 v[84:87], v217, s[4:7], s44 offen
    v_cndmask_b32 v127, v176, v127, vcc
    v_accvgpr_read_b32 v184, a0
    v_accvgpr_read_b32 v185, a1
    v_accvgpr_read_b32 v186, a2
    v_mfma_f32_16x16x32_bf16 a[40:43], a[228:231], v[132:135], a[40:43]
    buffer_load_dwordx4 v[88:91], v218, s[4:7], s44 offen
    v_accvgpr_read_b32 v187, a3
    v_accvgpr_read_b32 v188, a8
    v_accvgpr_read_b32 v189, a9
    v_mfma_f32_16x16x32_bf16 a[40:43], a[232:235], v[136:139], a[40:43]
    ds_read_b128 a[212:215], v201 offset:17408
    v_accvgpr_read_b32 v190, a10
    v_accvgpr_read_b32 v191, a11
    v_cvt_pk_bf16_f32 v184, v184, v185
    v_mfma_f32_16x16x32_bf16 a[40:43], a[236:239], v[140:143], a[40:43]
    buffer_load_dwordx4 v[92:95], v219, s[4:7], s44 offen
    v_cvt_pk_bf16_f32 v185, v186, v187
    v_cvt_pk_bf16_f32 v186, v188, v189
    v_cvt_pk_bf16_f32 v187, v190, v191
    v_mfma_f32_16x16x32_bf16 a[44:47], a[236:239], v[156:159], a[44:47]
    ds_read_b128 a[216:219], v201 offset:18432
    ds_write_b128 v124, v[184:187]
    ds_read_b128 v[188:191], v125
    v_accvgpr_read_b32 v192, a4
    v_accvgpr_read_b32 v193, a5
    v_accvgpr_read_b32 v194, a6
    v_mfma_f32_16x16x32_bf16 a[44:47], a[232:235], v[152:155], a[44:47]
    buffer_load_dwordx4 v[96:99], v220, s[4:7], s44 offen
    v_accvgpr_read_b32 v195, a7
    v_accvgpr_read_b32 v196, a12
    v_accvgpr_read_b32 v197, a13
    v_mfma_f32_16x16x32_bf16 a[44:47], a[228:231], v[148:151], a[44:47]
    ds_read_b128 a[220:223], v201 offset:19456
    v_accvgpr_read_b32 v198, a14
    v_accvgpr_read_b32 v199, a15
    s_waitcnt lgkmcnt(1)
    buffer_store_dwordx4 v[188:191], v204, s[12:15], s22 offen offset:0 sc0 sc1
    v_cvt_pk_bf16_f32 v192, v192, v193
    v_mfma_f32_16x16x32_bf16 a[44:47], a[224:227], v[144:147], a[44:47]
    buffer_load_dwordx4 v[100:103], v221, s[4:7], s44 offen
    v_cvt_pk_bf16_f32 v193, v194, v195
    v_cvt_pk_bf16_f32 v194, v196, v197
    v_cvt_pk_bf16_f32 v195, v198, v199
    ds_write_b128 v124, v[192:195]
    ds_read_b128 v[196:199], v125
    s_waitcnt vmcnt(27)
    s_barrier
    v_mfma_f32_16x16x32_bf16 a[48:51], a[192:195], v[128:131], a[48:51]
    ds_read_b128 a[224:227], v201 offset:20480
    v_mfma_f32_16x16x32_bf16 a[48:51], a[196:199], v[132:135], a[48:51]
    s_add_u32 m0, s24, 36864
    v_accvgpr_read_b32 v184, a16
    v_accvgpr_read_b32 v185, a17
    v_accvgpr_read_b32 v186, a18
    v_mfma_f32_16x16x32_bf16 a[48:51], a[200:203], v[136:139], a[48:51]
    ds_read_b128 a[228:231], v201 offset:21504
    v_accvgpr_read_b32 v187, a19
    v_accvgpr_read_b32 v188, a24
    v_accvgpr_read_b32 v189, a25
    v_mfma_f32_16x16x32_bf16 a[48:51], a[204:207], v[140:143], a[48:51]
    s_mov_b32 s26, 2519040
    v_accvgpr_read_b32 v190, a26
    v_accvgpr_read_b32 v191, a27
    v_mfma_f32_16x16x32_bf16 a[52:55], a[204:207], v[156:159], a[52:55]
    ds_read_b128 a[232:235], v201 offset:22528
    s_waitcnt lgkmcnt(3)
    buffer_store_dwordx4 v[196:199], v205, s[12:15], s22 offen offset:0 sc0 sc1
    v_cvt_pk_bf16_f32 v184, v184, v185
    v_cvt_pk_bf16_f32 v185, v186, v187
    v_mfma_f32_16x16x32_bf16 a[52:55], a[200:203], v[152:155], a[52:55]
    buffer_load_dwordx4 v203, s[8:11], s26 offen offset:0 lds
    v_cvt_pk_bf16_f32 v186, v188, v189
    v_cvt_pk_bf16_f32 v187, v190, v191
    v_mfma_f32_16x16x32_bf16 a[52:55], a[196:199], v[148:151], a[52:55]
    ds_read_b128 a[236:239], v201 offset:23552
    ds_write_b128 v124, v[184:187]
    ds_read_b128 v[188:191], v125
    v_accvgpr_read_b32 v192, a20
    v_accvgpr_read_b32 v193, a21
    v_mfma_f32_16x16x32_bf16 a[52:55], a[192:195], v[144:147], a[52:55]
    buffer_load_dwordx4 v203, s[8:11], s26 offen offset:1024 lds
    v_accvgpr_read_b32 v194, a22
    v_accvgpr_read_b32 v195, a23
    v_mfma_f32_16x16x32_bf16 a[56:59], a[208:211], v[128:131], a[56:59]
    ds_read_b128 a[192:195], v201 offset:36864
    v_accvgpr_read_b32 v196, a28
    v_accvgpr_read_b32 v197, a29
    v_mfma_f32_16x16x32_bf16 a[56:59], a[212:215], v[132:135], a[56:59]
    buffer_load_dwordx4 v203, s[8:11], s26 offen offset:2048 lds
    v_accvgpr_read_b32 v198, a30
    v_accvgpr_read_b32 v199, a31
    v_mfma_f32_16x16x32_bf16 a[56:59], a[216:219], v[136:139], a[56:59]
    ds_read_b128 a[196:199], v201 offset:37888
    s_waitcnt lgkmcnt(2)
    buffer_store_dwordx4 v[188:191], v204, s[12:15], s22 offen offset:64 sc0 sc1
    v_cvt_pk_bf16_f32 v192, v192, v193
    v_cvt_pk_bf16_f32 v193, v194, v195
    v_mfma_f32_16x16x32_bf16 a[56:59], a[220:223], v[140:143], a[56:59]
    buffer_load_dwordx4 v[104:107], v222, s[4:7], s44 offen
    v_cvt_pk_bf16_f32 v194, v196, v197
    v_cvt_pk_bf16_f32 v195, v198, v199
    v_mfma_f32_16x16x32_bf16 a[60:63], a[220:223], v[156:159], a[60:63]
    ds_read_b128 a[200:203], v201 offset:38912
    ds_write_b128 v124, v[192:195]
    ds_read_b128 v[196:199], v125
    v_accvgpr_read_b32 v184, a32
    v_accvgpr_read_b32 v185, a33
    v_mfma_f32_16x16x32_bf16 a[60:63], a[216:219], v[152:155], a[60:63]
    buffer_load_dwordx4 v[108:111], v223, s[4:7], s44 offen
    v_accvgpr_read_b32 v186, a34
    v_accvgpr_read_b32 v187, a35
    v_mfma_f32_16x16x32_bf16 a[60:63], a[212:215], v[148:151], a[60:63]
    ds_read_b128 a[204:207], v201 offset:39936
    v_accvgpr_read_b32 v188, a40
    v_accvgpr_read_b32 v189, a41
    v_mfma_f32_16x16x32_bf16 a[60:63], a[208:211], v[144:147], a[60:63]
    s_nop 0
    v_accvgpr_read_b32 v190, a42
    v_accvgpr_read_b32 v191, a43
    v_mfma_f32_16x16x32_bf16 a[64:67], a[224:227], v[128:131], a[64:67]
    ds_read_b128 a[208:211], v201 offset:40960
    s_waitcnt lgkmcnt(2)
    buffer_store_dwordx4 v[196:199], v205, s[12:15], s22 offen offset:64 sc0 sc1
    v_cvt_pk_bf16_f32 v184, v184, v185
    v_cvt_pk_bf16_f32 v185, v186, v187
    v_mfma_f32_16x16x32_bf16 a[64:67], a[228:231], v[132:135], a[64:67]
    buffer_load_dwordx4 v[112:115], v224, s[4:7], s44 offen
    v_cvt_pk_bf16_f32 v186, v188, v189
    v_cvt_pk_bf16_f32 v187, v190, v191
    v_mfma_f32_16x16x32_bf16 a[64:67], a[232:235], v[136:139], a[64:67]
    ds_read_b128 a[212:215], v201 offset:41984
    ds_write_b128 v124, v[184:187]
    ds_read_b128 v[188:191], v125
    v_accvgpr_read_b32 v192, a36
    v_accvgpr_read_b32 v193, a37
    v_mfma_f32_16x16x32_bf16 a[64:67], a[236:239], v[140:143], a[64:67]
    buffer_load_dwordx4 v[116:119], v225, s[4:7], s44 offen
    v_accvgpr_read_b32 v194, a38
    v_accvgpr_read_b32 v195, a39
    v_mfma_f32_16x16x32_bf16 a[68:71], a[236:239], v[156:159], a[68:71]
    ds_read_b128 a[216:219], v201 offset:43008
    v_accvgpr_read_b32 v196, a44
    v_accvgpr_read_b32 v197, a45
    v_mfma_f32_16x16x32_bf16 a[68:71], a[232:235], v[152:155], a[68:71]
    buffer_load_dwordx4 v[120:123], v226, s[4:7], s44 offen
    v_accvgpr_read_b32 v198, a46
    v_accvgpr_read_b32 v199, a47
    v_mfma_f32_16x16x32_bf16 a[68:71], a[228:231], v[148:151], a[68:71]
    ds_read_b128 a[220:223], v201 offset:44032
    s_waitcnt lgkmcnt(2)
    buffer_store_dwordx4 v[188:191], v204, s[12:15], s22 offen offset:128 sc0 sc1
    v_cvt_pk_bf16_f32 v192, v192, v193
    v_cvt_pk_bf16_f32 v193, v194, v195
    v_mfma_f32_16x16x32_bf16 a[68:71], a[224:227], v[144:147], a[68:71]
    s_nop 0
    v_cvt_pk_bf16_f32 v194, v196, v197
    v_cvt_pk_bf16_f32 v195, v198, v199
    ds_write_b128 v124, v[192:195]
    ds_read_b128 v[196:199], v125
    s_waitcnt vmcnt(23)
    s_barrier
    v_mfma_f32_16x16x32_bf16 a[72:75], a[192:195], v[128:131], a[72:75]
    ds_read_b128 a[224:227], v201 offset:45056
    v_mfma_f32_16x16x32_bf16 a[72:75], a[196:199], v[132:135], a[72:75]
    s_nop 0
    v_accvgpr_read_b32 v184, a48
    v_accvgpr_read_b32 v185, a49
    v_mfma_f32_16x16x32_bf16 a[72:75], a[200:203], v[136:139], a[72:75]
    ds_read_b128 a[228:231], v201 offset:46080
    v_accvgpr_read_b32 v186, a50
    v_mfma_f32_16x16x32_bf16 a[72:75], a[204:207], v[140:143], a[72:75]
    v_accvgpr_read_b32 v187, a51
    v_mfma_f32_16x16x32_bf16 a[76:79], a[204:207], v[156:159], a[76:79]
    ds_read_b128 a[232:235], v201 offset:47104
    v_accvgpr_read_b32 v188, a56
    v_mfma_f32_16x16x32_bf16 a[76:79], a[200:203], v[152:155], a[76:79]
    v_accvgpr_read_b32 v189, a57
    v_mfma_f32_16x16x32_bf16 a[76:79], a[196:199], v[148:151], a[76:79]
    ds_read_b128 a[236:239], v201 offset:48128
    v_accvgpr_read_b32 v190, a58
    v_mfma_f32_16x16x32_bf16 a[76:79], a[192:195], v[144:147], a[76:79]
    v_accvgpr_read_b32 v191, a59
    s_waitcnt lgkmcnt(6)
    v_mfma_f32_16x16x32_bf16 a[80:83], a[208:211], v[128:131], a[80:83]
    ds_read_b128 a[192:195], v200 offset:12288
    s_waitcnt lgkmcnt(5)
    buffer_store_dwordx4 v[196:199], v205, s[12:15], s22 offen offset:128 sc0 sc1
    v_cvt_pk_bf16_f32 v184, v184, v185
    v_mfma_f32_16x16x32_bf16 a[80:83], a[212:215], v[132:135], a[80:83]
    v_cvt_pk_bf16_f32 v185, v186, v187
    v_mfma_f32_16x16x32_bf16 a[80:83], a[216:219], v[136:139], a[80:83]
    ds_read_b128 a[196:199], v200 offset:13312
    v_cvt_pk_bf16_f32 v186, v188, v189
    v_mfma_f32_16x16x32_bf16 a[80:83], a[220:223], v[140:143], a[80:83]
    v_cvt_pk_bf16_f32 v187, v190, v191
    v_mfma_f32_16x16x32_bf16 a[84:87], a[220:223], v[156:159], a[84:87]
    ds_read_b128 a[200:203], v200 offset:14336
    ds_write_b128 v124, v[184:187]
    ds_read_b128 v[188:191], v125
    v_accvgpr_read_b32 v192, a52
    v_mfma_f32_16x16x32_bf16 a[84:87], a[216:219], v[152:155], a[84:87]
    v_accvgpr_read_b32 v193, a53
    v_mfma_f32_16x16x32_bf16 a[84:87], a[212:215], v[148:151], a[84:87]
    ds_read_b128 a[204:207], v200 offset:15360
    v_accvgpr_read_b32 v194, a54
    v_mfma_f32_16x16x32_bf16 a[84:87], a[208:211], v[144:147], a[84:87]
    v_accvgpr_read_b32 v195, a55
    s_waitcnt lgkmcnt(6)
    v_mfma_f32_16x16x32_bf16 a[88:91], a[224:227], v[128:131], a[88:91]
    ds_read_b128 a[208:211], v200 offset:16384
    v_accvgpr_read_b32 v196, a60
    v_mfma_f32_16x16x32_bf16 a[88:91], a[228:231], v[132:135], a[88:91]
    v_accvgpr_read_b32 v197, a61
    v_mfma_f32_16x16x32_bf16 a[88:91], a[232:235], v[136:139], a[88:91]
    ds_read_b128 a[212:215], v200 offset:17408
    v_accvgpr_read_b32 v198, a62
    v_mfma_f32_16x16x32_bf16 a[88:91], a[236:239], v[140:143], a[88:91]
    v_accvgpr_read_b32 v199, a63
    v_mfma_f32_16x16x32_bf16 a[92:95], a[236:239], v[156:159], a[92:95]
    ds_read_b128 a[216:219], v200 offset:18432
    s_waitcnt lgkmcnt(4)
    buffer_store_dwordx4 v[188:191], v204, s[12:15], s22 offen offset:192 sc0 sc1
    v_cvt_pk_bf16_f32 v192, v192, v193
    v_mfma_f32_16x16x32_bf16 a[92:95], a[232:235], v[152:155], a[92:95]
    v_cvt_pk_bf16_f32 v193, v194, v195
    v_mfma_f32_16x16x32_bf16 a[92:95], a[228:231], v[148:151], a[92:95]
    ds_read_b128 a[220:223], v200 offset:19456
    v_cvt_pk_bf16_f32 v194, v196, v197
    v_mfma_f32_16x16x32_bf16 a[92:95], a[224:227], v[144:147], a[92:95]
    v_cvt_pk_bf16_f32 v195, v198, v199
    ds_write_b128 v124, v[192:195]
    ds_read_b128 v[196:199], v125
    s_waitcnt vmcnt(10)
    s_barrier
    s_waitcnt lgkmcnt(6)
    v_mfma_f32_16x16x32_bf16 a[96:99], a[192:195], v[128:131], a[96:99]
    ds_read_b128 a[224:227], v200 offset:20480
    s_add_u32 m0, s46, 0
    v_mfma_f32_16x16x32_bf16 a[96:99], a[196:199], v[132:135], a[96:99]
    s_nop 0
    v_accvgpr_read_b32 v184, a64
    v_accvgpr_read_b32 v185, a65
    v_accvgpr_read_b32 v186, a66
    v_mfma_f32_16x16x32_bf16 a[96:99], a[200:203], v[136:139], a[96:99]
    ds_read_b128 a[228:231], v200 offset:21504
    buffer_load_dwordx4 v0, s[16:19], 0 offen lds
    v_accvgpr_read_b32 v187, a67
    v_accvgpr_read_b32 v188, a72
    v_accvgpr_read_b32 v189, a73
    v_mfma_f32_16x16x32_bf16 a[96:99], a[204:207], v[140:143], a[96:99]
    s_add_u32 m0, s46, 1024
    v_accvgpr_read_b32 v190, a74
    v_accvgpr_read_b32 v191, a75
    v_mfma_f32_16x16x32_bf16 a[100:103], a[204:207], v[156:159], a[100:103]
    ds_read_b128 a[232:235], v200 offset:22528
    s_waitcnt lgkmcnt(3)
    buffer_store_dwordx4 v[196:199], v205, s[12:15], s22 offen offset:192 sc0 sc1
    v_cvt_pk_bf16_f32 v184, v184, v185
    v_cvt_pk_bf16_f32 v185, v186, v187
    v_mfma_f32_16x16x32_bf16 a[100:103], a[200:203], v[152:155], a[100:103]
    s_nop 0
    v_cvt_pk_bf16_f32 v186, v188, v189
    v_cvt_pk_bf16_f32 v187, v190, v191
    v_mfma_f32_16x16x32_bf16 a[100:103], a[196:199], v[148:151], a[100:103]
    ds_read_b128 a[236:239], v200 offset:23552
    ds_write_b128 v124, v[184:187]
    ds_read_b128 v[188:191], v125
    v_accvgpr_read_b32 v192, a68
    v_accvgpr_read_b32 v193, a69
    v_mfma_f32_16x16x32_bf16 a[100:103], a[192:195], v[144:147], a[100:103]
    buffer_load_dwordx4 v1, s[16:19], 0 offen lds
    v_accvgpr_read_b32 v194, a70
    v_accvgpr_read_b32 v195, a71
    v_mfma_f32_16x16x32_bf16 a[104:107], a[208:211], v[128:131], a[104:107]
    ds_read_b128 a[192:195], v200 offset:36864
    s_add_u32 m0, s46, 2048
    v_accvgpr_read_b32 v196, a76
    v_accvgpr_read_b32 v197, a77
    v_mfma_f32_16x16x32_bf16 a[104:107], a[212:215], v[132:135], a[104:107]
    s_nop 0
    v_accvgpr_read_b32 v198, a78
    v_accvgpr_read_b32 v199, a79
    v_mfma_f32_16x16x32_bf16 a[104:107], a[216:219], v[136:139], a[104:107]
    ds_read_b128 a[196:199], v200 offset:37888
    buffer_load_dwordx4 v2, s[16:19], 0 offen lds
    s_waitcnt lgkmcnt(2)
    buffer_store_dwordx4 v[188:191], v204, s[12:15], s22 offen offset:256 sc0 sc1
    v_cvt_pk_bf16_f32 v192, v192, v193
    v_cvt_pk_bf16_f32 v193, v194, v195
    v_mfma_f32_16x16x32_bf16 a[104:107], a[220:223], v[140:143], a[104:107]
    s_add_u32 m0, s46, 3072
    v_cvt_pk_bf16_f32 v194, v196, v197
    v_cvt_pk_bf16_f32 v195, v198, v199
    v_mfma_f32_16x16x32_bf16 a[108:111], a[220:223], v[156:159], a[108:111]
    ds_read_b128 a[200:203], v200 offset:38912
    ds_write_b128 v124, v[192:195]
    ds_read_b128 v[196:199], v125
    v_accvgpr_read_b32 v184, a80
    v_accvgpr_read_b32 v185, a81
    v_mfma_f32_16x16x32_bf16 a[108:111], a[216:219], v[152:155], a[108:111]
    s_nop 0
    v_accvgpr_read_b32 v186, a82
    v_accvgpr_read_b32 v187, a83
    v_mfma_f32_16x16x32_bf16 a[108:111], a[212:215], v[148:151], a[108:111]
    ds_read_b128 a[204:207], v200 offset:39936
    v_accvgpr_read_b32 v188, a88
    v_accvgpr_read_b32 v189, a89
    v_mfma_f32_16x16x32_bf16 a[108:111], a[208:211], v[144:147], a[108:111]
    buffer_load_dwordx4 v3, s[16:19], 0 offen lds
    v_accvgpr_read_b32 v190, a90
    v_accvgpr_read_b32 v191, a91
    v_mfma_f32_16x16x32_bf16 a[112:115], a[224:227], v[128:131], a[112:115]
    ds_read_b128 a[208:211], v200 offset:40960
    s_add_u32 m0, s46, 4096
    s_waitcnt lgkmcnt(2)
    buffer_store_dwordx4 v[196:199], v205, s[12:15], s22 offen offset:256 sc0 sc1
    v_cvt_pk_bf16_f32 v184, v184, v185
    v_cvt_pk_bf16_f32 v185, v186, v187
    v_mfma_f32_16x16x32_bf16 a[112:115], a[228:231], v[132:135], a[112:115]
    s_nop 0
    v_cvt_pk_bf16_f32 v186, v188, v189
    v_cvt_pk_bf16_f32 v187, v190, v191
    v_mfma_f32_16x16x32_bf16 a[112:115], a[232:235], v[136:139], a[112:115]
    ds_read_b128 a[212:215], v200 offset:41984
    buffer_load_dwordx4 v126, s[16:19], 0 offen lds
    ds_write_b128 v124, v[184:187]
    ds_read_b128 v[188:191], v125
    v_accvgpr_read_b32 v192, a84
    v_accvgpr_read_b32 v193, a85
    v_mfma_f32_16x16x32_bf16 a[112:115], a[236:239], v[140:143], a[112:115]
    s_add_u32 m0, s46, 5120
    v_accvgpr_read_b32 v194, a86
    v_accvgpr_read_b32 v195, a87
    v_mfma_f32_16x16x32_bf16 a[116:119], a[236:239], v[156:159], a[116:119]
    ds_read_b128 a[216:219], v200 offset:43008
    v_accvgpr_read_b32 v196, a92
    v_accvgpr_read_b32 v197, a93
    v_mfma_f32_16x16x32_bf16 a[116:119], a[232:235], v[152:155], a[116:119]
    s_nop 0
    v_accvgpr_read_b32 v198, a94
    v_accvgpr_read_b32 v199, a95
    v_mfma_f32_16x16x32_bf16 a[116:119], a[228:231], v[148:151], a[116:119]
    ds_read_b128 a[220:223], v200 offset:44032
    s_waitcnt lgkmcnt(2)
    buffer_store_dwordx4 v[188:191], v204, s[12:15], s22 offen offset:320 sc0 sc1
    v_cvt_pk_bf16_f32 v192, v192, v193
    v_cvt_pk_bf16_f32 v193, v194, v195
    v_mfma_f32_16x16x32_bf16 a[116:119], a[224:227], v[144:147], a[116:119]
    buffer_load_dwordx4 v127, s[52:55], 0 offen lds
    v_cvt_pk_bf16_f32 v194, v196, v197
    v_cvt_pk_bf16_f32 v195, v198, v199
    ds_write_b128 v124, v[192:195]
    ds_read_b128 v[196:199], v125
    v_mfma_f32_16x16x32_bf16 a[120:123], a[192:195], v[128:131], a[120:123]
    ds_read_b128 a[224:227], v200 offset:45056
    v_mfma_f32_16x16x32_bf16 a[120:123], a[196:199], v[132:135], a[120:123]
    s_nop 0
    v_accvgpr_read_b32 v184, a96
    v_accvgpr_read_b32 v185, a97
    v_mfma_f32_16x16x32_bf16 a[120:123], a[200:203], v[136:139], a[120:123]
    ds_read_b128 a[228:231], v200 offset:46080
    v_accvgpr_read_b32 v186, a98
    v_mfma_f32_16x16x32_bf16 a[120:123], a[204:207], v[140:143], a[120:123]
    v_accvgpr_read_b32 v187, a99
    v_mfma_f32_16x16x32_bf16 a[124:127], a[204:207], v[156:159], a[124:127]
    ds_read_b128 a[232:235], v200 offset:47104
    v_accvgpr_read_b32 v188, a104
    v_mfma_f32_16x16x32_bf16 a[124:127], a[200:203], v[152:155], a[124:127]
    v_accvgpr_read_b32 v189, a105
    v_mfma_f32_16x16x32_bf16 a[124:127], a[196:199], v[148:151], a[124:127]
    ds_read_b128 a[236:239], v200 offset:48128
    v_accvgpr_read_b32 v190, a106
    v_mfma_f32_16x16x32_bf16 a[124:127], a[192:195], v[144:147], a[124:127]
    v_accvgpr_read_b32 v191, a107
    s_waitcnt lgkmcnt(6)
    v_mfma_f32_16x16x32_bf16 a[128:131], a[208:211], v[128:131], a[128:131]
    ds_read_b128 a[192:195], v201 offset:0
    s_waitcnt lgkmcnt(5)
    buffer_store_dwordx4 v[196:199], v205, s[12:15], s22 offen offset:320 sc0 sc1
    v_cvt_pk_bf16_f32 v184, v184, v185
    v_mfma_f32_16x16x32_bf16 a[128:131], a[212:215], v[132:135], a[128:131]
    v_cvt_pk_bf16_f32 v185, v186, v187
    v_mfma_f32_16x16x32_bf16 a[128:131], a[216:219], v[136:139], a[128:131]
    ds_read_b128 a[196:199], v201 offset:1024
    v_cvt_pk_bf16_f32 v186, v188, v189
    v_mfma_f32_16x16x32_bf16 a[128:131], a[220:223], v[140:143], a[128:131]
    v_cvt_pk_bf16_f32 v187, v190, v191
    v_mfma_f32_16x16x32_bf16 a[132:135], a[220:223], v[156:159], a[132:135]
    ds_read_b128 a[200:203], v201 offset:2048
    ds_write_b128 v124, v[184:187]
    ds_read_b128 v[188:191], v125
    v_accvgpr_read_b32 v192, a100
    v_mfma_f32_16x16x32_bf16 a[132:135], a[216:219], v[152:155], a[132:135]
    v_accvgpr_read_b32 v193, a101
    v_mfma_f32_16x16x32_bf16 a[132:135], a[212:215], v[148:151], a[132:135]
    ds_read_b128 a[204:207], v201 offset:3072
    v_accvgpr_read_b32 v194, a102
    v_mfma_f32_16x16x32_bf16 a[132:135], a[208:211], v[144:147], a[132:135]
    v_accvgpr_read_b32 v195, a103
    s_waitcnt lgkmcnt(6)
    v_mfma_f32_16x16x32_bf16 a[136:139], a[224:227], v[128:131], a[136:139]
    ds_read_b128 a[208:211], v201 offset:4096
    v_accvgpr_read_b32 v196, a108
    v_mfma_f32_16x16x32_bf16 a[136:139], a[228:231], v[132:135], a[136:139]
    v_accvgpr_read_b32 v197, a109
    v_mfma_f32_16x16x32_bf16 a[136:139], a[232:235], v[136:139], a[136:139]
    ds_read_b128 a[212:215], v201 offset:5120
    v_accvgpr_read_b32 v198, a110
    v_mfma_f32_16x16x32_bf16 a[136:139], a[236:239], v[140:143], a[136:139]
    v_accvgpr_read_b32 v199, a111
    v_mfma_f32_16x16x32_bf16 a[140:143], a[236:239], v[156:159], a[140:143]
    ds_read_b128 a[216:219], v201 offset:6144
    s_waitcnt lgkmcnt(4)
    buffer_store_dwordx4 v[188:191], v204, s[12:15], s22 offen offset:384 sc0 sc1
    v_cvt_pk_bf16_f32 v192, v192, v193
    v_mfma_f32_16x16x32_bf16 a[140:143], a[232:235], v[152:155], a[140:143]
    v_cvt_pk_bf16_f32 v193, v194, v195
    v_mfma_f32_16x16x32_bf16 a[140:143], a[228:231], v[148:151], a[140:143]
    ds_read_b128 a[220:223], v201 offset:7168
    v_cvt_pk_bf16_f32 v194, v196, v197
    v_mfma_f32_16x16x32_bf16 a[140:143], a[224:227], v[144:147], a[140:143]
    v_cvt_pk_bf16_f32 v195, v198, v199
    ds_write_b128 v124, v[192:195]
    ds_read_b128 v[196:199], v125
    s_waitcnt lgkmcnt(6)
    v_mfma_f32_16x16x32_bf16 a[144:147], a[192:195], v[128:131], a[144:147]
    ds_read_b128 a[224:227], v201 offset:8192
    v_mfma_f32_16x16x32_bf16 a[144:147], a[196:199], v[132:135], a[144:147]
    s_nop 0
    v_accvgpr_read_b32 v184, a112
    v_accvgpr_read_b32 v185, a113
    v_accvgpr_read_b32 v186, a114
    v_mfma_f32_16x16x32_bf16 a[144:147], a[200:203], v[136:139], a[144:147]
    ds_read_b128 a[228:231], v201 offset:9216
    v_accvgpr_read_b32 v187, a115
    v_accvgpr_read_b32 v188, a120
    v_accvgpr_read_b32 v189, a121
    v_mfma_f32_16x16x32_bf16 a[144:147], a[204:207], v[140:143], a[144:147]
    s_nop 0
    v_accvgpr_read_b32 v190, a122
    v_accvgpr_read_b32 v191, a123
    v_mfma_f32_16x16x32_bf16 a[148:151], a[204:207], v[156:159], a[148:151]
    ds_read_b128 a[232:235], v201 offset:10240
    s_waitcnt lgkmcnt(3)
    buffer_store_dwordx4 v[196:199], v205, s[12:15], s22 offen offset:384 sc0 sc1
    v_cvt_pk_bf16_f32 v184, v184, v185
    v_cvt_pk_bf16_f32 v185, v186, v187
    v_mfma_f32_16x16x32_bf16 a[148:151], a[200:203], v[152:155], a[148:151]
    s_nop 0
    v_cvt_pk_bf16_f32 v186, v188, v189
    v_cvt_pk_bf16_f32 v187, v190, v191
    v_mfma_f32_16x16x32_bf16 a[148:151], a[196:199], v[148:151], a[148:151]
    ds_read_b128 a[236:239], v201 offset:11264
    ds_write_b128 v124, v[184:187]
    ds_read_b128 v[188:191], v125
    v_accvgpr_read_b32 v192, a116
    v_accvgpr_read_b32 v193, a117
    v_mfma_f32_16x16x32_bf16 a[148:151], a[192:195], v[144:147], a[148:151]
    s_nop 0
    v_accvgpr_read_b32 v194, a118
    v_accvgpr_read_b32 v195, a119
    v_mfma_f32_16x16x32_bf16 a[152:155], a[208:211], v[128:131], a[152:155]
    ds_read_b128 a[192:195], v201 offset:24576
    v_accvgpr_read_b32 v196, a124
    v_accvgpr_read_b32 v197, a125
    v_mfma_f32_16x16x32_bf16 a[152:155], a[212:215], v[132:135], a[152:155]
    s_nop 0
    v_accvgpr_read_b32 v198, a126
    v_accvgpr_read_b32 v199, a127
    v_mfma_f32_16x16x32_bf16 a[152:155], a[216:219], v[136:139], a[152:155]
    ds_read_b128 a[196:199], v201 offset:25600
    s_waitcnt lgkmcnt(2)
    buffer_store_dwordx4 v[188:191], v204, s[12:15], s22 offen offset:448 sc0 sc1
    v_cvt_pk_bf16_f32 v192, v192, v193
    v_cvt_pk_bf16_f32 v193, v194, v195
    v_mfma_f32_16x16x32_bf16 a[152:155], a[220:223], v[140:143], a[152:155]
    s_nop 0
    v_cvt_pk_bf16_f32 v194, v196, v197
    v_cvt_pk_bf16_f32 v195, v198, v199
    v_mfma_f32_16x16x32_bf16 a[156:159], a[220:223], v[156:159], a[156:159]
    ds_read_b128 a[200:203], v201 offset:26624
    ds_write_b128 v124, v[192:195]
    ds_read_b128 v[196:199], v125
    v_accvgpr_read_b32 v184, a128
    v_accvgpr_read_b32 v185, a129
    v_mfma_f32_16x16x32_bf16 a[156:159], a[216:219], v[152:155], a[156:159]
    s_nop 0
    v_accvgpr_read_b32 v186, a130
    v_accvgpr_read_b32 v187, a131
    v_mfma_f32_16x16x32_bf16 a[156:159], a[212:215], v[148:151], a[156:159]
    ds_read_b128 a[204:207], v201 offset:27648
    v_accvgpr_read_b32 v188, a136
    v_accvgpr_read_b32 v189, a137
    v_mfma_f32_16x16x32_bf16 a[156:159], a[208:211], v[144:147], a[156:159]
    s_nop 0
    v_accvgpr_read_b32 v190, a138
    v_accvgpr_read_b32 v191, a139
    v_mfma_f32_16x16x32_bf16 a[160:163], a[224:227], v[128:131], a[160:163]
    ds_read_b128 a[208:211], v201 offset:28672
    s_waitcnt lgkmcnt(2)
    buffer_store_dwordx4 v[196:199], v205, s[12:15], s22 offen offset:448 sc0 sc1
    v_cvt_pk_bf16_f32 v184, v184, v185
    v_cvt_pk_bf16_f32 v185, v186, v187
    v_mfma_f32_16x16x32_bf16 a[160:163], a[228:231], v[132:135], a[160:163]
    s_nop 0
    v_cvt_pk_bf16_f32 v186, v188, v189
    v_cvt_pk_bf16_f32 v187, v190, v191
    v_mfma_f32_16x16x32_bf16 a[160:163], a[232:235], v[136:139], a[160:163]
    ds_read_b128 a[212:215], v201 offset:29696
    ds_write_b128 v124, v[184:187]
    ds_read_b128 v[188:191], v125
    v_accvgpr_read_b32 v192, a132
    v_accvgpr_read_b32 v193, a133
    v_mfma_f32_16x16x32_bf16 a[160:163], a[236:239], v[140:143], a[160:163]
    s_nop 0
    v_accvgpr_read_b32 v194, a134
    v_accvgpr_read_b32 v195, a135
    v_mfma_f32_16x16x32_bf16 a[164:167], a[236:239], v[156:159], a[164:167]
    ds_read_b128 a[216:219], v201 offset:30720
    v_accvgpr_read_b32 v196, a140
    v_accvgpr_read_b32 v197, a141
    v_mfma_f32_16x16x32_bf16 a[164:167], a[232:235], v[152:155], a[164:167]
    s_nop 0
    v_accvgpr_read_b32 v198, a142
    v_accvgpr_read_b32 v199, a143
    v_mfma_f32_16x16x32_bf16 a[164:167], a[228:231], v[148:151], a[164:167]
    ds_read_b128 a[220:223], v201 offset:31744
    s_waitcnt lgkmcnt(2)
    buffer_store_dwordx4 v[188:191], v204, s[12:15], s22 offen offset:512 sc0 sc1
    v_cvt_pk_bf16_f32 v192, v192, v193
    v_cvt_pk_bf16_f32 v193, v194, v195
    v_mfma_f32_16x16x32_bf16 a[164:167], a[224:227], v[144:147], a[164:167]
    s_nop 0
    v_cvt_pk_bf16_f32 v194, v196, v197
    v_cvt_pk_bf16_f32 v195, v198, v199
    ds_write_b128 v124, v[192:195]
    ds_read_b128 v[196:199], v125
    v_mfma_f32_16x16x32_bf16 a[168:171], a[192:195], v[128:131], a[168:171]
    ds_read_b128 a[224:227], v201 offset:32768
    v_mfma_f32_16x16x32_bf16 a[168:171], a[196:199], v[132:135], a[168:171]
    s_nop 0
    v_accvgpr_read_b32 v184, a144
    v_accvgpr_read_b32 v185, a145
    v_mfma_f32_16x16x32_bf16 a[168:171], a[200:203], v[136:139], a[168:171]
    ds_read_b128 a[228:231], v201 offset:33792
    v_accvgpr_read_b32 v186, a146
    v_mfma_f32_16x16x32_bf16 a[168:171], a[204:207], v[140:143], a[168:171]
    v_accvgpr_read_b32 v187, a147
    v_mfma_f32_16x16x32_bf16 a[172:175], a[204:207], v[156:159], a[172:175]
    ds_read_b128 a[232:235], v201 offset:34816
    v_accvgpr_read_b32 v188, a152
    v_mfma_f32_16x16x32_bf16 a[172:175], a[200:203], v[152:155], a[172:175]
    v_accvgpr_read_b32 v189, a153
    v_mfma_f32_16x16x32_bf16 a[172:175], a[196:199], v[148:151], a[172:175]
    ds_read_b128 a[236:239], v201 offset:35840
    v_accvgpr_read_b32 v190, a154
    v_mfma_f32_16x16x32_bf16 a[172:175], a[192:195], v[144:147], a[172:175]
    v_accvgpr_read_b32 v191, a155
    s_waitcnt lgkmcnt(6)
    v_mfma_f32_16x16x32_bf16 a[176:179], a[208:211], v[128:131], a[176:179]
    s_waitcnt lgkmcnt(4)
    buffer_store_dwordx4 v[196:199], v205, s[12:15], s22 offen offset:512 sc0 sc1
    v_cvt_pk_bf16_f32 v184, v184, v185
    v_mfma_f32_16x16x32_bf16 a[176:179], a[212:215], v[132:135], a[176:179]
    v_cvt_pk_bf16_f32 v185, v186, v187
    v_mfma_f32_16x16x32_bf16 a[176:179], a[216:219], v[136:139], a[176:179]
    v_cvt_pk_bf16_f32 v186, v188, v189
    v_mfma_f32_16x16x32_bf16 a[176:179], a[220:223], v[140:143], a[176:179]
    v_cvt_pk_bf16_f32 v187, v190, v191
    v_mfma_f32_16x16x32_bf16 a[180:183], a[220:223], v[156:159], a[180:183]
    ds_write_b128 v124, v[184:187]
    ds_read_b128 v[188:191], v125
    v_accvgpr_read_b32 v192, a148
    v_mfma_f32_16x16x32_bf16 a[180:183], a[216:219], v[152:155], a[180:183]
    v_accvgpr_read_b32 v193, a149
    v_mfma_f32_16x16x32_bf16 a[180:183], a[212:215], v[148:151], a[180:183]
    v_accvgpr_read_b32 v194, a150
    v_mfma_f32_16x16x32_bf16 a[180:183], a[208:211], v[144:147], a[180:183]
    v_accvgpr_read_b32 v195, a151
    s_waitcnt lgkmcnt(2)
    v_mfma_f32_16x16x32_bf16 a[184:187], a[224:227], v[128:131], a[184:187]
    v_accvgpr_read_b32 v196, a156
    v_mfma_f32_16x16x32_bf16 a[184:187], a[228:231], v[132:135], a[184:187]
    v_accvgpr_read_b32 v197, a157
    v_mfma_f32_16x16x32_bf16 a[184:187], a[232:235], v[136:139], a[184:187]
    v_accvgpr_read_b32 v198, a158
    v_mfma_f32_16x16x32_bf16 a[184:187], a[236:239], v[140:143], a[184:187]
    v_accvgpr_read_b32 v199, a159
    v_mfma_f32_16x16x32_bf16 a[188:191], a[236:239], v[156:159], a[188:191]
    s_waitcnt lgkmcnt(0)
    buffer_store_dwordx4 v[188:191], v204, s[12:15], s22 offen offset:576 sc0 sc1
    v_cvt_pk_bf16_f32 v192, v192, v193
    v_mfma_f32_16x16x32_bf16 a[188:191], a[232:235], v[152:155], a[188:191]
    v_cvt_pk_bf16_f32 v193, v194, v195
    v_mfma_f32_16x16x32_bf16 a[188:191], a[228:231], v[148:151], a[188:191]
    v_cvt_pk_bf16_f32 v194, v196, v197
    v_mfma_f32_16x16x32_bf16 a[188:191], a[224:227], v[144:147], a[188:191]
    v_cvt_pk_bf16_f32 v195, v198, v199
    ds_write_b128 v124, v[192:195]
    ds_read_b128 v[196:199], v125
    s_nop 7
    v_accvgpr_read_b32 v184, a160
    v_accvgpr_read_b32 v185, a161
    v_accvgpr_read_b32 v186, a162
    v_accvgpr_read_b32 v187, a163
    v_accvgpr_read_b32 v188, a168
    v_accvgpr_read_b32 v189, a169
    v_accvgpr_read_b32 v190, a170
    v_accvgpr_read_b32 v191, a171
    s_waitcnt lgkmcnt(0)
    buffer_store_dwordx4 v[196:199], v205, s[12:15], s22 offen offset:576 sc0 sc1
    v_cvt_pk_bf16_f32 v184, v184, v185
    v_cvt_pk_bf16_f32 v185, v186, v187
    v_cvt_pk_bf16_f32 v186, v188, v189
    v_cvt_pk_bf16_f32 v187, v190, v191
    ds_write_b128 v124, v[184:187]
    ds_read_b128 v[188:191], v125
    v_accvgpr_read_b32 v192, a164
    v_accvgpr_read_b32 v193, a165
    v_accvgpr_read_b32 v194, a166
    v_accvgpr_read_b32 v195, a167
    v_accvgpr_read_b32 v196, a172
    v_accvgpr_read_b32 v197, a173
    v_accvgpr_read_b32 v198, a174
    v_accvgpr_read_b32 v199, a175
    s_waitcnt lgkmcnt(0)
    buffer_store_dwordx4 v[188:191], v204, s[12:15], s22 offen offset:640 sc0 sc1
    v_cvt_pk_bf16_f32 v192, v192, v193
    v_cvt_pk_bf16_f32 v193, v194, v195
    v_cvt_pk_bf16_f32 v194, v196, v197
    v_cvt_pk_bf16_f32 v195, v198, v199
    ds_write_b128 v124, v[192:195]
    ds_read_b128 v[196:199], v125
    v_accvgpr_read_b32 v184, a176
    v_accvgpr_read_b32 v185, a177
    v_accvgpr_read_b32 v186, a178
    v_accvgpr_read_b32 v187, a179
    v_accvgpr_read_b32 v188, a184
    v_accvgpr_read_b32 v189, a185
    v_accvgpr_read_b32 v190, a186
    v_accvgpr_read_b32 v191, a187
    s_waitcnt lgkmcnt(0)
    buffer_store_dwordx4 v[196:199], v205, s[12:15], s22 offen offset:640 sc0 sc1
    v_cvt_pk_bf16_f32 v184, v184, v185
    v_cvt_pk_bf16_f32 v185, v186, v187
    v_cvt_pk_bf16_f32 v186, v188, v189
    v_cvt_pk_bf16_f32 v187, v190, v191
    ds_write_b128 v124, v[184:187]
    ds_read_b128 v[188:191], v125
    v_accvgpr_read_b32 v192, a180
    v_accvgpr_read_b32 v193, a181
    v_accvgpr_read_b32 v194, a182
    v_accvgpr_read_b32 v195, a183
    v_accvgpr_read_b32 v196, a188
    v_accvgpr_read_b32 v197, a189
    v_accvgpr_read_b32 v198, a190
    v_accvgpr_read_b32 v199, a191
    s_waitcnt lgkmcnt(0)
    buffer_store_dwordx4 v[188:191], v204, s[12:15], s22 offen offset:704 sc0 sc1
    v_cvt_pk_bf16_f32 v192, v192, v193
    v_cvt_pk_bf16_f32 v193, v194, v195
    v_cvt_pk_bf16_f32 v194, v196, v197
    v_cvt_pk_bf16_f32 v195, v198, v199
    ds_write_b128 v124, v[192:195]
    ds_read_b128 v[196:199], v125
    s_waitcnt lgkmcnt(0)
    buffer_store_dwordx4 v[196:199], v205, s[12:15], s22 offen offset:704 sc0 sc1
    s_mov_b32 s21, 1
    s_branch L_tile
L_final:
    s_barrier
    v_mfma_f32_16x16x32_bf16 a[168:171], a[192:195], v[96:99], a[168:171]
    ds_read_b128 a[224:227], v201 offset:45056
    v_fma_f32 v176, v168, v168, s27
    v_fma_f32 v177, v169, v169, s27
    v_fma_f32 v178, v170, v170, s27
    v_mfma_f32_16x16x32_bf16 a[168:171], a[196:199], v[100:103], a[168:171]
    s_add_u32 m0, s24, 61440
    v_fma_f32 v179, v171, v171, s27
    v_fma_f32 v180, v172, v172, s27
    v_fma_f32 v181, v173, v173, s27
    v_mfma_f32_16x16x32_bf16 a[168:171], a[200:203], v[104:107], a[168:171]
    ds_read_b128 a[228:231], v201 offset:46080
    v_fma_f32 v182, v174, v174, s27
    v_fma_f32 v183, v175, v175, s27
    v_mul_f32 v176, v176, v168
    v_mfma_f32_16x16x32_bf16 a[168:171], a[204:207], v[108:111], a[168:171]
    s_mov_b32 s26, 2445312
    v_mul_f32 v177, v177, v169
    v_mul_f32 v178, v178, v170
    v_mul_f32 v179, v179, v171
    v_mfma_f32_16x16x32_bf16 a[172:175], a[204:207], v[124:127], a[172:175]
    ds_read_b128 a[232:235], v201 offset:47104
    v_mul_f32 v180, v180, v172
    v_mul_f32 v181, v181, v173
    v_mul_f32 v182, v182, v174
    v_mfma_f32_16x16x32_bf16 a[172:175], a[200:203], v[120:123], a[172:175]
    s_nop 0
    v_mul_f32 v183, v183, v175
    v_exp_f32 v176, v176
    v_mfma_f32_16x16x32_bf16 a[172:175], a[196:199], v[116:119], a[172:175]
    ds_read_b128 a[236:239], v201 offset:48128
    v_exp_f32 v177, v177
    v_mfma_f32_16x16x32_bf16 a[172:175], a[192:195], v[112:115], a[172:175]
    v_exp_f32 v178, v178
    s_waitcnt lgkmcnt(4)
    v_mfma_f32_16x16x32_bf16 a[176:179], a[208:211], v[96:99], a[176:179]
    ds_read_b128 a[192:195], v200 offset:12288
    v_exp_f32 v179, v179
    v_mfma_f32_16x16x32_bf16 a[176:179], a[212:215], v[100:103], a[176:179]
    buffer_load_dwordx4 v203, s[8:11], s26 offen offset:0 lds
    v_exp_f32 v180, v180
    v_mfma_f32_16x16x32_bf16 a[176:179], a[216:219], v[104:107], a[176:179]
    ds_read_b128 a[196:199], v200 offset:13312
    v_exp_f32 v181, v181
    v_mfma_f32_16x16x32_bf16 a[176:179], a[220:223], v[108:111], a[176:179]
    buffer_load_dwordx4 v203, s[8:11], s26 offen offset:1024 lds
    v_exp_f32 v182, v182
    v_exp_f32 v183, v183
    v_mfma_f32_16x16x32_bf16 a[180:183], a[220:223], v[124:127], a[180:183]
    ds_read_b128 a[200:203], v200 offset:14336
    v_fma_f32 v176, v176, s28, s28
    v_fma_f32 v177, v177, s28, s28
    v_fma_f32 v178, v178, s28, s28
    v_mfma_f32_16x16x32_bf16 a[180:183], a[216:219], v[120:123], a[180:183]
    s_nop 0
    v_fma_f32 v179, v179, s28, s28
    v_fma_f32 v180, v180, s28, s28
    v_fma_f32 v181, v181, s28, s28
    v_mfma_f32_16x16x32_bf16 a[180:183], a[212:215], v[116:119], a[180:183]
    ds_read_b128 a[204:207], v200 offset:15360
    v_fma_f32 v182, v182, s28, s28
    v_fma_f32 v183, v183, s28, s28
    v_mfma_f32_16x16x32_bf16 a[180:183], a[208:211], v[112:115], a[180:183]
    v_rcp_f32 v176, v176
    v_rcp_f32 v177, v177
    s_waitcnt lgkmcnt(4)
    v_mfma_f32_16x16x32_bf16 a[184:187], a[224:227], v[96:99], a[184:187]
    ds_read_b128 a[208:211], v200 offset:16384
    v_rcp_f32 v178, v178
    v_mfma_f32_16x16x32_bf16 a[184:187], a[228:231], v[100:103], a[184:187]
    buffer_load_dwordx4 v203, s[8:11], s26 offen offset:2048 lds
    v_rcp_f32 v179, v179
    v_rcp_f32 v180, v180
    v_mfma_f32_16x16x32_bf16 a[184:187], a[232:235], v[104:107], a[184:187]
    ds_read_b128 a[212:215], v200 offset:17408
    v_rcp_f32 v181, v181
    v_mfma_f32_16x16x32_bf16 a[184:187], a[236:239], v[108:111], a[184:187]
    v_rcp_f32 v182, v182
    v_rcp_f32 v183, v183
    v_mfma_f32_16x16x32_bf16 a[188:191], a[236:239], v[124:127], a[188:191]
    ds_read_b128 a[216:219], v200 offset:18432
    v_mul_f32 v176, v176, v168
    v_mul_f32 v177, v177, v169
    v_mul_f32 v178, v178, v170
    v_mfma_f32_16x16x32_bf16 a[188:191], a[232:235], v[120:123], a[188:191]
    s_nop 0
    v_mul_f32 v179, v179, v171
    v_mul_f32 v180, v180, v172
    v_mul_f32 v181, v181, v173
    v_mfma_f32_16x16x32_bf16 a[188:191], a[228:231], v[116:119], a[188:191]
    ds_read_b128 a[220:223], v200 offset:19456
    v_mul_f32 v182, v182, v174
    v_mul_f32 v183, v183, v175
    v_cvt_pk_bf16_f32 v142, v176, v177
    v_mfma_f32_16x16x32_bf16 a[188:191], a[224:227], v[112:115], a[188:191]
    s_nop 0
    v_cvt_pk_bf16_f32 v143, v178, v179
    v_cvt_pk_bf16_f32 v158, v180, v181
    v_cvt_pk_bf16_f32 v159, v182, v183
    s_waitcnt vmcnt(3)
    s_barrier
    s_waitcnt lgkmcnt(4)
    v_mfma_f32_16x16x32_bf16 a[0:3], a[192:195], v[128:131], a[0:3]
    ds_read_b128 a[224:227], v200 offset:20480
    v_and_b32 v179, 15, v252
    v_mfma_f32_16x16x32_bf16 a[0:3], a[196:199], v[132:135], a[0:3]
    s_add_u32 m0, s24, 86016
    v_lshrrev_b32 v180, 4, v252
    v_mfma_f32_16x16x32_bf16 a[0:3], a[200:203], v[136:139], a[0:3]
    ds_read_b128 a[228:231], v200 offset:21504
    v_lshrrev_b32 v181, 1, v179
    v_mfma_f32_16x16x32_bf16 a[0:3], a[204:207], v[140:143], a[0:3]
    s_mov_b32 s26, 2469888
    v_add_u32 v180, v180, v181
    v_mfma_f32_16x16x32_bf16 a[4:7], a[204:207], v[156:159], a[4:7]
    ds_read_b128 a[232:235], v200 offset:22528
    v_and_b32 v180, 3, v180
    v_mfma_f32_16x16x32_bf16 a[4:7], a[200:203], v[152:155], a[4:7]
    buffer_load_dwordx4 v203, s[8:11], s26 offen offset:0 lds
    v_lshlrev_b32 v180, 4, v180
    v_mfma_f32_16x16x32_bf16 a[4:7], a[196:199], v[148:151], a[4:7]
    ds_read_b128 a[236:239], v200 offset:23552
    v_lshl_add_u32 v180, v179, 6, v180
    v_mfma_f32_16x16x32_bf16 a[4:7], a[192:195], v[144:147], a[4:7]
    buffer_load_dwordx4 v203, s[8:11], s26 offen offset:1024 lds
    s_lshl_b32 s49, s20, 10
    s_waitcnt lgkmcnt(4)
    v_mfma_f32_16x16x32_bf16 a[8:11], a[208:211], v[128:131], a[8:11]
    ds_read_b128 a[192:195], v200 offset:36864
    s_add_u32 s49, s49, 159744
    v_mfma_f32_16x16x32_bf16 a[8:11], a[212:215], v[132:135], a[8:11]
    buffer_load_dwordx4 v203, s[8:11], s26 offen offset:2048 lds
    v_add_u32 v124, s49, v180
    v_mfma_f32_16x16x32_bf16 a[8:11], a[216:219], v[136:139], a[8:11]
    ds_read_b128 a[196:199], v200 offset:37888
    v_lshrrev_b32 v179, 2, v252
    v_mfma_f32_16x16x32_bf16 a[8:11], a[220:223], v[140:143], a[8:11]
    s_add_u32 m0, s24, 49152
    v_and_b32 v180, 3, v252
    v_mfma_f32_16x16x32_bf16 a[12:15], a[220:223], v[156:159], a[12:15]
    ds_read_b128 a[200:203], v200 offset:38912
    v_lshrrev_b32 v181, 3, v179
    v_mfma_f32_16x16x32_bf16 a[12:15], a[216:219], v[152:155], a[12:15]
    s_mov_b32 s26, 2543616
    v_lshlrev_b32 v181, 1, v181
    v_mfma_f32_16x16x32_bf16 a[12:15], a[212:215], v[148:151], a[12:15]
    ds_read_b128 a[204:207], v200 offset:39936
    v_xor_b32 v180, v180, v181
    v_mfma_f32_16x16x32_bf16 a[12:15], a[208:211], v[144:147], a[12:15]
    v_lshrrev_b32 v181, 1, v179
    s_waitcnt lgkmcnt(4)
    v_mfma_f32_16x16x32_bf16 a[16:19], a[224:227], v[128:131], a[16:19]
    ds_read_b128 a[208:211], v200 offset:40960
    v_add_u32 v180, v180, v181
    v_mfma_f32_16x16x32_bf16 a[16:19], a[228:231], v[132:135], a[16:19]
    buffer_load_dwordx4 v203, s[8:11], s26 offen offset:0 lds
    v_and_b32 v180, 3, v180
    v_mfma_f32_16x16x32_bf16 a[16:19], a[232:235], v[136:139], a[16:19]
    ds_read_b128 a[212:215], v200 offset:41984
    v_lshlrev_b32 v180, 4, v180
    v_mfma_f32_16x16x32_bf16 a[16:19], a[236:239], v[140:143], a[16:19]
    buffer_load_dwordx4 v203, s[8:11], s26 offen offset:1024 lds
    v_lshl_add_u32 v180, v179, 6, v180
    v_mfma_f32_16x16x32_bf16 a[20:23], a[236:239], v[156:159], a[20:23]
    ds_read_b128 a[216:219], v200 offset:43008
    v_add_u32 v125, s49, v180
    v_mfma_f32_16x16x32_bf16 a[20:23], a[232:235], v[152:155], a[20:23]
    buffer_load_dwordx4 v203, s[8:11], s26 offen offset:2048 lds
    v_mfma_f32_16x16x32_bf16 a[20:23], a[228:231], v[148:151], a[20:23]
    ds_read_b128 a[220:223], v200 offset:44032
    v_mfma_f32_16x16x32_bf16 a[20:23], a[224:227], v[144:147], a[20:23]
    s_waitcnt vmcnt(6)
    s_barrier
    s_waitcnt lgkmcnt(4)
    v_mfma_f32_16x16x32_bf16 a[24:27], a[192:195], v[128:131], a[24:27]
    ds_read_b128 a[224:227], v200 offset:45056
    v_mfma_f32_16x16x32_bf16 a[24:27], a[196:199], v[132:135], a[24:27]
    s_add_u32 m0, s24, 12288
    v_accvgpr_read_b32 v184, a0
    v_accvgpr_read_b32 v185, a1
    v_mfma_f32_16x16x32_bf16 a[24:27], a[200:203], v[136:139], a[24:27]
    ds_read_b128 a[228:231], v200 offset:46080
    v_accvgpr_read_b32 v186, a2
    v_mfma_f32_16x16x32_bf16 a[24:27], a[204:207], v[140:143], a[24:27]
    s_mov_b32 s26, 2494464
    v_accvgpr_read_b32 v187, a3
    v_mfma_f32_16x16x32_bf16 a[28:31], a[204:207], v[156:159], a[28:31]
    ds_read_b128 a[232:235], v200 offset:47104
    v_accvgpr_read_b32 v188, a8
    v_mfma_f32_16x16x32_bf16 a[28:31], a[200:203], v[152:155], a[28:31]
    buffer_load_dwordx4 v203, s[8:11], s26 offen offset:0 lds
    v_accvgpr_read_b32 v189, a9
    v_mfma_f32_16x16x32_bf16 a[28:31], a[196:199], v[148:151], a[28:31]
    ds_read_b128 a[236:239], v200 offset:48128
    v_accvgpr_read_b32 v190, a10
    v_mfma_f32_16x16x32_bf16 a[28:31], a[192:195], v[144:147], a[28:31]
    buffer_load_dwordx4 v203, s[8:11], s26 offen offset:1024 lds
    v_accvgpr_read_b32 v191, a11
    s_waitcnt lgkmcnt(4)
    v_mfma_f32_16x16x32_bf16 a[32:35], a[208:211], v[128:131], a[32:35]
    ds_read_b128 a[192:195], v201 offset:12288
    v_cvt_pk_bf16_f32 v184, v184, v185
    v_mfma_f32_16x16x32_bf16 a[32:35], a[212:215], v[132:135], a[32:35]
    buffer_load_dwordx4 v203, s[8:11], s26 offen offset:2048 lds
    v_cvt_pk_bf16_f32 v185, v186, v187
    v_mfma_f32_16x16x32_bf16 a[32:35], a[216:219], v[136:139], a[32:35]
    ds_read_b128 a[196:199], v201 offset:13312
    v_cvt_pk_bf16_f32 v186, v188, v189
    v_mfma_f32_16x16x32_bf16 a[32:35], a[220:223], v[140:143], a[32:35]
    s_add_u32 m0, s24, 73728
    v_cvt_pk_bf16_f32 v187, v190, v191
    v_mfma_f32_16x16x32_bf16 a[36:39], a[220:223], v[156:159], a[36:39]
    ds_read_b128 a[200:203], v201 offset:14336
    ds_write_b128 v124, v[184:187]
    ds_read_b128 v[188:191], v125
    v_accvgpr_read_b32 v192, a4
    v_mfma_f32_16x16x32_bf16 a[36:39], a[216:219], v[152:155], a[36:39]
    s_mov_b32 s26, 2568192
    v_accvgpr_read_b32 v193, a5
    v_mfma_f32_16x16x32_bf16 a[36:39], a[212:215], v[148:151], a[36:39]
    ds_read_b128 a[204:207], v201 offset:15360
    v_accvgpr_read_b32 v194, a6
    v_mfma_f32_16x16x32_bf16 a[36:39], a[208:211], v[144:147], a[36:39]
    v_accvgpr_read_b32 v195, a7
    s_waitcnt lgkmcnt(6)
    v_mfma_f32_16x16x32_bf16 a[40:43], a[224:227], v[128:131], a[40:43]
    ds_read_b128 a[208:211], v201 offset:16384
    v_accvgpr_read_b32 v196, a12
    v_mfma_f32_16x16x32_bf16 a[40:43], a[228:231], v[132:135], a[40:43]
    buffer_load_dwordx4 v203, s[8:11], s26 offen offset:0 lds
    v_accvgpr_read_b32 v197, a13
    v_mfma_f32_16x16x32_bf16 a[40:43], a[232:235], v[136:139], a[40:43]
    ds_read_b128 a[212:215], v201 offset:17408
    v_accvgpr_read_b32 v198, a14
    v_mfma_f32_16x16x32_bf16 a[40:43], a[236:239], v[140:143], a[40:43]
    buffer_load_dwordx4 v203, s[8:11], s26 offen offset:1024 lds
    v_accvgpr_read_b32 v199, a15
    v_mfma_f32_16x16x32_bf16 a[44:47], a[236:239], v[156:159], a[44:47]
    ds_read_b128 a[216:219], v201 offset:18432
    s_waitcnt lgkmcnt(4)
    buffer_store_dwordx4 v[188:191], v204, s[12:15], s22 offen offset:0 sc0 sc1
    v_cvt_pk_bf16_f32 v192, v192, v193
    v_mfma_f32_16x16x32_bf16 a[44:47], a[232:235], v[152:155], a[44:47]
    buffer_load_dwordx4 v203, s[8:11], s26 offen offset:2048 lds
    v_cvt_pk_bf16_f32 v193, v194, v195
    v_mfma_f32_16x16x32_bf16 a[44:47], a[228:231], v[148:151], a[44:47]
    ds_read_b128 a[220:223], v201 offset:19456
    v_cvt_pk_bf16_f32 v194, v196, v197
    v_mfma_f32_16x16x32_bf16 a[44:47], a[224:227], v[144:147], a[44:47]
    v_cvt_pk_bf16_f32 v195, v198, v199
    ds_write_b128 v124, v[192:195]
    ds_read_b128 v[196:199], v125
    s_waitcnt vmcnt(10)
    s_barrier
    s_waitcnt lgkmcnt(6)
    v_mfma_f32_16x16x32_bf16 a[48:51], a[192:195], v[128:131], a[48:51]
    ds_read_b128 a[224:227], v201 offset:20480
    v_mfma_f32_16x16x32_bf16 a[48:51], a[196:199], v[132:135], a[48:51]
    s_add_u32 m0, s24, 36864
    v_accvgpr_read_b32 v184, a16
    v_accvgpr_read_b32 v185, a17
    v_accvgpr_read_b32 v186, a18
    v_mfma_f32_16x16x32_bf16 a[48:51], a[200:203], v[136:139], a[48:51]
    ds_read_b128 a[228:231], v201 offset:21504
    v_accvgpr_read_b32 v187, a19
    v_accvgpr_read_b32 v188, a24
    v_accvgpr_read_b32 v189, a25
    v_mfma_f32_16x16x32_bf16 a[48:51], a[204:207], v[140:143], a[48:51]
    s_mov_b32 s26, 2519040
    v_accvgpr_read_b32 v190, a26
    v_accvgpr_read_b32 v191, a27
    v_mfma_f32_16x16x32_bf16 a[52:55], a[204:207], v[156:159], a[52:55]
    ds_read_b128 a[232:235], v201 offset:22528
    s_waitcnt lgkmcnt(3)
    buffer_store_dwordx4 v[196:199], v205, s[12:15], s22 offen offset:0 sc0 sc1
    v_cvt_pk_bf16_f32 v184, v184, v185
    v_cvt_pk_bf16_f32 v185, v186, v187
    v_mfma_f32_16x16x32_bf16 a[52:55], a[200:203], v[152:155], a[52:55]
    s_nop 0
    v_cvt_pk_bf16_f32 v186, v188, v189
    v_cvt_pk_bf16_f32 v187, v190, v191
    v_mfma_f32_16x16x32_bf16 a[52:55], a[196:199], v[148:151], a[52:55]
    ds_read_b128 a[236:239], v201 offset:23552
    ds_write_b128 v124, v[184:187]
    ds_read_b128 v[188:191], v125
    v_accvgpr_read_b32 v192, a20
    v_accvgpr_read_b32 v193, a21
    v_mfma_f32_16x16x32_bf16 a[52:55], a[192:195], v[144:147], a[52:55]
    s_nop 0
    v_accvgpr_read_b32 v194, a22
    v_accvgpr_read_b32 v195, a23
    v_mfma_f32_16x16x32_bf16 a[56:59], a[208:211], v[128:131], a[56:59]
    ds_read_b128 a[192:195], v201 offset:36864
    v_accvgpr_read_b32 v196, a28
    v_accvgpr_read_b32 v197, a29
    v_mfma_f32_16x16x32_bf16 a[56:59], a[212:215], v[132:135], a[56:59]
    buffer_load_dwordx4 v203, s[8:11], s26 offen offset:0 lds
    v_accvgpr_read_b32 v198, a30
    v_accvgpr_read_b32 v199, a31
    v_mfma_f32_16x16x32_bf16 a[56:59], a[216:219], v[136:139], a[56:59]
    ds_read_b128 a[196:199], v201 offset:37888
    s_waitcnt lgkmcnt(2)
    buffer_store_dwordx4 v[188:191], v204, s[12:15], s22 offen offset:64 sc0 sc1
    v_cvt_pk_bf16_f32 v192, v192, v193
    v_cvt_pk_bf16_f32 v193, v194, v195
    v_mfma_f32_16x16x32_bf16 a[56:59], a[220:223], v[140:143], a[56:59]
    buffer_load_dwordx4 v203, s[8:11], s26 offen offset:1024 lds
    v_cvt_pk_bf16_f32 v194, v196, v197
    v_cvt_pk_bf16_f32 v195, v198, v199
    v_mfma_f32_16x16x32_bf16 a[60:63], a[220:223], v[156:159], a[60:63]
    ds_read_b128 a[200:203], v201 offset:38912
    ds_write_b128 v124, v[192:195]
    ds_read_b128 v[196:199], v125
    v_accvgpr_read_b32 v184, a32
    v_accvgpr_read_b32 v185, a33
    v_mfma_f32_16x16x32_bf16 a[60:63], a[216:219], v[152:155], a[60:63]
    s_nop 0
    v_accvgpr_read_b32 v186, a34
    v_accvgpr_read_b32 v187, a35
    v_mfma_f32_16x16x32_bf16 a[60:63], a[212:215], v[148:151], a[60:63]
    ds_read_b128 a[204:207], v201 offset:39936
    v_accvgpr_read_b32 v188, a40
    v_accvgpr_read_b32 v189, a41
    v_mfma_f32_16x16x32_bf16 a[60:63], a[208:211], v[144:147], a[60:63]
    s_nop 0
    v_accvgpr_read_b32 v190, a42
    v_accvgpr_read_b32 v191, a43
    v_mfma_f32_16x16x32_bf16 a[64:67], a[224:227], v[128:131], a[64:67]
    ds_read_b128 a[208:211], v201 offset:40960
    s_waitcnt lgkmcnt(2)
    buffer_store_dwordx4 v[196:199], v205, s[12:15], s22 offen offset:64 sc0 sc1
    v_cvt_pk_bf16_f32 v184, v184, v185
    v_cvt_pk_bf16_f32 v185, v186, v187
    v_mfma_f32_16x16x32_bf16 a[64:67], a[228:231], v[132:135], a[64:67]
    buffer_load_dwordx4 v203, s[8:11], s26 offen offset:2048 lds
    v_cvt_pk_bf16_f32 v186, v188, v189
    v_cvt_pk_bf16_f32 v187, v190, v191
    v_mfma_f32_16x16x32_bf16 a[64:67], a[232:235], v[136:139], a[64:67]
    ds_read_b128 a[212:215], v201 offset:41984
    ds_write_b128 v124, v[184:187]
    ds_read_b128 v[188:191], v125
    v_accvgpr_read_b32 v192, a36
    v_accvgpr_read_b32 v193, a37
    v_mfma_f32_16x16x32_bf16 a[64:67], a[236:239], v[140:143], a[64:67]
    s_nop 0
    v_accvgpr_read_b32 v194, a38
    v_accvgpr_read_b32 v195, a39
    v_mfma_f32_16x16x32_bf16 a[68:71], a[236:239], v[156:159], a[68:71]
    ds_read_b128 a[216:219], v201 offset:43008
    v_accvgpr_read_b32 v196, a44
    v_accvgpr_read_b32 v197, a45
    v_mfma_f32_16x16x32_bf16 a[68:71], a[232:235], v[152:155], a[68:71]
    s_nop 0
    v_accvgpr_read_b32 v198, a46
    v_accvgpr_read_b32 v199, a47
    v_mfma_f32_16x16x32_bf16 a[68:71], a[228:231], v[148:151], a[68:71]
    ds_read_b128 a[220:223], v201 offset:44032
    s_waitcnt lgkmcnt(2)
    buffer_store_dwordx4 v[188:191], v204, s[12:15], s22 offen offset:128 sc0 sc1
    v_cvt_pk_bf16_f32 v192, v192, v193
    v_cvt_pk_bf16_f32 v193, v194, v195
    v_mfma_f32_16x16x32_bf16 a[68:71], a[224:227], v[144:147], a[68:71]
    s_nop 0
    v_cvt_pk_bf16_f32 v194, v196, v197
    v_cvt_pk_bf16_f32 v195, v198, v199
    ds_write_b128 v124, v[192:195]
    ds_read_b128 v[196:199], v125
    s_waitcnt vmcnt(11)
    s_barrier
    v_mfma_f32_16x16x32_bf16 a[72:75], a[192:195], v[128:131], a[72:75]
    ds_read_b128 a[224:227], v201 offset:45056
    v_mfma_f32_16x16x32_bf16 a[72:75], a[196:199], v[132:135], a[72:75]
    s_nop 0
    v_accvgpr_read_b32 v184, a48
    v_accvgpr_read_b32 v185, a49
    v_mfma_f32_16x16x32_bf16 a[72:75], a[200:203], v[136:139], a[72:75]
    ds_read_b128 a[228:231], v201 offset:46080
    v_accvgpr_read_b32 v186, a50
    v_mfma_f32_16x16x32_bf16 a[72:75], a[204:207], v[140:143], a[72:75]
    v_accvgpr_read_b32 v187, a51
    v_mfma_f32_16x16x32_bf16 a[76:79], a[204:207], v[156:159], a[76:79]
    ds_read_b128 a[232:235], v201 offset:47104
    v_accvgpr_read_b32 v188, a56
    v_mfma_f32_16x16x32_bf16 a[76:79], a[200:203], v[152:155], a[76:79]
    v_accvgpr_read_b32 v189, a57
    v_mfma_f32_16x16x32_bf16 a[76:79], a[196:199], v[148:151], a[76:79]
    ds_read_b128 a[236:239], v201 offset:48128
    v_accvgpr_read_b32 v190, a58
    v_mfma_f32_16x16x32_bf16 a[76:79], a[192:195], v[144:147], a[76:79]
    v_accvgpr_read_b32 v191, a59
    s_waitcnt lgkmcnt(6)
    v_mfma_f32_16x16x32_bf16 a[80:83], a[208:211], v[128:131], a[80:83]
    ds_read_b128 a[192:195], v200 offset:12288
    s_waitcnt lgkmcnt(5)
    buffer_store_dwordx4 v[196:199], v205, s[12:15], s22 offen offset:128 sc0 sc1
    v_cvt_pk_bf16_f32 v184, v184, v185
    v_mfma_f32_16x16x32_bf16 a[80:83], a[212:215], v[132:135], a[80:83]
    v_cvt_pk_bf16_f32 v185, v186, v187
    v_mfma_f32_16x16x32_bf16 a[80:83], a[216:219], v[136:139], a[80:83]
    ds_read_b128 a[196:199], v200 offset:13312
    v_cvt_pk_bf16_f32 v186, v188, v189
    v_mfma_f32_16x16x32_bf16 a[80:83], a[220:223], v[140:143], a[80:83]
    v_cvt_pk_bf16_f32 v187, v190, v191
    v_mfma_f32_16x16x32_bf16 a[84:87], a[220:223], v[156:159], a[84:87]
    ds_read_b128 a[200:203], v200 offset:14336
    ds_write_b128 v124, v[184:187]
    ds_read_b128 v[188:191], v125
    v_accvgpr_read_b32 v192, a52
    v_mfma_f32_16x16x32_bf16 a[84:87], a[216:219], v[152:155], a[84:87]
    v_accvgpr_read_b32 v193, a53
    v_mfma_f32_16x16x32_bf16 a[84:87], a[212:215], v[148:151], a[84:87]
    ds_read_b128 a[204:207], v200 offset:15360
    v_accvgpr_read_b32 v194, a54
    v_mfma_f32_16x16x32_bf16 a[84:87], a[208:211], v[144:147], a[84:87]
    v_accvgpr_read_b32 v195, a55
    s_waitcnt lgkmcnt(6)
    v_mfma_f32_16x16x32_bf16 a[88:91], a[224:227], v[128:131], a[88:91]
    ds_read_b128 a[208:211], v200 offset:16384
    v_accvgpr_read_b32 v196, a60
    v_mfma_f32_16x16x32_bf16 a[88:91], a[228:231], v[132:135], a[88:91]
    v_accvgpr_read_b32 v197, a61
    v_mfma_f32_16x16x32_bf16 a[88:91], a[232:235], v[136:139], a[88:91]
    ds_read_b128 a[212:215], v200 offset:17408
    v_accvgpr_read_b32 v198, a62
    v_mfma_f32_16x16x32_bf16 a[88:91], a[236:239], v[140:143], a[88:91]
    v_accvgpr_read_b32 v199, a63
    v_mfma_f32_16x16x32_bf16 a[92:95], a[236:239], v[156:159], a[92:95]
    ds_read_b128 a[216:219], v200 offset:18432
    s_waitcnt lgkmcnt(4)
    buffer_store_dwordx4 v[188:191], v204, s[12:15], s22 offen offset:192 sc0 sc1
    v_cvt_pk_bf16_f32 v192, v192, v193
    v_mfma_f32_16x16x32_bf16 a[92:95], a[232:235], v[152:155], a[92:95]
    v_cvt_pk_bf16_f32 v193, v194, v195
    v_mfma_f32_16x16x32_bf16 a[92:95], a[228:231], v[148:151], a[92:95]
    ds_read_b128 a[220:223], v200 offset:19456
    v_cvt_pk_bf16_f32 v194, v196, v197
    v_mfma_f32_16x16x32_bf16 a[92:95], a[224:227], v[144:147], a[92:95]
    v_cvt_pk_bf16_f32 v195, v198, v199
    ds_write_b128 v124, v[192:195]
    ds_read_b128 v[196:199], v125
    s_waitcnt vmcnt(3)
    s_barrier
    s_waitcnt lgkmcnt(6)
    v_mfma_f32_16x16x32_bf16 a[96:99], a[192:195], v[128:131], a[96:99]
    ds_read_b128 a[224:227], v200 offset:20480
    v_mfma_f32_16x16x32_bf16 a[96:99], a[196:199], v[132:135], a[96:99]
    s_nop 0
    v_accvgpr_read_b32 v184, a64
    v_accvgpr_read_b32 v185, a65
    v_accvgpr_read_b32 v186, a66
    v_mfma_f32_16x16x32_bf16 a[96:99], a[200:203], v[136:139], a[96:99]
    ds_read_b128 a[228:231], v200 offset:21504
    v_accvgpr_read_b32 v187, a67
    v_accvgpr_read_b32 v188, a72
    v_accvgpr_read_b32 v189, a73
    v_mfma_f32_16x16x32_bf16 a[96:99], a[204:207], v[140:143], a[96:99]
    s_nop 0
    v_accvgpr_read_b32 v190, a74
    v_accvgpr_read_b32 v191, a75
    v_mfma_f32_16x16x32_bf16 a[100:103], a[204:207], v[156:159], a[100:103]
    ds_read_b128 a[232:235], v200 offset:22528
    s_waitcnt lgkmcnt(3)
    buffer_store_dwordx4 v[196:199], v205, s[12:15], s22 offen offset:192 sc0 sc1
    v_cvt_pk_bf16_f32 v184, v184, v185
    v_cvt_pk_bf16_f32 v185, v186, v187
    v_mfma_f32_16x16x32_bf16 a[100:103], a[200:203], v[152:155], a[100:103]
    s_nop 0
    v_cvt_pk_bf16_f32 v186, v188, v189
    v_cvt_pk_bf16_f32 v187, v190, v191
    v_mfma_f32_16x16x32_bf16 a[100:103], a[196:199], v[148:151], a[100:103]
    ds_read_b128 a[236:239], v200 offset:23552
    ds_write_b128 v124, v[184:187]
    ds_read_b128 v[188:191], v125
    v_accvgpr_read_b32 v192, a68
    v_accvgpr_read_b32 v193, a69
    v_mfma_f32_16x16x32_bf16 a[100:103], a[192:195], v[144:147], a[100:103]
    s_nop 0
    v_accvgpr_read_b32 v194, a70
    v_accvgpr_read_b32 v195, a71
    v_mfma_f32_16x16x32_bf16 a[104:107], a[208:211], v[128:131], a[104:107]
    ds_read_b128 a[192:195], v200 offset:36864
    v_accvgpr_read_b32 v196, a76
    v_accvgpr_read_b32 v197, a77
    v_mfma_f32_16x16x32_bf16 a[104:107], a[212:215], v[132:135], a[104:107]
    s_nop 0
    v_accvgpr_read_b32 v198, a78
    v_accvgpr_read_b32 v199, a79
    v_mfma_f32_16x16x32_bf16 a[104:107], a[216:219], v[136:139], a[104:107]
    ds_read_b128 a[196:199], v200 offset:37888
    s_waitcnt lgkmcnt(2)
    buffer_store_dwordx4 v[188:191], v204, s[12:15], s22 offen offset:256 sc0 sc1
    v_cvt_pk_bf16_f32 v192, v192, v193
    v_cvt_pk_bf16_f32 v193, v194, v195
    v_mfma_f32_16x16x32_bf16 a[104:107], a[220:223], v[140:143], a[104:107]
    s_nop 0
    v_cvt_pk_bf16_f32 v194, v196, v197
    v_cvt_pk_bf16_f32 v195, v198, v199
    v_mfma_f32_16x16x32_bf16 a[108:111], a[220:223], v[156:159], a[108:111]
    ds_read_b128 a[200:203], v200 offset:38912
    ds_write_b128 v124, v[192:195]
    ds_read_b128 v[196:199], v125
    v_accvgpr_read_b32 v184, a80
    v_accvgpr_read_b32 v185, a81
    v_mfma_f32_16x16x32_bf16 a[108:111], a[216:219], v[152:155], a[108:111]
    s_nop 0
    v_accvgpr_read_b32 v186, a82
    v_accvgpr_read_b32 v187, a83
    v_mfma_f32_16x16x32_bf16 a[108:111], a[212:215], v[148:151], a[108:111]
    ds_read_b128 a[204:207], v200 offset:39936
    v_accvgpr_read_b32 v188, a88
    v_accvgpr_read_b32 v189, a89
    v_mfma_f32_16x16x32_bf16 a[108:111], a[208:211], v[144:147], a[108:111]
    s_nop 0
    v_accvgpr_read_b32 v190, a90
    v_accvgpr_read_b32 v191, a91
    v_mfma_f32_16x16x32_bf16 a[112:115], a[224:227], v[128:131], a[112:115]
    ds_read_b128 a[208:211], v200 offset:40960
    s_waitcnt lgkmcnt(2)
    buffer_store_dwordx4 v[196:199], v205, s[12:15], s22 offen offset:256 sc0 sc1
    v_cvt_pk_bf16_f32 v184, v184, v185
    v_cvt_pk_bf16_f32 v185, v186, v187
    v_mfma_f32_16x16x32_bf16 a[112:115], a[228:231], v[132:135], a[112:115]
    s_nop 0
    v_cvt_pk_bf16_f32 v186, v188, v189
    v_cvt_pk_bf16_f32 v187, v190, v191
    v_mfma_f32_16x16x32_bf16 a[112:115], a[232:235], v[136:139], a[112:115]
    ds_read_b128 a[212:215], v200 offset:41984
    ds_write_b128 v124, v[184:187]
    ds_read_b128 v[188:191], v125
    v_accvgpr_read_b32 v192, a84
    v_accvgpr_read_b32 v193, a85
    v_mfma_f32_16x16x32_bf16 a[112:115], a[236:239], v[140:143], a[112:115]
    s_nop 0
    v_accvgpr_read_b32 v194, a86
    v_accvgpr_read_b32 v195, a87
    v_mfma_f32_16x16x32_bf16 a[116:119], a[236:239], v[156:159], a[116:119]
    ds_read_b128 a[216:219], v200 offset:43008
    v_accvgpr_read_b32 v196, a92
    v_accvgpr_read_b32 v197, a93
    v_mfma_f32_16x16x32_bf16 a[116:119], a[232:235], v[152:155], a[116:119]
    s_nop 0
    v_accvgpr_read_b32 v198, a94
    v_accvgpr_read_b32 v199, a95
    v_mfma_f32_16x16x32_bf16 a[116:119], a[228:231], v[148:151], a[116:119]
    ds_read_b128 a[220:223], v200 offset:44032
    s_waitcnt lgkmcnt(2)
    buffer_store_dwordx4 v[188:191], v204, s[12:15], s22 offen offset:320 sc0 sc1
    v_cvt_pk_bf16_f32 v192, v192, v193
    v_cvt_pk_bf16_f32 v193, v194, v195
    v_mfma_f32_16x16x32_bf16 a[116:119], a[224:227], v[144:147], a[116:119]
    s_nop 0
    v_cvt_pk_bf16_f32 v194, v196, v197
    v_cvt_pk_bf16_f32 v195, v198, v199
    ds_write_b128 v124, v[192:195]
    ds_read_b128 v[196:199], v125
    v_mfma_f32_16x16x32_bf16 a[120:123], a[192:195], v[128:131], a[120:123]
    ds_read_b128 a[224:227], v200 offset:45056
    v_mfma_f32_16x16x32_bf16 a[120:123], a[196:199], v[132:135], a[120:123]
    s_nop 0
    v_accvgpr_read_b32 v184, a96
    v_accvgpr_read_b32 v185, a97
    v_mfma_f32_16x16x32_bf16 a[120:123], a[200:203], v[136:139], a[120:123]
    ds_read_b128 a[228:231], v200 offset:46080
    v_accvgpr_read_b32 v186, a98
    v_mfma_f32_16x16x32_bf16 a[120:123], a[204:207], v[140:143], a[120:123]
    v_accvgpr_read_b32 v187, a99
    v_mfma_f32_16x16x32_bf16 a[124:127], a[204:207], v[156:159], a[124:127]
    ds_read_b128 a[232:235], v200 offset:47104
    v_accvgpr_read_b32 v188, a104
    v_mfma_f32_16x16x32_bf16 a[124:127], a[200:203], v[152:155], a[124:127]
    v_accvgpr_read_b32 v189, a105
    v_mfma_f32_16x16x32_bf16 a[124:127], a[196:199], v[148:151], a[124:127]
    ds_read_b128 a[236:239], v200 offset:48128
    v_accvgpr_read_b32 v190, a106
    v_mfma_f32_16x16x32_bf16 a[124:127], a[192:195], v[144:147], a[124:127]
    v_accvgpr_read_b32 v191, a107
    s_waitcnt lgkmcnt(6)
    v_mfma_f32_16x16x32_bf16 a[128:131], a[208:211], v[128:131], a[128:131]
    ds_read_b128 a[192:195], v201 offset:0
    s_waitcnt lgkmcnt(5)
    buffer_store_dwordx4 v[196:199], v205, s[12:15], s22 offen offset:320 sc0 sc1
    v_cvt_pk_bf16_f32 v184, v184, v185
    v_mfma_f32_16x16x32_bf16 a[128:131], a[212:215], v[132:135], a[128:131]
    v_cvt_pk_bf16_f32 v185, v186, v187
    v_mfma_f32_16x16x32_bf16 a[128:131], a[216:219], v[136:139], a[128:131]
    ds_read_b128 a[196:199], v201 offset:1024
    v_cvt_pk_bf16_f32 v186, v188, v189
    v_mfma_f32_16x16x32_bf16 a[128:131], a[220:223], v[140:143], a[128:131]
    v_cvt_pk_bf16_f32 v187, v190, v191
    v_mfma_f32_16x16x32_bf16 a[132:135], a[220:223], v[156:159], a[132:135]
    ds_read_b128 a[200:203], v201 offset:2048
    ds_write_b128 v124, v[184:187]
    ds_read_b128 v[188:191], v125
    v_accvgpr_read_b32 v192, a100
    v_mfma_f32_16x16x32_bf16 a[132:135], a[216:219], v[152:155], a[132:135]
    v_accvgpr_read_b32 v193, a101
    v_mfma_f32_16x16x32_bf16 a[132:135], a[212:215], v[148:151], a[132:135]
    ds_read_b128 a[204:207], v201 offset:3072
    v_accvgpr_read_b32 v194, a102
    v_mfma_f32_16x16x32_bf16 a[132:135], a[208:211], v[144:147], a[132:135]
    v_accvgpr_read_b32 v195, a103
    s_waitcnt lgkmcnt(6)
    v_mfma_f32_16x16x32_bf16 a[136:139], a[224:227], v[128:131], a[136:139]
    ds_read_b128 a[208:211], v201 offset:4096
    v_accvgpr_read_b32 v196, a108
    v_mfma_f32_16x16x32_bf16 a[136:139], a[228:231], v[132:135], a[136:139]
    v_accvgpr_read_b32 v197, a109
    v_mfma_f32_16x16x32_bf16 a[136:139], a[232:235], v[136:139], a[136:139]
    ds_read_b128 a[212:215], v201 offset:5120
    v_accvgpr_read_b32 v198, a110
    v_mfma_f32_16x16x32_bf16 a[136:139], a[236:239], v[140:143], a[136:139]
    v_accvgpr_read_b32 v199, a111
    v_mfma_f32_16x16x32_bf16 a[140:143], a[236:239], v[156:159], a[140:143]
    ds_read_b128 a[216:219], v201 offset:6144
    s_waitcnt lgkmcnt(4)
    buffer_store_dwordx4 v[188:191], v204, s[12:15], s22 offen offset:384 sc0 sc1
    v_cvt_pk_bf16_f32 v192, v192, v193
    v_mfma_f32_16x16x32_bf16 a[140:143], a[232:235], v[152:155], a[140:143]
    v_cvt_pk_bf16_f32 v193, v194, v195
    v_mfma_f32_16x16x32_bf16 a[140:143], a[228:231], v[148:151], a[140:143]
    ds_read_b128 a[220:223], v201 offset:7168
    v_cvt_pk_bf16_f32 v194, v196, v197
    v_mfma_f32_16x16x32_bf16 a[140:143], a[224:227], v[144:147], a[140:143]
    v_cvt_pk_bf16_f32 v195, v198, v199
    ds_write_b128 v124, v[192:195]
    ds_read_b128 v[196:199], v125
    s_waitcnt lgkmcnt(6)
    v_mfma_f32_16x16x32_bf16 a[144:147], a[192:195], v[128:131], a[144:147]
    ds_read_b128 a[224:227], v201 offset:8192
    v_mfma_f32_16x16x32_bf16 a[144:147], a[196:199], v[132:135], a[144:147]
    s_nop 0
    v_accvgpr_read_b32 v184, a112
    v_accvgpr_read_b32 v185, a113
    v_accvgpr_read_b32 v186, a114
    v_mfma_f32_16x16x32_bf16 a[144:147], a[200:203], v[136:139], a[144:147]
    ds_read_b128 a[228:231], v201 offset:9216
    v_accvgpr_read_b32 v187, a115
    v_accvgpr_read_b32 v188, a120
    v_accvgpr_read_b32 v189, a121
    v_mfma_f32_16x16x32_bf16 a[144:147], a[204:207], v[140:143], a[144:147]
    s_nop 0
    v_accvgpr_read_b32 v190, a122
    v_accvgpr_read_b32 v191, a123
    v_mfma_f32_16x16x32_bf16 a[148:151], a[204:207], v[156:159], a[148:151]
    ds_read_b128 a[232:235], v201 offset:10240
    s_waitcnt lgkmcnt(3)
    buffer_store_dwordx4 v[196:199], v205, s[12:15], s22 offen offset:384 sc0 sc1
    v_cvt_pk_bf16_f32 v184, v184, v185
    v_cvt_pk_bf16_f32 v185, v186, v187
    v_mfma_f32_16x16x32_bf16 a[148:151], a[200:203], v[152:155], a[148:151]
    s_nop 0
    v_cvt_pk_bf16_f32 v186, v188, v189
    v_cvt_pk_bf16_f32 v187, v190, v191
    v_mfma_f32_16x16x32_bf16 a[148:151], a[196:199], v[148:151], a[148:151]
    ds_read_b128 a[236:239], v201 offset:11264
    ds_write_b128 v124, v[184:187]
    ds_read_b128 v[188:191], v125
    v_accvgpr_read_b32 v192, a116
    v_accvgpr_read_b32 v193, a117
    v_mfma_f32_16x16x32_bf16 a[148:151], a[192:195], v[144:147], a[148:151]
    s_nop 0
    v_accvgpr_read_b32 v194, a118
    v_accvgpr_read_b32 v195, a119
    v_mfma_f32_16x16x32_bf16 a[152:155], a[208:211], v[128:131], a[152:155]
    ds_read_b128 a[192:195], v201 offset:24576
    v_accvgpr_read_b32 v196, a124
    v_accvgpr_read_b32 v197, a125
    v_mfma_f32_16x16x32_bf16 a[152:155], a[212:215], v[132:135], a[152:155]
    s_nop 0
    v_accvgpr_read_b32 v198, a126
    v_accvgpr_read_b32 v199, a127
    v_mfma_f32_16x16x32_bf16 a[152:155], a[216:219], v[136:139], a[152:155]
    ds_read_b128 a[196:199], v201 offset:25600
    s_waitcnt lgkmcnt(2)
    buffer_store_dwordx4 v[188:191], v204, s[12:15], s22 offen offset:448 sc0 sc1
    v_cvt_pk_bf16_f32 v192, v192, v193
    v_cvt_pk_bf16_f32 v193, v194, v195
    v_mfma_f32_16x16x32_bf16 a[152:155], a[220:223], v[140:143], a[152:155]
    s_nop 0
    v_cvt_pk_bf16_f32 v194, v196, v197
    v_cvt_pk_bf16_f32 v195, v198, v199
    v_mfma_f32_16x16x32_bf16 a[156:159], a[220:223], v[156:159], a[156:159]
    ds_read_b128 a[200:203], v201 offset:26624
    ds_write_b128 v124, v[192:195]
    ds_read_b128 v[196:199], v125
    v_accvgpr_read_b32 v184, a128
    v_accvgpr_read_b32 v185, a129
    v_mfma_f32_16x16x32_bf16 a[156:159], a[216:219], v[152:155], a[156:159]
    s_nop 0
    v_accvgpr_read_b32 v186, a130
    v_accvgpr_read_b32 v187, a131
    v_mfma_f32_16x16x32_bf16 a[156:159], a[212:215], v[148:151], a[156:159]
    ds_read_b128 a[204:207], v201 offset:27648
    v_accvgpr_read_b32 v188, a136
    v_accvgpr_read_b32 v189, a137
    v_mfma_f32_16x16x32_bf16 a[156:159], a[208:211], v[144:147], a[156:159]
    s_nop 0
    v_accvgpr_read_b32 v190, a138
    v_accvgpr_read_b32 v191, a139
    v_mfma_f32_16x16x32_bf16 a[160:163], a[224:227], v[128:131], a[160:163]
    ds_read_b128 a[208:211], v201 offset:28672
    s_waitcnt lgkmcnt(2)
    buffer_store_dwordx4 v[196:199], v205, s[12:15], s22 offen offset:448 sc0 sc1
    v_cvt_pk_bf16_f32 v184, v184, v185
    v_cvt_pk_bf16_f32 v185, v186, v187
    v_mfma_f32_16x16x32_bf16 a[160:163], a[228:231], v[132:135], a[160:163]
    s_nop 0
    v_cvt_pk_bf16_f32 v186, v188, v189
    v_cvt_pk_bf16_f32 v187, v190, v191
    v_mfma_f32_16x16x32_bf16 a[160:163], a[232:235], v[136:139], a[160:163]
    ds_read_b128 a[212:215], v201 offset:29696
    ds_write_b128 v124, v[184:187]
    ds_read_b128 v[188:191], v125
    v_accvgpr_read_b32 v192, a132
    v_accvgpr_read_b32 v193, a133
    v_mfma_f32_16x16x32_bf16 a[160:163], a[236:239], v[140:143], a[160:163]
    s_nop 0
    v_accvgpr_read_b32 v194, a134
    v_accvgpr_read_b32 v195, a135
    v_mfma_f32_16x16x32_bf16 a[164:167], a[236:239], v[156:159], a[164:167]
    ds_read_b128 a[216:219], v201 offset:30720
    v_accvgpr_read_b32 v196, a140
    v_accvgpr_read_b32 v197, a141
    v_mfma_f32_16x16x32_bf16 a[164:167], a[232:235], v[152:155], a[164:167]
    s_nop 0
    v_accvgpr_read_b32 v198, a142
    v_accvgpr_read_b32 v199, a143
    v_mfma_f32_16x16x32_bf16 a[164:167], a[228:231], v[148:151], a[164:167]
    ds_read_b128 a[220:223], v201 offset:31744
    s_waitcnt lgkmcnt(2)
    buffer_store_dwordx4 v[188:191], v204, s[12:15], s22 offen offset:512 sc0 sc1
    v_cvt_pk_bf16_f32 v192, v192, v193
    v_cvt_pk_bf16_f32 v193, v194, v195
    v_mfma_f32_16x16x32_bf16 a[164:167], a[224:227], v[144:147], a[164:167]
    s_nop 0
    v_cvt_pk_bf16_f32 v194, v196, v197
    v_cvt_pk_bf16_f32 v195, v198, v199
    ds_write_b128 v124, v[192:195]
    ds_read_b128 v[196:199], v125
    v_mfma_f32_16x16x32_bf16 a[168:171], a[192:195], v[128:131], a[168:171]
    ds_read_b128 a[224:227], v201 offset:32768
    v_mfma_f32_16x16x32_bf16 a[168:171], a[196:199], v[132:135], a[168:171]
    s_nop 0
    v_accvgpr_read_b32 v184, a144
    v_accvgpr_read_b32 v185, a145
    v_mfma_f32_16x16x32_bf16 a[168:171], a[200:203], v[136:139], a[168:171]
    ds_read_b128 a[228:231], v201 offset:33792
    v_accvgpr_read_b32 v186, a146
    v_mfma_f32_16x16x32_bf16 a[168:171], a[204:207], v[140:143], a[168:171]
    v_accvgpr_read_b32 v187, a147
    v_mfma_f32_16x16x32_bf16 a[172:175], a[204:207], v[156:159], a[172:175]
    ds_read_b128 a[232:235], v201 offset:34816
    v_accvgpr_read_b32 v188, a152
    v_mfma_f32_16x16x32_bf16 a[172:175], a[200:203], v[152:155], a[172:175]
    v_accvgpr_read_b32 v189, a153
    v_mfma_f32_16x16x32_bf16 a[172:175], a[196:199], v[148:151], a[172:175]
    ds_read_b128 a[236:239], v201 offset:35840
    v_accvgpr_read_b32 v190, a154
    v_mfma_f32_16x16x32_bf16 a[172:175], a[192:195], v[144:147], a[172:175]
    v_accvgpr_read_b32 v191, a155
    s_waitcnt lgkmcnt(6)
    v_mfma_f32_16x16x32_bf16 a[176:179], a[208:211], v[128:131], a[176:179]
    s_waitcnt lgkmcnt(4)
    buffer_store_dwordx4 v[196:199], v205, s[12:15], s22 offen offset:512 sc0 sc1
    v_cvt_pk_bf16_f32 v184, v184, v185
    v_mfma_f32_16x16x32_bf16 a[176:179], a[212:215], v[132:135], a[176:179]
    v_cvt_pk_bf16_f32 v185, v186, v187
    v_mfma_f32_16x16x32_bf16 a[176:179], a[216:219], v[136:139], a[176:179]
    v_cvt_pk_bf16_f32 v186, v188, v189
    v_mfma_f32_16x16x32_bf16 a[176:179], a[220:223], v[140:143], a[176:179]
    v_cvt_pk_bf16_f32 v187, v190, v191
    v_mfma_f32_16x16x32_bf16 a[180:183], a[220:223], v[156:159], a[180:183]
    ds_write_b128 v124, v[184:187]
    ds_read_b128 v[188:191], v125
    v_accvgpr_read_b32 v192, a148
    v_mfma_f32_16x16x32_bf16 a[180:183], a[216:219], v[152:155], a[180:183]
    v_accvgpr_read_b32 v193, a149
    v_mfma_f32_16x16x32_bf16 a[180:183], a[212:215], v[148:151], a[180:183]
    v_accvgpr_read_b32 v194, a150
    v_mfma_f32_16x16x32_bf16 a[180:183], a[208:211], v[144:147], a[180:183]
    v_accvgpr_read_b32 v195, a151
    s_waitcnt lgkmcnt(2)
    v_mfma_f32_16x16x32_bf16 a[184:187], a[224:227], v[128:131], a[184:187]
    v_accvgpr_read_b32 v196, a156
    v_mfma_f32_16x16x32_bf16 a[184:187], a[228:231], v[132:135], a[184:187]
    v_accvgpr_read_b32 v197, a157
    v_mfma_f32_16x16x32_bf16 a[184:187], a[232:235], v[136:139], a[184:187]
    v_accvgpr_read_b32 v198, a158
    v_mfma_f32_16x16x32_bf16 a[184:187], a[236:239], v[140:143], a[184:187]
    v_accvgpr_read_b32 v199, a159
    v_mfma_f32_16x16x32_bf16 a[188:191], a[236:239], v[156:159], a[188:191]
    s_waitcnt lgkmcnt(0)
    buffer_store_dwordx4 v[188:191], v204, s[12:15], s22 offen offset:576 sc0 sc1
    v_cvt_pk_bf16_f32 v192, v192, v193
    v_mfma_f32_16x16x32_bf16 a[188:191], a[232:235], v[152:155], a[188:191]
    v_cvt_pk_bf16_f32 v193, v194, v195
    v_mfma_f32_16x16x32_bf16 a[188:191], a[228:231], v[148:151], a[188:191]
    v_cvt_pk_bf16_f32 v194, v196, v197
    v_mfma_f32_16x16x32_bf16 a[188:191], a[224:227], v[144:147], a[188:191]
    v_cvt_pk_bf16_f32 v195, v198, v199
    ds_write_b128 v124, v[192:195]
    ds_read_b128 v[196:199], v125
    s_nop 7
    v_accvgpr_read_b32 v184, a160
    v_accvgpr_read_b32 v185, a161
    v_accvgpr_read_b32 v186, a162
    v_accvgpr_read_b32 v187, a163
    v_accvgpr_read_b32 v188, a168
    v_accvgpr_read_b32 v189, a169
    v_accvgpr_read_b32 v190, a170
    v_accvgpr_read_b32 v191, a171
    s_waitcnt lgkmcnt(0)
    buffer_store_dwordx4 v[196:199], v205, s[12:15], s22 offen offset:576 sc0 sc1
    v_cvt_pk_bf16_f32 v184, v184, v185
    v_cvt_pk_bf16_f32 v185, v186, v187
    v_cvt_pk_bf16_f32 v186, v188, v189
    v_cvt_pk_bf16_f32 v187, v190, v191
    ds_write_b128 v124, v[184:187]
    ds_read_b128 v[188:191], v125
    v_accvgpr_read_b32 v192, a164
    v_accvgpr_read_b32 v193, a165
    v_accvgpr_read_b32 v194, a166
    v_accvgpr_read_b32 v195, a167
    v_accvgpr_read_b32 v196, a172
    v_accvgpr_read_b32 v197, a173
    v_accvgpr_read_b32 v198, a174
    v_accvgpr_read_b32 v199, a175
    s_waitcnt lgkmcnt(0)
    buffer_store_dwordx4 v[188:191], v204, s[12:15], s22 offen offset:640 sc0 sc1
    v_cvt_pk_bf16_f32 v192, v192, v193
    v_cvt_pk_bf16_f32 v193, v194, v195
    v_cvt_pk_bf16_f32 v194, v196, v197
    v_cvt_pk_bf16_f32 v195, v198, v199
    ds_write_b128 v124, v[192:195]
    ds_read_b128 v[196:199], v125
    v_accvgpr_read_b32 v184, a176
    v_accvgpr_read_b32 v185, a177
    v_accvgpr_read_b32 v186, a178
    v_accvgpr_read_b32 v187, a179
    v_accvgpr_read_b32 v188, a184
    v_accvgpr_read_b32 v189, a185
    v_accvgpr_read_b32 v190, a186
    v_accvgpr_read_b32 v191, a187
    s_waitcnt lgkmcnt(0)
    buffer_store_dwordx4 v[196:199], v205, s[12:15], s22 offen offset:640 sc0 sc1
    v_cvt_pk_bf16_f32 v184, v184, v185
    v_cvt_pk_bf16_f32 v185, v186, v187
    v_cvt_pk_bf16_f32 v186, v188, v189
    v_cvt_pk_bf16_f32 v187, v190, v191
    ds_write_b128 v124, v[184:187]
    ds_read_b128 v[188:191], v125
    v_accvgpr_read_b32 v192, a180
    v_accvgpr_read_b32 v193, a181
    v_accvgpr_read_b32 v194, a182
    v_accvgpr_read_b32 v195, a183
    v_accvgpr_read_b32 v196, a188
    v_accvgpr_read_b32 v197, a189
    v_accvgpr_read_b32 v198, a190
    v_accvgpr_read_b32 v199, a191
    s_waitcnt lgkmcnt(0)
    buffer_store_dwordx4 v[188:191], v204, s[12:15], s22 offen offset:704 sc0 sc1
    v_cvt_pk_bf16_f32 v192, v192, v193
    v_cvt_pk_bf16_f32 v193, v194, v195
    v_cvt_pk_bf16_f32 v194, v196, v197
    v_cvt_pk_bf16_f32 v195, v198, v199
    ds_write_b128 v124, v[192:195]
    ds_read_b128 v[196:199], v125
    s_waitcnt lgkmcnt(0)
    buffer_store_dwordx4 v[196:199], v205, s[12:15], s22 offen offset:704 sc0 sc1
L_end:
    s_endpgm
L_spin:
    s_mov_b32 s36, 0x80000
    v_lshlrev_b32 v209, 7, v252
    s_mov_b32 s49, 96
L_spin2:
    buffer_load_dword v210, v209, s[56:59], 0 offen sc1
    s_waitcnt vmcnt(0)
    v_cmp_le_u32 s[50:51], s49, v210
    s_nop 3
    s_and_b32 s35, s50, 3
    s_cmp_eq_u32 s35, 3
    s_cbranch_scc1 L_spin3
    s_sub_u32 s36, s36, 1
    s_cmp_lg_u32 s36, 0
    s_cbranch_scc1 L_spin2
L_spin3:
    buffer_inv sc1
    s_waitcnt vmcnt(0)
    s_branch L_ready
L_codeend:
.section .rodata,"a"
.p2align 6
.amdhsa_kernel standalone__modern_conv_block_replknet__vision_kernel
  .amdhsa_next_free_vgpr 512
  .amdhsa_next_free_sgpr 102
  .amdhsa_accum_offset 256
  .amdhsa_group_segment_fixed_size 0
  .amdhsa_kernarg_size 64
  .amdhsa_user_sgpr_count 2
  .amdhsa_user_sgpr_kernarg_segment_ptr 1
  .amdhsa_system_sgpr_workgroup_id_x 1
  .amdhsa_float_denorm_mode_32 3
.end_amdhsa_kernel
```
